```python
import torch

def _softmax(x, axis=-1):
    return torch.softmax(x, dim=axis)
def _gelu(x):
    return torch.nn.functional.gelu(x, approximate="tanh")
def _silu(x):
    return torch.nn.functional.silu(x)
def _sigmoid(x):
    return torch.sigmoid(x)
def _layernorm(x, axis=-1, eps=1e-5):
    m = x.mean(dim=axis, keepdim=True)
    v = x.var(dim=axis, keepdim=True, unbiased=False)
    return (x - m) / torch.sqrt(v + eps)
def _scatter_add(tgt, idx, src, axis=0):
    return tgt.clone().index_add_(axis, idx, src)
def _segment_sum(src, seg, n):
    out = torch.zeros((n,) + src.shape[1:], dtype=src.dtype)
    return out.index_add_(0, seg, src)
def _pad(x, pw):
    flat = tuple(v for pair in reversed(pw) for v in pair)
    return torch.nn.functional.pad(x, flat)

kernel_name = 'sequential_preLN__softmax_full_mha__dense_activation_relu__prompt'

def setup_inputs():

    _w = (lambda a: (lambda t: t.to(torch.bfloat16) if t.is_floating_point() else t)(torch.as_tensor(a)))
    def _A_setup():
        B, S, D = 1, 2048, 640
        return {
            "x": _w((lambda *s: torch.randn(*s, dtype=torch.bfloat16) * 0.05)(B, S, D)),
            "wqkv": _w((lambda *s: torch.randn(*s, dtype=torch.bfloat16) * 0.05)(D, 3 * D)),
            "wo": _w((lambda *s: torch.randn(*s, dtype=torch.bfloat16) * 0.05)(D, D)),
        }
    _A_in = _A_setup()

    def _B_setup():
        B, S, D, Dff = 1, 2048, 640, 1728
        return {
            "x": _w((lambda *s: torch.randn(*s, dtype=torch.bfloat16) * 0.05)(B, S, D)),
            "w1": _w((lambda *s: torch.randn(*s, dtype=torch.bfloat16) * 0.05)(D, Dff)),
            "w2": _w((lambda *s: torch.randn(*s, dtype=torch.bfloat16) * 0.05)(Dff, D)),
        }
    _B_in = _B_setup()

    return {
        "A_x": _A_in["x"],
        "A_wqkv": _A_in["wqkv"],
        "A_wo": _A_in["wo"],
        "B_x": _B_in["x"],
        "B_w1": _B_in["w1"],
        "B_w2": _B_in["w2"],
    }

def reference(A_x, A_wqkv, A_wo, B_x, B_w1, B_w2):
    def _A_ref(x, wqkv, wo):
        B, S, D = x.shape
        H = 32; Dh = D // H
        qkv = (lambda x, *d: x.permute(*d))((x @ wqkv).reshape(B, S, 3, H, Dh), 2, 0, 3, 1, 4)
        q, k, v = qkv[0], qkv[1], qkv[2]
        scale = Dh ** -0.5
        scores = torch.einsum("bhqd,bhkd->bhqk", q, k) * scale
        p = _softmax(scores, axis=-1)
        o = torch.einsum("bhqk,bhkd->bhqd", p, v)
        return (lambda x, *d: x.permute(*d))(o, 0, 2, 1, 3).reshape(B, S, D) @ wo

    def _B_ref(x, w1, w2):
        h = torch.einsum("bsd,df->bsf", x, w1)
        zero = torch.zeros_like(h)
        h = torch.maximum(h, zero)
        return torch.einsum("bsf,fd->bsd", h, w2)

    x = A_x
    h = x + _A_ref(_layernorm(x, axis=-1), A_wqkv, A_wo)
    h2 = h + _B_ref(_layernorm(h, axis=-1), B_w1, B_w2)
    return h2
```

```asm
; @launch grid=(256,1,1) block=(512,1,1) lds=149504
.amdgcn_target "amdgcn-amd-amdhsa--gfx950"
.text
.globl sequential_preLN__softmax_full_mha__dense_activation_relu__prompt_kernel
.p2align 8
.type sequential_preLN__softmax_full_mha__dense_activation_relu__prompt_kernel,@function
sequential_preLN__softmax_full_mha__dense_activation_relu__prompt_kernel:
    s_cmp_ge_u32 s2, 256
    s_cbranch_scc1 L_exit
    s_load_dwordx8 s[84:91], s[0:1], 0
    s_load_dwordx8 s[92:99], s[0:1], 32
    s_load_dwordx2 s[78:79], s[0:1], 64
    v_lshrrev_b32 v2, 6, v0
    s_nop 0
    v_readfirstlane_b32 s100, v2
    v_mbcnt_lo_u32_b32 v1, -1, 0
    v_mbcnt_hi_u32_b32 v1, -1, v1
    s_cmp_eq_u32 s100, 1
    s_cbranch_scc0 L_pf_1
    s_getpc_b64 s[40:41]
L_pcref:
    s_lshr_b32 s42, s2, 3
    s_lshl_b32 s42, s42, 11
    v_lshlrev_b32 v26, 7, v1
    v_add_u32 v26, s42, v26
    s_mov_b32 s43, L_exit-L_pcref
    v_cmp_gt_u32 vcc, s43, v26
    s_nop 4
    s_and_b32 vcc_lo, vcc_lo, 0xffff
    s_mov_b32 vcc_hi, 0
    s_mov_b64 exec, vcc
    s_cbranch_execz L_pcskip
    global_load_dword v31, v26, s[40:41]
L_pcskip:
    s_mov_b64 exec, -1
L_pf_1:
    s_waitcnt lgkmcnt(0)
    s_mov_b32 s80, s78
    s_mov_b32 s81, s79
    s_and_b32 s81, s81, 0xffff
    s_mov_b32 s82, 0x16ba000
    s_mov_b32 s83, 0x20000
    s_cmp_eq_u32 s100, 3
    s_cbranch_scc0 L_wo_2
    v_lshlrev_b32 v26, 21, v1
    s_mov_b64 exec, 3
    s_mov_b32 s8, s84
    s_mov_b32 s9, s85
    s_and_b32 s9, s9, 0xffff
    s_mov_b32 s10, 0x280000
    s_mov_b32 s11, 0x20000
    buffer_load_dword v31, v26, s[8:11], 0 offen sc1
    s_mov_b32 s8, s86
    s_mov_b32 s9, s87
    s_and_b32 s9, s9, 0xffff
    s_mov_b32 s10, 0x258000
    s_mov_b32 s11, 0x20000
    buffer_load_dword v31, v26, s[8:11], 0 offen sc1
    s_mov_b64 exec, -1
L_wo_2:
    s_and_b32 s23, s2, 7
    s_lshr_b32 s24, s2, 3
    s_lshr_b32 s25, s23, 1
    s_lshl_b32 s25, s25, 2
    s_and_b32 s26, s24, 3
    s_add_u32 s21, s25, s26
    s_lshl_b32 s21, s21, 7
    s_and_b32 s23, s23, 1
    s_mul_i32 s23, s23, 8
    s_lshr_b32 s24, s24, 2
    s_add_u32 s34, s23, s24
    s_cmp_ge_u32 s24, 8
    s_cbranch_scc1 L_repack
    s_cmp_ge_u32 s34, 15
    s_cbranch_scc1 L_repack
    s_lshl_b32 s22, s34, 7
    s_mul_i32 s35, s26, 3
    s_add_u32 s35, s35, s24
    s_cmp_ge_u32 s35, 10
    s_cselect_b32 s23, 10, 0
    s_sub_u32 s35, s35, s23
    s_cmp_ge_u32 s100, 4
    s_cbranch_scc0 L_q_compute
    s_sub_u32 s20, s100, 4
    s_mov_b32 s8, s84
    s_mov_b32 s9, s85
    s_and_b32 s9, s9, 0xffff
    s_mov_b32 s10, 0x280000
    s_mov_b32 s11, 0x20000
    v_lshrrev_b32 v2, 3, v1
    v_mul_u32_u24 v2, 1280, v2
    v_lshrrev_b32 v3, 4, v1
    v_and_b32 v7, 7, v1
    v_xor_b32 v3, v3, v7
    v_lshlrev_b32 v3, 4, v3
    v_add_u32 v4, v2, v3
    v_xor_b32 v5, 64, v4
    s_lshl_b32 s23, s20, 5
    s_add_u32 s23, s23, s21
    s_mul_i32 s29, s23, 1280
    s_mov_b32 s12, s86
    s_mov_b32 s13, s87
    s_and_b32 s13, s13, 0xffff
    s_mov_b32 s14, 0x258000
    s_mov_b32 s15, 0x20000
    v_lshrrev_b32 v2, 4, v1
    v_mul_u32_u24 v3, 3840, v2
    v_lshlrev_b32 v2, 2, v2
    v_and_b32 v7, 15, v1
    v_xor_b32 v2, v2, v7
    v_lshlrev_b32 v2, 4, v2
    v_add_u32 v6, v2, v3
    s_lshl_b32 s23, s20, 4
    s_mul_i32 s23, s23, 3840
    s_lshl_b32 s24, s22, 1
    s_add_u32 s30, s23, s24
    s_lshl_b32 s31, s20, 12
    s_mul_i32 s23, s35, 128
    s_add_u32 s29, s29, s23
    s_mul_i32 s23, s35, 245760
    s_add_u32 s30, s30, s23
    s_mov_b32 s36, s35
    s_add_u32 m0, s31, 0
    s_mov_b32 s23, s29
    buffer_load_dwordx4 v4, s[8:11], s23 offen  lds
    s_add_u32 m0, m0, 1024
    s_add_u32 s23, s23, 10240
    buffer_load_dwordx4 v5, s[8:11], s23 offen  lds
    s_add_u32 m0, m0, 1024
    s_add_u32 s23, s23, 10240
    buffer_load_dwordx4 v4, s[8:11], s23 offen  lds
    s_add_u32 m0, m0, 1024
    s_add_u32 s23, s23, 10240
    buffer_load_dwordx4 v5, s[8:11], s23 offen  lds
    s_add_u32 s35, s35, 1
    s_cmp_eq_u32 s35, 10
    s_cselect_b32 s23, 1280, 0
    s_cselect_b32 s35, 0, s35
    s_add_u32 s29, s29, 128
    s_sub_u32 s29, s29, s23
    s_add_u32 m0, s31, 16384
    s_mov_b32 s23, s30
    buffer_load_dwordx4 v6, s[12:15], s23 offen  lds
    s_add_u32 m0, m0, 1024
    s_add_u32 s23, s23, 15360
    buffer_load_dwordx4 v6, s[12:15], s23 offen  lds
    s_add_u32 m0, m0, 1024
    s_add_u32 s23, s23, 15360
    buffer_load_dwordx4 v6, s[12:15], s23 offen  lds
    s_add_u32 m0, m0, 1024
    s_add_u32 s23, s23, 15360
    buffer_load_dwordx4 v6, s[12:15], s23 offen  lds
    s_add_u32 s36, s36, 1
    s_cmp_eq_u32 s36, 10
    s_cselect_b32 s23, 2457600, 0
    s_cselect_b32 s36, 0, s36
    s_add_u32 s30, s30, 245760
    s_sub_u32 s30, s30, s23
    s_add_u32 m0, s31, 32768
    s_mov_b32 s23, s29
    buffer_load_dwordx4 v4, s[8:11], s23 offen  lds
    s_add_u32 m0, m0, 1024
    s_add_u32 s23, s23, 10240
    buffer_load_dwordx4 v5, s[8:11], s23 offen  lds
    s_add_u32 m0, m0, 1024
    s_add_u32 s23, s23, 10240
    buffer_load_dwordx4 v4, s[8:11], s23 offen  lds
    s_add_u32 m0, m0, 1024
    s_add_u32 s23, s23, 10240
    buffer_load_dwordx4 v5, s[8:11], s23 offen  lds
    s_add_u32 s35, s35, 1
    s_cmp_eq_u32 s35, 10
    s_cselect_b32 s23, 1280, 0
    s_cselect_b32 s35, 0, s35
    s_add_u32 s29, s29, 128
    s_sub_u32 s29, s29, s23
    s_add_u32 m0, s31, 49152
    s_mov_b32 s23, s30
    buffer_load_dwordx4 v6, s[12:15], s23 offen  lds
    s_add_u32 m0, m0, 1024
    s_add_u32 s23, s23, 15360
    buffer_load_dwordx4 v6, s[12:15], s23 offen  lds
    s_add_u32 m0, m0, 1024
    s_add_u32 s23, s23, 15360
    buffer_load_dwordx4 v6, s[12:15], s23 offen  lds
    s_add_u32 m0, m0, 1024
    s_add_u32 s23, s23, 15360
    buffer_load_dwordx4 v6, s[12:15], s23 offen  lds
    s_add_u32 s36, s36, 1
    s_cmp_eq_u32 s36, 10
    s_cselect_b32 s23, 2457600, 0
    s_cselect_b32 s36, 0, s36
    s_add_u32 s30, s30, 245760
    s_sub_u32 s30, s30, s23
    s_mov_b32 s44, s98
    s_mov_b32 s45, s99
    s_and_b32 s45, s45, 0xffff
    s_mov_b32 s46, 0x100
    s_mov_b32 s47, 0x20000
    v_lshlrev_b32 v71, 2, v1
    v_mov_b32 v70, 0
    s_mul_i32 s75, s2, 768
    s_sub_u32 s76, s100, 4
    s_lshl_b32 s76, s76, 6
    s_add_u32 s75, s75, s76
    v_add_u32 v88, s75, v1
    v_add_u32 v89, 0, v88
    s_mov_b32 s75, 0x333334
    v_mul_hi_u32 v90, v89, s75
    v_mul_u32_u24 v91, 1280, v90
    v_sub_u32 v91, v89, v91
    v_mul_u32_u24 v92, 0xcccd, v91
    v_lshrrev_b32 v92, 19, v92
    v_mul_u32_u24 v93, 10, v92
    v_sub_u32 v93, v91, v93
    v_and_b32 v94, 0x73, v92
    v_and_b32 v97, 4, v92
    v_lshlrev_b32 v97, 1, v97
    v_or_b32 v94, v94, v97
    v_and_b32 v97, 8, v92
    v_lshrrev_b32 v97, 1, v97
    v_or_b32 v94, v94, v97
    v_lshlrev_b32 v110, 4, v89
    v_cmp_gt_u32 vcc, 40, v90
    v_subrev_u32 v97, 40, v90
    s_nop 0
    v_cndmask_b32 v97, v97, v90, vcc
    v_mul_u32_u24 v95, 0x4925, v97
    v_mul_u32_u24 v96, 0xcccd, v97
    v_cndmask_b32 v95, v95, v96, vcc
    v_lshrrev_b32 v95, 18, v95
    v_mov_b32 v96, 14
    v_cndmask_b32 v96, v96, 5, vcc
    v_mul_u32_u24 v96, v96, v95
    v_sub_u32 v96, v97, v96
    v_lshlrev_b32 v96, 7, v96
    v_add_u32 v94, v94, v96
    v_mul_u32_u24 v94, 1280, v94
    v_mul_u32_u24 v95, 160, v95
    v_lshlrev_b32 v93, 4, v93
    v_add3_u32 v94, v94, v95, v93
    v_mov_b32 v97, 0x7fffff00
    v_cndmask_b32 v95, v97, v94, vcc
    v_cndmask_b32 v94, v94, v97, vcc
    v_cmp_gt_u32 vcc, 152, v90
    s_nop 1
    v_cndmask_b32 v110, v97, v110, vcc
    v_mov_b32 v100, v95
    v_mov_b32 v101, v94
    v_mov_b32 v106, v90
    v_add_u32 v89, 256, v88
    s_mov_b32 s75, 0x333334
    v_mul_hi_u32 v90, v89, s75
    v_mul_u32_u24 v91, 1280, v90
    v_sub_u32 v91, v89, v91
    v_mul_u32_u24 v92, 0xcccd, v91
    v_lshrrev_b32 v92, 19, v92
    v_mul_u32_u24 v93, 10, v92
    v_sub_u32 v93, v91, v93
    v_and_b32 v94, 0x73, v92
    v_and_b32 v97, 4, v92
    v_lshlrev_b32 v97, 1, v97
    v_or_b32 v94, v94, v97
    v_and_b32 v97, 8, v92
    v_lshrrev_b32 v97, 1, v97
    v_or_b32 v94, v94, v97
    v_lshlrev_b32 v111, 4, v89
    v_cmp_gt_u32 vcc, 40, v90
    v_subrev_u32 v97, 40, v90
    s_nop 0
    v_cndmask_b32 v97, v97, v90, vcc
    v_mul_u32_u24 v95, 0x4925, v97
    v_mul_u32_u24 v96, 0xcccd, v97
    v_cndmask_b32 v95, v95, v96, vcc
    v_lshrrev_b32 v95, 18, v95
    v_mov_b32 v96, 14
    v_cndmask_b32 v96, v96, 5, vcc
    v_mul_u32_u24 v96, v96, v95
    v_sub_u32 v96, v97, v96
    v_lshlrev_b32 v96, 7, v96
    v_add_u32 v94, v94, v96
    v_mul_u32_u24 v94, 1280, v94
    v_mul_u32_u24 v95, 160, v95
    v_lshlrev_b32 v93, 4, v93
    v_add3_u32 v94, v94, v95, v93
    v_mov_b32 v97, 0x7fffff00
    v_cndmask_b32 v95, v97, v94, vcc
    v_cndmask_b32 v94, v94, v97, vcc
    v_cmp_gt_u32 vcc, 152, v90
    s_nop 1
    v_cndmask_b32 v111, v97, v111, vcc
    v_mov_b32 v102, v95
    v_mov_b32 v103, v94
    v_mov_b32 v107, v90
    v_add_u32 v89, 512, v88
    s_mov_b32 s75, 0x333334
    v_mul_hi_u32 v90, v89, s75
    v_mul_u32_u24 v91, 1280, v90
    v_sub_u32 v91, v89, v91
    v_mul_u32_u24 v92, 0xcccd, v91
    v_lshrrev_b32 v92, 19, v92
    v_mul_u32_u24 v93, 10, v92
    v_sub_u32 v93, v91, v93
    v_and_b32 v94, 0x73, v92
    v_and_b32 v97, 4, v92
    v_lshlrev_b32 v97, 1, v97
    v_or_b32 v94, v94, v97
    v_and_b32 v97, 8, v92
    v_lshrrev_b32 v97, 1, v97
    v_or_b32 v94, v94, v97
    v_lshlrev_b32 v112, 4, v89
    v_cmp_gt_u32 vcc, 40, v90
    v_subrev_u32 v97, 40, v90
    s_nop 0
    v_cndmask_b32 v97, v97, v90, vcc
    v_mul_u32_u24 v95, 0x4925, v97
    v_mul_u32_u24 v96, 0xcccd, v97
    v_cndmask_b32 v95, v95, v96, vcc
    v_lshrrev_b32 v95, 18, v95
    v_mov_b32 v96, 14
    v_cndmask_b32 v96, v96, 5, vcc
    v_mul_u32_u24 v96, v96, v95
    v_sub_u32 v96, v97, v96
    v_lshlrev_b32 v96, 7, v96
    v_add_u32 v94, v94, v96
    v_mul_u32_u24 v94, 1280, v94
    v_mul_u32_u24 v95, 160, v95
    v_lshlrev_b32 v93, 4, v93
    v_add3_u32 v94, v94, v95, v93
    v_mov_b32 v97, 0x7fffff00
    v_cndmask_b32 v95, v97, v94, vcc
    v_cndmask_b32 v94, v94, v97, vcc
    v_cmp_gt_u32 vcc, 152, v90
    s_nop 1
    v_cndmask_b32 v112, v97, v112, vcc
    v_mov_b32 v104, v95
    v_mov_b32 v105, v94
    v_mov_b32 v108, v90
    v_accvgpr_write_b32 a40, v110
    v_accvgpr_write_b32 a41, v111
    v_accvgpr_write_b32 a42, v112
    v_accvgpr_write_b32 a43, v100
    v_accvgpr_write_b32 a44, v101
    v_accvgpr_write_b32 a45, v102
    v_accvgpr_write_b32 a46, v103
    v_accvgpr_write_b32 a47, v104
    v_accvgpr_write_b32 a48, v105
    v_accvgpr_write_b32 a49, v106
    v_accvgpr_write_b32 a50, v107
    v_accvgpr_write_b32 a51, v108
    s_waitcnt vmcnt(8) lgkmcnt(0)
    s_barrier
    s_cmp_eq_u32 s100, 4
    s_cbranch_scc0 L_wo_3
    buffer_load_dword v70, v71, s[44:47], 0 offen sc1
L_wo_3:
    s_add_u32 m0, s31, 65536
    s_mov_b32 s23, s29
    buffer_load_dwordx4 v4, s[8:11], s23 offen  lds
    s_add_u32 m0, m0, 1024
    s_add_u32 s23, s23, 10240
    buffer_load_dwordx4 v5, s[8:11], s23 offen  lds
    s_add_u32 m0, m0, 1024
    s_add_u32 s23, s23, 10240
    buffer_load_dwordx4 v4, s[8:11], s23 offen  lds
    s_add_u32 m0, m0, 1024
    s_add_u32 s23, s23, 10240
    buffer_load_dwordx4 v5, s[8:11], s23 offen  lds
    s_add_u32 s35, s35, 1
    s_cmp_eq_u32 s35, 10
    s_cselect_b32 s23, 1280, 0
    s_cselect_b32 s35, 0, s35
    s_add_u32 s29, s29, 128
    s_sub_u32 s29, s29, s23
    s_add_u32 m0, s31, 81920
    s_mov_b32 s23, s30
    buffer_load_dwordx4 v6, s[12:15], s23 offen  lds
    s_add_u32 m0, m0, 1024
    s_add_u32 s23, s23, 15360
    buffer_load_dwordx4 v6, s[12:15], s23 offen  lds
    s_add_u32 m0, m0, 1024
    s_add_u32 s23, s23, 15360
    buffer_load_dwordx4 v6, s[12:15], s23 offen  lds
    s_add_u32 m0, m0, 1024
    s_add_u32 s23, s23, 15360
    buffer_load_dwordx4 v6, s[12:15], s23 offen  lds
    s_add_u32 s36, s36, 1
    s_cmp_eq_u32 s36, 10
    s_cselect_b32 s23, 2457600, 0
    s_cselect_b32 s36, 0, s36
    s_add_u32 s30, s30, 245760
    s_sub_u32 s30, s30, s23
    s_waitcnt vmcnt(8) lgkmcnt(0)
    s_barrier
    s_add_u32 m0, s31, 98304
    s_mov_b32 s23, s29
    buffer_load_dwordx4 v4, s[8:11], s23 offen  lds
    s_add_u32 m0, m0, 1024
    s_add_u32 s23, s23, 10240
    buffer_load_dwordx4 v5, s[8:11], s23 offen  lds
    s_add_u32 m0, m0, 1024
    s_add_u32 s23, s23, 10240
    buffer_load_dwordx4 v4, s[8:11], s23 offen  lds
    s_add_u32 m0, m0, 1024
    s_add_u32 s23, s23, 10240
    buffer_load_dwordx4 v5, s[8:11], s23 offen  lds
    s_add_u32 s35, s35, 1
    s_cmp_eq_u32 s35, 10
    s_cselect_b32 s23, 1280, 0
    s_cselect_b32 s35, 0, s35
    s_add_u32 s29, s29, 128
    s_sub_u32 s29, s29, s23
    s_add_u32 m0, s31, 114688
    s_mov_b32 s23, s30
    buffer_load_dwordx4 v6, s[12:15], s23 offen  lds
    s_add_u32 m0, m0, 1024
    s_add_u32 s23, s23, 15360
    buffer_load_dwordx4 v6, s[12:15], s23 offen  lds
    s_add_u32 m0, m0, 1024
    s_add_u32 s23, s23, 15360
    buffer_load_dwordx4 v6, s[12:15], s23 offen  lds
    s_add_u32 m0, m0, 1024
    s_add_u32 s23, s23, 15360
    buffer_load_dwordx4 v6, s[12:15], s23 offen  lds
    s_add_u32 s36, s36, 1
    s_cmp_eq_u32 s36, 10
    s_cselect_b32 s23, 2457600, 0
    s_cselect_b32 s36, 0, s36
    s_add_u32 s30, s30, 245760
    s_sub_u32 s30, s30, s23
    s_waitcnt vmcnt(8) lgkmcnt(0)
    s_barrier
    s_add_u32 m0, s31, 0
    s_mov_b32 s23, s29
    buffer_load_dwordx4 v4, s[8:11], s23 offen  lds
    s_add_u32 m0, m0, 1024
    s_add_u32 s23, s23, 10240
    buffer_load_dwordx4 v5, s[8:11], s23 offen  lds
    s_add_u32 m0, m0, 1024
    s_add_u32 s23, s23, 10240
    buffer_load_dwordx4 v4, s[8:11], s23 offen  lds
    s_add_u32 m0, m0, 1024
    s_add_u32 s23, s23, 10240
    buffer_load_dwordx4 v5, s[8:11], s23 offen  lds
    s_add_u32 s35, s35, 1
    s_cmp_eq_u32 s35, 10
    s_cselect_b32 s23, 1280, 0
    s_cselect_b32 s35, 0, s35
    s_add_u32 s29, s29, 128
    s_sub_u32 s29, s29, s23
    s_add_u32 m0, s31, 16384
    s_mov_b32 s23, s30
    buffer_load_dwordx4 v6, s[12:15], s23 offen  lds
    s_add_u32 m0, m0, 1024
    s_add_u32 s23, s23, 15360
    buffer_load_dwordx4 v6, s[12:15], s23 offen  lds
    s_add_u32 m0, m0, 1024
    s_add_u32 s23, s23, 15360
    buffer_load_dwordx4 v6, s[12:15], s23 offen  lds
    s_add_u32 m0, m0, 1024
    s_add_u32 s23, s23, 15360
    buffer_load_dwordx4 v6, s[12:15], s23 offen  lds
    s_add_u32 s36, s36, 1
    s_cmp_eq_u32 s36, 10
    s_cselect_b32 s23, 2457600, 0
    s_cselect_b32 s36, 0, s36
    s_add_u32 s30, s30, 245760
    s_sub_u32 s30, s30, s23
    s_waitcnt vmcnt(8) lgkmcnt(0)
    s_barrier
    s_cmp_eq_u32 s100, 7
    s_cbranch_scc0 L_wo_4
    s_mov_b64 exec, 7
    buffer_load_dword v70, v71, s[44:47], 0 offen sc1
    s_mov_b64 exec, -1
L_wo_4:
    s_add_u32 m0, s31, 32768
    s_mov_b32 s23, s29
    buffer_load_dwordx4 v4, s[8:11], s23 offen  lds
    s_add_u32 m0, m0, 1024
    s_add_u32 s23, s23, 10240
    buffer_load_dwordx4 v5, s[8:11], s23 offen  lds
    s_add_u32 m0, m0, 1024
    s_add_u32 s23, s23, 10240
    buffer_load_dwordx4 v4, s[8:11], s23 offen  lds
    s_add_u32 m0, m0, 1024
    s_add_u32 s23, s23, 10240
    buffer_load_dwordx4 v5, s[8:11], s23 offen  lds
    s_add_u32 s35, s35, 1
    s_cmp_eq_u32 s35, 10
    s_cselect_b32 s23, 1280, 0
    s_cselect_b32 s35, 0, s35
    s_add_u32 s29, s29, 128
    s_sub_u32 s29, s29, s23
    s_add_u32 m0, s31, 49152
    s_mov_b32 s23, s30
    buffer_load_dwordx4 v6, s[12:15], s23 offen  lds
    s_add_u32 m0, m0, 1024
    s_add_u32 s23, s23, 15360
    buffer_load_dwordx4 v6, s[12:15], s23 offen  lds
    s_add_u32 m0, m0, 1024
    s_add_u32 s23, s23, 15360
    buffer_load_dwordx4 v6, s[12:15], s23 offen  lds
    s_add_u32 m0, m0, 1024
    s_add_u32 s23, s23, 15360
    buffer_load_dwordx4 v6, s[12:15], s23 offen  lds
    s_add_u32 s36, s36, 1
    s_cmp_eq_u32 s36, 10
    s_cselect_b32 s23, 2457600, 0
    s_cselect_b32 s36, 0, s36
    s_add_u32 s30, s30, 245760
    s_sub_u32 s30, s30, s23
    s_waitcnt vmcnt(8) lgkmcnt(0)
    s_barrier
    s_add_u32 m0, s31, 65536
    s_mov_b32 s23, s29
    buffer_load_dwordx4 v4, s[8:11], s23 offen  lds
    s_add_u32 m0, m0, 1024
    s_add_u32 s23, s23, 10240
    buffer_load_dwordx4 v5, s[8:11], s23 offen  lds
    s_add_u32 m0, m0, 1024
    s_add_u32 s23, s23, 10240
    buffer_load_dwordx4 v4, s[8:11], s23 offen  lds
    s_add_u32 m0, m0, 1024
    s_add_u32 s23, s23, 10240
    buffer_load_dwordx4 v5, s[8:11], s23 offen  lds
    s_add_u32 s35, s35, 1
    s_cmp_eq_u32 s35, 10
    s_cselect_b32 s23, 1280, 0
    s_cselect_b32 s35, 0, s35
    s_add_u32 s29, s29, 128
    s_sub_u32 s29, s29, s23
    s_add_u32 m0, s31, 81920
    s_mov_b32 s23, s30
    buffer_load_dwordx4 v6, s[12:15], s23 offen  lds
    s_add_u32 m0, m0, 1024
    s_add_u32 s23, s23, 15360
    buffer_load_dwordx4 v6, s[12:15], s23 offen  lds
    s_add_u32 m0, m0, 1024
    s_add_u32 s23, s23, 15360
    buffer_load_dwordx4 v6, s[12:15], s23 offen  lds
    s_add_u32 m0, m0, 1024
    s_add_u32 s23, s23, 15360
    buffer_load_dwordx4 v6, s[12:15], s23 offen  lds
    s_add_u32 s36, s36, 1
    s_cmp_eq_u32 s36, 10
    s_cselect_b32 s23, 2457600, 0
    s_cselect_b32 s36, 0, s36
    s_add_u32 s30, s30, 245760
    s_sub_u32 s30, s30, s23
    s_waitcnt vmcnt(8) lgkmcnt(0)
    s_barrier
    s_cmp_eq_u32 s100, 7
    s_cbranch_scc0 L_wo_5
    s_mov_b32 s101, 0
    s_branch L_dbgc_8
L_dbgp_6:
    s_waitcnt vmcnt(0)
L_dbgc_8:
    v_readfirstlane_b32 s75, v70
    s_cmp_lg_u32 s75, 0
    s_cbranch_scc1 L_dbgok_7
    s_add_u32 s101, s101, 1
    s_cmp_gt_u32 s101, 262144
    s_cbranch_scc1 L_dbgok_7
    s_sleep 1
    buffer_load_dword v70, v71, s[44:47], 0 offen sc1
    s_branch L_dbgp_6
L_dbgok_7:
    s_getreg_b32 s72, hwreg(HW_REG_XCC_ID)
    s_and_b32 s72, s72, 7
    s_add_u32 s76, s72, 0
    s_lshl_b32 s76, s76, 7
    s_add_u32 s76, s76, 23814144
    v_mov_b32 v69, s76
    v_accvgpr_write_b32 a0, 1
    s_mov_b64 exec, 1
    s_nop 1
    buffer_atomic_add a0, v69, s[80:83], 0 offen sc0
    s_mov_b64 exec, -1
L_wo_5:
    s_add_u32 m0, s31, 98304
    s_mov_b32 s23, s29
    buffer_load_dwordx4 v4, s[8:11], s23 offen  lds
    s_add_u32 m0, m0, 1024
    s_add_u32 s23, s23, 10240
    buffer_load_dwordx4 v5, s[8:11], s23 offen  lds
    s_add_u32 m0, m0, 1024
    s_add_u32 s23, s23, 10240
    buffer_load_dwordx4 v4, s[8:11], s23 offen  lds
    s_add_u32 m0, m0, 1024
    s_add_u32 s23, s23, 10240
    buffer_load_dwordx4 v5, s[8:11], s23 offen  lds
    s_add_u32 s35, s35, 1
    s_cmp_eq_u32 s35, 10
    s_cselect_b32 s23, 1280, 0
    s_cselect_b32 s35, 0, s35
    s_add_u32 s29, s29, 128
    s_sub_u32 s29, s29, s23
    s_add_u32 m0, s31, 114688
    s_mov_b32 s23, s30
    buffer_load_dwordx4 v6, s[12:15], s23 offen  lds
    s_add_u32 m0, m0, 1024
    s_add_u32 s23, s23, 15360
    buffer_load_dwordx4 v6, s[12:15], s23 offen  lds
    s_add_u32 m0, m0, 1024
    s_add_u32 s23, s23, 15360
    buffer_load_dwordx4 v6, s[12:15], s23 offen  lds
    s_add_u32 m0, m0, 1024
    s_add_u32 s23, s23, 15360
    buffer_load_dwordx4 v6, s[12:15], s23 offen  lds
    s_add_u32 s36, s36, 1
    s_cmp_eq_u32 s36, 10
    s_cselect_b32 s23, 2457600, 0
    s_cselect_b32 s36, 0, s36
    s_add_u32 s30, s30, 245760
    s_sub_u32 s30, s30, s23
    s_waitcnt vmcnt(8) lgkmcnt(0)
    s_barrier
    s_add_u32 m0, s31, 0
    s_mov_b32 s23, s29
    buffer_load_dwordx4 v4, s[8:11], s23 offen  lds
    s_add_u32 m0, m0, 1024
    s_add_u32 s23, s23, 10240
    buffer_load_dwordx4 v5, s[8:11], s23 offen  lds
    s_add_u32 m0, m0, 1024
    s_add_u32 s23, s23, 10240
    buffer_load_dwordx4 v4, s[8:11], s23 offen  lds
    s_add_u32 m0, m0, 1024
    s_add_u32 s23, s23, 10240
    buffer_load_dwordx4 v5, s[8:11], s23 offen  lds
    s_add_u32 s35, s35, 1
    s_cmp_eq_u32 s35, 10
    s_cselect_b32 s23, 1280, 0
    s_cselect_b32 s35, 0, s35
    s_add_u32 s29, s29, 128
    s_sub_u32 s29, s29, s23
    s_add_u32 m0, s31, 16384
    s_mov_b32 s23, s30
    buffer_load_dwordx4 v6, s[12:15], s23 offen  lds
    s_add_u32 m0, m0, 1024
    s_add_u32 s23, s23, 15360
    buffer_load_dwordx4 v6, s[12:15], s23 offen  lds
    s_add_u32 m0, m0, 1024
    s_add_u32 s23, s23, 15360
    buffer_load_dwordx4 v6, s[12:15], s23 offen  lds
    s_add_u32 m0, m0, 1024
    s_add_u32 s23, s23, 15360
    buffer_load_dwordx4 v6, s[12:15], s23 offen  lds
    s_add_u32 s36, s36, 1
    s_cmp_eq_u32 s36, 10
    s_cselect_b32 s23, 2457600, 0
    s_cselect_b32 s36, 0, s36
    s_add_u32 s30, s30, 245760
    s_sub_u32 s30, s30, s23
    s_lshr_b32 s24, s21, 7
    s_add_u32 s24, s24, 64
    s_lshl_b32 s24, s24, 7
    s_add_u32 s24, s24, 23814144
    v_mov_b32 v16, s24
    v_mov_b32 v17, 1
    s_mov_b64 exec, 1
    buffer_load_dword v18, v16, s[80:83], 0 offen sc1
    s_mov_b64 exec, -1
    s_waitcnt vmcnt(9) lgkmcnt(0)
    s_barrier
    s_cmp_eq_u32 s100, 7
    s_cbranch_scc0 L_wo_9
    v_accvgpr_read_b32 v69, a0
    s_nop 1
    v_readfirstlane_b32 s73, v69
    s_cmp_eq_u32 s73, 31
    s_cbranch_scc0 L_r3a_10
    v_mov_b32 v69, 4
    v_mov_b32 v68, 1
    s_mov_b64 exec, 1
    buffer_atomic_add v68, v69, s[44:47], 0 offen sc1
    s_mov_b64 exec, -1
L_r3a_10:
    s_cmp_ge_u32 s73, 32
    s_cbranch_scc0 L_r3b_11
    v_mov_b32 v69, 8
    v_mov_b32 v68, 1
    s_mov_b64 exec, 1
    buffer_store_dword v68, v69, s[44:47], 0 offen sc1
    s_mov_b64 exec, -1
L_r3b_11:
    s_mov_b64 exec, 7
    buffer_load_dword v70, v71, s[44:47], 0 offen sc1
    s_mov_b64 exec, -1
L_wo_9:
    s_add_u32 m0, s31, 32768
    s_mov_b32 s23, s29
    buffer_load_dwordx4 v4, s[8:11], s23 offen  lds
    s_add_u32 m0, m0, 1024
    s_add_u32 s23, s23, 10240
    buffer_load_dwordx4 v5, s[8:11], s23 offen  lds
    s_add_u32 m0, m0, 1024
    s_add_u32 s23, s23, 10240
    buffer_load_dwordx4 v4, s[8:11], s23 offen  lds
    s_add_u32 m0, m0, 1024
    s_add_u32 s23, s23, 10240
    buffer_load_dwordx4 v5, s[8:11], s23 offen  lds
    s_add_u32 s35, s35, 1
    s_cmp_eq_u32 s35, 10
    s_cselect_b32 s23, 1280, 0
    s_cselect_b32 s35, 0, s35
    s_add_u32 s29, s29, 128
    s_sub_u32 s29, s29, s23
    s_add_u32 m0, s31, 49152
    s_mov_b32 s23, s30
    buffer_load_dwordx4 v6, s[12:15], s23 offen  lds
    s_add_u32 m0, m0, 1024
    s_add_u32 s23, s23, 15360
    buffer_load_dwordx4 v6, s[12:15], s23 offen  lds
    s_add_u32 m0, m0, 1024
    s_add_u32 s23, s23, 15360
    buffer_load_dwordx4 v6, s[12:15], s23 offen  lds
    s_add_u32 m0, m0, 1024
    s_add_u32 s23, s23, 15360
    buffer_load_dwordx4 v6, s[12:15], s23 offen  lds
    s_add_u32 s36, s36, 1
    s_cmp_eq_u32 s36, 10
    s_cselect_b32 s23, 2457600, 0
    s_cselect_b32 s36, 0, s36
    s_add_u32 s30, s30, 245760
    s_sub_u32 s30, s30, s23
    s_waitcnt vmcnt(8)
    v_readfirstlane_b32 s23, v18
    s_cmp_ge_u32 s23, 1
    s_cbranch_scc1 L_lok_12
    s_mov_b64 exec, 0x1
    s_mov_b32 s101, 0
L_poll_13:
    buffer_load_dword v18, v16, s[80:83], 0 offen sc1
    s_waitcnt vmcnt(0)
    v_cmp_gt_u32 vcc, v17, v18
    s_nop 4
    s_cmp_eq_u64 vcc, 0
    s_cbranch_scc1 L_pollok_14
    s_add_u32 s101, s101, 1
    s_cmp_gt_u32 s101, 262144
    s_cbranch_scc1 L_pollok_14
    s_sleep 1
    s_branch L_poll_13
L_pollok_14:
    s_mov_b64 exec, -1
L_lok_12:
    v_and_b32 v20, 31, v1
    v_lshlrev_b32 v21, 2, v20
    v_lshlrev_b32 v20, 3, v20
    s_lshl_b32 s23, s20, 5
    s_add_u32 s24, s23, s21
    s_lshl_b32 s24, s24, 3
    s_add_u32 s24, s24, 20185088
    buffer_load_dwordx2 v[24:25], v20, s[80:83], s24 offen
    s_waitcnt vmcnt(10) lgkmcnt(0)
    s_barrier
    s_waitcnt vmcnt(1) lgkmcnt(0)
    s_barrier
    s_waitcnt vmcnt(0)
    s_lshl_b32 s23, s20, 7
    s_add_u32 s23, s23, 145408
    v_add_u32 v21, s23, v21
    ds_write_b32 v21, v24
    ds_write_b32 v21, v25 offset:512
    s_waitcnt lgkmcnt(0)
    s_barrier
    v_and_b32 v120, 31, v1
    v_mov_b32 v124, 0
    v_mov_b32 v123, 0x3f803f80
    v_cmp_eq_u32 vcc, 20, v120
    s_sub_u32 s75, s100, 4
    s_mul_i32 s75, s75, 4096
    s_add_u32 s75, s75, 12288
    v_cndmask_b32 v124, v124, v123, vcc
    v_lshlrev_b32 v123, 4, v1
    v_add_u32 v123, s75, v123
    v_mov_b32 v125, v124
    v_mov_b32 v126, v124
    v_mov_b32 v127, v124
    s_mov_b32 exec_lo, 0xfff00000
    s_mov_b32 exec_hi, 0xfff00000
    ds_write_b128 v123, v[124:127] offset:0
    ds_write_b128 v123, v[124:127] offset:1024
    ds_write_b128 v123, v[124:127] offset:2048
    ds_write_b128 v123, v[124:127] offset:3072
    ds_write_b128 v123, v[124:127] offset:28672
    ds_write_b128 v123, v[124:127] offset:29696
    ds_write_b128 v123, v[124:127] offset:30720
    ds_write_b128 v123, v[124:127] offset:31744
    ds_write_b128 v123, v[124:127] offset:57344
    ds_write_b128 v123, v[124:127] offset:58368
    ds_write_b128 v123, v[124:127] offset:59392
    ds_write_b128 v123, v[124:127] offset:60416
    v_add_u32 v123, 86016, v123
    ds_write_b128 v123, v[124:127] offset:0
    ds_write_b128 v123, v[124:127] offset:1024
    ds_write_b128 v123, v[124:127] offset:2048
    ds_write_b128 v123, v[124:127] offset:3072
    ds_write_b128 v123, v[124:127] offset:28672
    ds_write_b128 v123, v[124:127] offset:29696
    ds_write_b128 v123, v[124:127] offset:30720
    ds_write_b128 v123, v[124:127] offset:31744
    s_mov_b64 exec, -1
    v_mov_b32 v123, 143360
    v_mov_b32 v124, 0
    ds_write_b32 v123, v124
    s_waitcnt lgkmcnt(0)
    s_barrier
    s_cmp_eq_u32 s100, 7
    s_cbranch_scc0 L_wo_15
    s_mov_b32 s101, 0
L_rp_16:
    s_waitcnt vmcnt(0)
    v_readlane_b32 s39, v70, 1
    v_readlane_b32 s40, v70, 2
    s_cmp_eq_u32 s39, 8
    s_cselect_b32 s38, 1, 0
    s_cmp_lg_u32 s40, 0
    s_cselect_b32 s38, 0, s38
    s_cbranch_scc1 L_rpok_17
    s_cmp_eq_u32 s38, 1
    s_cbranch_scc1 L_rpok_17
    s_add_u32 s101, s101, 1
    s_cmp_gt_u32 s101, 262144
    s_cbranch_scc1 L_rpok_17
    s_sleep 1
    s_mov_b64 exec, 7
    buffer_load_dword v70, v71, s[44:47], 0 offen sc1
    s_mov_b64 exec, -1
    s_branch L_rp_16
L_rpok_17:
    v_mov_b32 v64, s72
    v_mov_b32 v66, s38
    v_mov_b32 v65, s73
    v_mov_b32 v63, 149440
    ds_write_b96 v63, v[64:66]
    s_waitcnt lgkmcnt(0)
L_wo_15:
    s_branch L_attn
L_q_compute:
    s_lshr_b32 s32, s100, 1
    s_and_b32 s33, s100, 1
    v_and_b32 v2, 31, v1
    v_lshrrev_b32 v3, 5, v1
    v_lshrrev_b32 v128, 1, v1
    v_and_b32 v128, 7, v128
    v_xor_b32 v128, v128, v3
    v_lshlrev_b32 v128, 4, v128
    v_lshlrev_b32 v129, 7, v2
    v_add_u32 v128, v128, v129
    s_lshl_b32 s23, s32, 13
    s_lshl_b32 s24, s33, 12
    s_add_u32 s23, s23, s24
    v_add_u32 v128, s23, v128
    v_xor_b32 v4, 0, v128
    v_xor_b32 v8, 4096, v4
    v_xor_b32 v5, 32, v128
    v_xor_b32 v9, 4096, v5
    v_xor_b32 v6, 64, v128
    v_xor_b32 v10, 4096, v6
    v_xor_b32 v7, 96, v128
    v_xor_b32 v11, 4096, v7
    v_add_u32 v12, 65536, v4
    v_add_u32 v13, 65536, v5
    v_add_u32 v14, 65536, v6
    v_add_u32 v15, 65536, v7
    v_add_u32 v16, 65536, v8
    v_add_u32 v17, 65536, v9
    v_add_u32 v18, 65536, v10
    v_add_u32 v19, 65536, v11
    v_lshrrev_b32 v128, 2, v1
    v_and_b32 v128, 3, v128
    v_lshlrev_b32 v129, 3, v3
    v_add_u32 v129, v129, v128
    v_lshlrev_b32 v129, 8, v129
    v_lshlrev_b32 v128, 6, v128
    v_add_u32 v129, v129, v128
    v_lshrrev_b32 v128, 4, v1
    v_and_b32 v128, 1, v128
    v_lshlrev_b32 v128, 5, v128
    v_add_u32 v129, v129, v128
    v_lshrrev_b32 v128, 1, v1
    v_and_b32 v128, 1, v128
    v_lshlrev_b32 v128, 4, v128
    v_add_u32 v129, v129, v128
    v_and_b32 v128, 1, v1
    v_lshlrev_b32 v128, 3, v128
    v_add_u32 v129, v129, v128
    v_add_u32 v129, 16384, v129
    s_lshl_b32 s23, s33, 7
    s_lshl_b32 s24, s32, 6
    s_add_u32 s23, s23, s24
    v_xor_b32 v20, s23, v129
    v_xor_b32 v21, 64, v20
    v_add_u32 v22, 65536, v20
    v_add_u32 v23, 65536, v21
    s_mov_b32 s44, s98
    s_mov_b32 s45, s99
    s_and_b32 s45, s45, 0xffff
    s_mov_b32 s46, 0x100
    s_mov_b32 s47, 0x20000
    v_lshlrev_b32 v171, 2, v1
    v_mov_b32 v170, 0
    s_cmp_ge_u32 s34, 10
    s_cbranch_scc1 L_q_vpath
    s_cmp_lt_u32 s34, 5
    s_cselect_b32 s23, 0, 640
    s_sub_u32 s25, s22, s23
    s_lshl_b32 s24, s33, 6
    s_add_u32 s25, s25, s24
    s_lshr_b32 s25, s25, 3
    v_add_u32 v128, s25, v3
    v_lshlrev_b32 v132, 4, v2
    s_xor_b32 s26, s32, 0
    s_lshl_b32 s26, s26, 2
    s_add_u32 s26, s26, 0
    v_add_u32 v129, s26, v128
    v_mul_u32_u24 v130, 0xcccd, v129
    v_lshrrev_b32 v130, 18, v130
    v_mul_u32_u24 v131, 5, v130
    v_sub_u32 v131, v129, v131
    v_lshlrev_b32 v131, 9, v131
    v_mul_u32_u24 v130, 0x28000, v130
    v_add3_u32 v24, v130, v131, v132
    s_xor_b32 s26, s32, 0
    s_lshl_b32 s26, s26, 2
    s_add_u32 s26, s26, 2
    v_add_u32 v129, s26, v128
    v_mul_u32_u24 v130, 0xcccd, v129
    v_lshrrev_b32 v130, 18, v130
    v_mul_u32_u24 v131, 5, v130
    v_sub_u32 v131, v129, v131
    v_lshlrev_b32 v131, 9, v131
    v_mul_u32_u24 v130, 0x28000, v130
    v_add3_u32 v25, v130, v131, v132
    s_xor_b32 s26, s32, 1
    s_lshl_b32 s26, s26, 2
    s_add_u32 s26, s26, 0
    v_add_u32 v129, s26, v128
    v_mul_u32_u24 v130, 0xcccd, v129
    v_lshrrev_b32 v130, 18, v130
    v_mul_u32_u24 v131, 5, v130
    v_sub_u32 v131, v129, v131
    v_lshlrev_b32 v131, 9, v131
    v_mul_u32_u24 v130, 0x28000, v130
    v_add3_u32 v26, v130, v131, v132
    s_xor_b32 s26, s32, 1
    s_lshl_b32 s26, s26, 2
    s_add_u32 s26, s26, 2
    v_add_u32 v129, s26, v128
    v_mul_u32_u24 v130, 0xcccd, v129
    v_lshrrev_b32 v130, 18, v130
    v_mul_u32_u24 v131, 5, v130
    v_sub_u32 v131, v129, v131
    v_lshlrev_b32 v131, 9, v131
    v_mul_u32_u24 v130, 0x28000, v130
    v_add3_u32 v27, v130, v131, v132
    s_lshr_b32 s23, s21, 5
    s_lshl_b32 s24, s32, 1
    s_add_u32 s23, s23, s24
    s_add_u32 s24, s23, s33
    s_mul_i32 s40, s24, 2560
    s_xor_b32 s24, s33, 1
    s_add_u32 s24, s23, s24
    s_mul_i32 s41, s24, 2560
    s_cmp_lt_u32 s34, 5
    s_cselect_b32 s23, 0, 2621440
    s_add_u32 s16, s78, s23
    s_addc_u32 s17, s79, 0
    s_and_b32 s17, s17, 0xffff
    s_mov_b32 s18, 2621440
    s_mov_b32 s19, 0x20000
    v_mov_b32 v144, 0
    v_mov_b32 v145, 0
    s_barrier
    ds_read_b128 a[4:7], v4 offset:0
    ds_read_b128 a[8:11], v8 offset:0
    ds_read_b64_tr_b16 v[32:33], v20 offset:0
    ds_read_b64_tr_b16 v[34:35], v20 offset:1024
    ds_read_b64_tr_b16 v[36:37], v21 offset:0
    ds_read_b64_tr_b16 v[38:39], v21 offset:1024
    ds_read_b128 a[12:15], v5 offset:0
    ds_read_b128 a[16:19], v9 offset:0
    ds_read_b64_tr_b16 v[40:41], v20 offset:4096
    ds_read_b64_tr_b16 v[42:43], v20 offset:5120
    ds_read_b64_tr_b16 v[44:45], v21 offset:4096
    ds_read_b64_tr_b16 v[46:47], v21 offset:5120
    s_waitcnt lgkmcnt(6)
    v_mfma_f32_32x32x16_bf16 v[64:79], v[32:35], a[4:7], 0
    ds_read_b128 a[20:23], v6 offset:0
    ds_read_b128 a[24:27], v10 offset:0
    v_lshlrev_b32 v128, 16, v32
    v_and_b32 v129, 0xffff0000, v32
    v_add_f32 v144, v144, v128
    v_mfma_f32_32x32x16_bf16 v[80:95], v[32:35], a[8:11], 0
    ds_read_b64_tr_b16 v[48:49], v20 offset:8192
    ds_read_b64_tr_b16 v[50:51], v20 offset:9216
    v_add_f32 v145, v145, v129
    v_lshlrev_b32 v130, 16, v33
    v_and_b32 v131, 0xffff0000, v33
    v_mfma_f32_32x32x16_bf16 v[96:111], v[36:39], a[4:7], 0
    ds_read_b64_tr_b16 v[52:53], v21 offset:8192
    ds_read_b64_tr_b16 v[54:55], v21 offset:9216
    v_add_f32 v144, v144, v130
    v_add_f32 v145, v145, v131
    v_lshlrev_b32 v128, 16, v34
    v_and_b32 v129, 0xffff0000, v34
    v_mfma_f32_32x32x16_bf16 v[112:127], v[36:39], a[8:11], 0
    v_add_f32 v144, v144, v128
    v_add_f32 v145, v145, v129
    v_lshlrev_b32 v130, 16, v35
    v_and_b32 v131, 0xffff0000, v35
    v_add_f32 v144, v144, v130
    v_add_f32 v145, v145, v131
    s_waitcnt lgkmcnt(6)
    v_mfma_f32_32x32x16_bf16 v[64:79], v[40:43], a[12:15], v[64:79]
    ds_read_b128 a[4:7], v7 offset:0
    ds_read_b128 a[8:11], v11 offset:0
    v_lshlrev_b32 v128, 16, v40
    v_and_b32 v129, 0xffff0000, v40
    v_add_f32 v144, v144, v128
    v_mfma_f32_32x32x16_bf16 v[80:95], v[40:43], a[16:19], v[80:95]
    ds_read_b64_tr_b16 v[32:33], v20 offset:12288
    ds_read_b64_tr_b16 v[34:35], v20 offset:13312
    v_add_f32 v145, v145, v129
    v_lshlrev_b32 v130, 16, v41
    v_and_b32 v131, 0xffff0000, v41
    v_mfma_f32_32x32x16_bf16 v[96:111], v[44:47], a[12:15], v[96:111]
    ds_read_b64_tr_b16 v[36:37], v21 offset:12288
    ds_read_b64_tr_b16 v[38:39], v21 offset:13312
    v_add_f32 v144, v144, v130
    v_add_f32 v145, v145, v131
    v_lshlrev_b32 v128, 16, v42
    v_and_b32 v129, 0xffff0000, v42
    v_mfma_f32_32x32x16_bf16 v[112:127], v[44:47], a[16:19], v[112:127]
    v_add_f32 v144, v144, v128
    v_add_f32 v145, v145, v129
    v_lshlrev_b32 v130, 16, v43
    v_and_b32 v131, 0xffff0000, v43
    v_add_f32 v144, v144, v130
    v_add_f32 v145, v145, v131
    s_waitcnt lgkmcnt(6)
    v_mfma_f32_32x32x16_bf16 v[64:79], v[48:51], a[20:23], v[64:79]
    s_barrier
    ds_read_b128 a[12:15], v4 offset:32768
    ds_read_b128 a[16:19], v8 offset:32768
    v_lshlrev_b32 v128, 16, v48
    v_and_b32 v129, 0xffff0000, v48
    v_add_f32 v144, v144, v128
    v_mfma_f32_32x32x16_bf16 v[80:95], v[48:51], a[24:27], v[80:95]
    ds_read_b64_tr_b16 v[40:41], v20 offset:32768
    ds_read_b64_tr_b16 v[42:43], v20 offset:33792
    v_add_f32 v145, v145, v129
    v_lshlrev_b32 v130, 16, v49
    v_and_b32 v131, 0xffff0000, v49
    s_cmp_eq_u32 s100, 3
    s_cbranch_scc0 L_wo_18
    s_lshr_b32 s75, s2, 3
    v_lshlrev_b32 v166, 5, v1
    v_add_u32 v166, s75, v166
    v_lshlrev_b32 v166, 21, v166
    s_mov_b64 exec, 0x1
    buffer_load_dword v167, v166, s[80:83], 0 offen sc1
    s_mov_b64 exec, 3
    s_mov_b32 s8, s92
    s_mov_b32 s9, s93
    s_and_b32 s9, s9, 0xffff
    s_mov_b32 s10, 0x21c000
    s_mov_b32 s11, 0x20000
    buffer_load_dword v167, v166, s[8:11], 0 offen sc1
    s_mov_b32 s8, s94
    s_mov_b32 s9, s95
    s_and_b32 s9, s9, 0xffff
    s_mov_b32 s10, 0x21c000
    s_mov_b32 s11, 0x20000
    buffer_load_dword v167, v166, s[8:11], 0 offen sc1
    s_mov_b32 s8, s88
    s_mov_b32 s9, s89
    s_and_b32 s9, s9, 0xffff
    s_mov_b32 s10, 0xc8000
    s_mov_b32 s11, 0x20000
    buffer_load_dword v167, v166, s[8:11], 0 offen sc1
    s_mov_b32 s8, s96
    s_mov_b32 s9, s97
    s_and_b32 s9, s9, 0xffff
    s_mov_b32 s10, 0x280000
    s_mov_b32 s11, 0x20000
    buffer_load_dword v167, v166, s[8:11], 0 offen sc1
    s_mov_b64 exec, -1
L_wo_18:
    v_mfma_f32_32x32x16_bf16 v[96:111], v[52:55], a[20:23], v[96:111]
    ds_read_b64_tr_b16 v[44:45], v21 offset:32768
    ds_read_b64_tr_b16 v[46:47], v21 offset:33792
    v_add_f32 v144, v144, v130
    v_add_f32 v145, v145, v131
    v_lshlrev_b32 v128, 16, v50
    v_and_b32 v129, 0xffff0000, v50
    v_mfma_f32_32x32x16_bf16 v[112:127], v[52:55], a[24:27], v[112:127]
    v_add_f32 v144, v144, v128
    v_add_f32 v145, v145, v129
    v_lshlrev_b32 v130, 16, v51
    v_and_b32 v131, 0xffff0000, v51
    v_add_f32 v144, v144, v130
    v_add_f32 v145, v145, v131
    s_waitcnt lgkmcnt(6)
    v_mfma_f32_32x32x16_bf16 v[64:79], v[32:35], a[4:7], v[64:79]
    ds_read_b128 a[20:23], v5 offset:32768
    ds_read_b128 a[24:27], v9 offset:32768
    v_lshlrev_b32 v128, 16, v32
    v_and_b32 v129, 0xffff0000, v32
    v_add_f32 v144, v144, v128
    v_mfma_f32_32x32x16_bf16 v[80:95], v[32:35], a[8:11], v[80:95]
    ds_read_b64_tr_b16 v[48:49], v20 offset:36864
    ds_read_b64_tr_b16 v[50:51], v20 offset:37888
    v_add_f32 v145, v145, v129
    v_lshlrev_b32 v130, 16, v33
    v_and_b32 v131, 0xffff0000, v33
    v_mfma_f32_32x32x16_bf16 v[96:111], v[36:39], a[4:7], v[96:111]
    ds_read_b64_tr_b16 v[52:53], v21 offset:36864
    ds_read_b64_tr_b16 v[54:55], v21 offset:37888
    v_add_f32 v144, v144, v130
    v_add_f32 v145, v145, v131
    v_lshlrev_b32 v128, 16, v34
    v_and_b32 v129, 0xffff0000, v34
    v_mfma_f32_32x32x16_bf16 v[112:127], v[36:39], a[8:11], v[112:127]
    v_add_f32 v144, v144, v128
    v_add_f32 v145, v145, v129
    v_lshlrev_b32 v130, 16, v35
    v_and_b32 v131, 0xffff0000, v35
    v_add_f32 v144, v144, v130
    v_add_f32 v145, v145, v131
    s_waitcnt lgkmcnt(6)
    v_mfma_f32_32x32x16_bf16 v[64:79], v[40:43], a[12:15], v[64:79]
    ds_read_b128 a[4:7], v6 offset:32768
    ds_read_b128 a[8:11], v10 offset:32768
    v_lshlrev_b32 v128, 16, v40
    v_and_b32 v129, 0xffff0000, v40
    v_add_f32 v144, v144, v128
    v_mfma_f32_32x32x16_bf16 v[80:95], v[40:43], a[16:19], v[80:95]
    ds_read_b64_tr_b16 v[32:33], v20 offset:40960
    ds_read_b64_tr_b16 v[34:35], v20 offset:41984
    v_add_f32 v145, v145, v129
    v_lshlrev_b32 v130, 16, v41
    v_and_b32 v131, 0xffff0000, v41
    v_mfma_f32_32x32x16_bf16 v[96:111], v[44:47], a[12:15], v[96:111]
    ds_read_b64_tr_b16 v[36:37], v21 offset:40960
    ds_read_b64_tr_b16 v[38:39], v21 offset:41984
    v_add_f32 v144, v144, v130
    v_add_f32 v145, v145, v131
    v_lshlrev_b32 v128, 16, v42
    v_and_b32 v129, 0xffff0000, v42
    v_mfma_f32_32x32x16_bf16 v[112:127], v[44:47], a[16:19], v[112:127]
    v_add_f32 v144, v144, v128
    v_add_f32 v145, v145, v129
    v_lshlrev_b32 v130, 16, v43
    v_and_b32 v131, 0xffff0000, v43
    v_add_f32 v144, v144, v130
    v_add_f32 v145, v145, v131
    s_waitcnt lgkmcnt(6)
    v_mfma_f32_32x32x16_bf16 v[64:79], v[48:51], a[20:23], v[64:79]
    ds_read_b128 a[12:15], v7 offset:32768
    ds_read_b128 a[16:19], v11 offset:32768
    v_lshlrev_b32 v128, 16, v48
    v_and_b32 v129, 0xffff0000, v48
    v_add_f32 v144, v144, v128
    v_mfma_f32_32x32x16_bf16 v[80:95], v[48:51], a[24:27], v[80:95]
    ds_read_b64_tr_b16 v[40:41], v20 offset:45056
    ds_read_b64_tr_b16 v[42:43], v20 offset:46080
    v_add_f32 v145, v145, v129
    v_lshlrev_b32 v130, 16, v49
    v_and_b32 v131, 0xffff0000, v49
    v_mfma_f32_32x32x16_bf16 v[96:111], v[52:55], a[20:23], v[96:111]
    ds_read_b64_tr_b16 v[44:45], v21 offset:45056
    ds_read_b64_tr_b16 v[46:47], v21 offset:46080
    v_add_f32 v144, v144, v130
    v_add_f32 v145, v145, v131
    v_lshlrev_b32 v128, 16, v50
    v_and_b32 v129, 0xffff0000, v50
    v_mfma_f32_32x32x16_bf16 v[112:127], v[52:55], a[24:27], v[112:127]
    v_add_f32 v144, v144, v128
    v_add_f32 v145, v145, v129
    v_lshlrev_b32 v130, 16, v51
    v_and_b32 v131, 0xffff0000, v51
    v_add_f32 v144, v144, v130
    v_add_f32 v145, v145, v131
    s_waitcnt lgkmcnt(6)
    v_mfma_f32_32x32x16_bf16 v[64:79], v[32:35], a[4:7], v[64:79]
    s_barrier
    ds_read_b128 a[20:23], v12 offset:0
    ds_read_b128 a[24:27], v16 offset:0
    v_lshlrev_b32 v128, 16, v32
    v_and_b32 v129, 0xffff0000, v32
    v_add_f32 v144, v144, v128
    v_mfma_f32_32x32x16_bf16 v[80:95], v[32:35], a[8:11], v[80:95]
    ds_read_b64_tr_b16 v[48:49], v22 offset:0
    ds_read_b64_tr_b16 v[50:51], v22 offset:1024
    v_add_f32 v145, v145, v129
    v_lshlrev_b32 v130, 16, v33
    v_and_b32 v131, 0xffff0000, v33
    v_mfma_f32_32x32x16_bf16 v[96:111], v[36:39], a[4:7], v[96:111]
    ds_read_b64_tr_b16 v[52:53], v23 offset:0
    ds_read_b64_tr_b16 v[54:55], v23 offset:1024
    v_add_f32 v144, v144, v130
    v_add_f32 v145, v145, v131
    v_lshlrev_b32 v128, 16, v34
    v_and_b32 v129, 0xffff0000, v34
    v_mfma_f32_32x32x16_bf16 v[112:127], v[36:39], a[8:11], v[112:127]
    v_add_f32 v144, v144, v128
    v_add_f32 v145, v145, v129
    v_lshlrev_b32 v130, 16, v35
    v_and_b32 v131, 0xffff0000, v35
    v_add_f32 v144, v144, v130
    v_add_f32 v145, v145, v131
    s_waitcnt lgkmcnt(6)
    v_mfma_f32_32x32x16_bf16 v[64:79], v[40:43], a[12:15], v[64:79]
    ds_read_b128 a[4:7], v13 offset:0
    ds_read_b128 a[8:11], v17 offset:0
    v_lshlrev_b32 v128, 16, v40
    v_and_b32 v129, 0xffff0000, v40
    v_add_f32 v144, v144, v128
    v_mfma_f32_32x32x16_bf16 v[80:95], v[40:43], a[16:19], v[80:95]
    ds_read_b64_tr_b16 v[32:33], v22 offset:4096
    ds_read_b64_tr_b16 v[34:35], v22 offset:5120
    v_add_f32 v145, v145, v129
    v_lshlrev_b32 v130, 16, v41
    v_and_b32 v131, 0xffff0000, v41
    v_mfma_f32_32x32x16_bf16 v[96:111], v[44:47], a[12:15], v[96:111]
    ds_read_b64_tr_b16 v[36:37], v23 offset:4096
    ds_read_b64_tr_b16 v[38:39], v23 offset:5120
    v_add_f32 v144, v144, v130
    v_add_f32 v145, v145, v131
    v_lshlrev_b32 v128, 16, v42
    v_and_b32 v129, 0xffff0000, v42
    v_mfma_f32_32x32x16_bf16 v[112:127], v[44:47], a[16:19], v[112:127]
    v_add_f32 v144, v144, v128
    v_add_f32 v145, v145, v129
    v_lshlrev_b32 v130, 16, v43
    v_and_b32 v131, 0xffff0000, v43
    v_add_f32 v144, v144, v130
    v_add_f32 v145, v145, v131
    s_waitcnt lgkmcnt(6)
    v_mfma_f32_32x32x16_bf16 v[64:79], v[48:51], a[20:23], v[64:79]
    ds_read_b128 a[12:15], v14 offset:0
    ds_read_b128 a[16:19], v18 offset:0
    v_lshlrev_b32 v128, 16, v48
    v_and_b32 v129, 0xffff0000, v48
    v_add_f32 v144, v144, v128
    v_mfma_f32_32x32x16_bf16 v[80:95], v[48:51], a[24:27], v[80:95]
    ds_read_b64_tr_b16 v[40:41], v22 offset:8192
    ds_read_b64_tr_b16 v[42:43], v22 offset:9216
    v_add_f32 v145, v145, v129
    v_lshlrev_b32 v130, 16, v49
    v_and_b32 v131, 0xffff0000, v49
    v_mfma_f32_32x32x16_bf16 v[96:111], v[52:55], a[20:23], v[96:111]
    ds_read_b64_tr_b16 v[44:45], v23 offset:8192
    ds_read_b64_tr_b16 v[46:47], v23 offset:9216
    v_add_f32 v144, v144, v130
    v_add_f32 v145, v145, v131
    v_lshlrev_b32 v128, 16, v50
    v_and_b32 v129, 0xffff0000, v50
    v_mfma_f32_32x32x16_bf16 v[112:127], v[52:55], a[24:27], v[112:127]
    v_add_f32 v144, v144, v128
    v_add_f32 v145, v145, v129
    v_lshlrev_b32 v130, 16, v51
    v_and_b32 v131, 0xffff0000, v51
    v_add_f32 v144, v144, v130
    v_add_f32 v145, v145, v131
    s_waitcnt lgkmcnt(6)
    v_mfma_f32_32x32x16_bf16 v[64:79], v[32:35], a[4:7], v[64:79]
    ds_read_b128 a[20:23], v15 offset:0
    ds_read_b128 a[24:27], v19 offset:0
    v_lshlrev_b32 v128, 16, v32
    v_and_b32 v129, 0xffff0000, v32
    v_add_f32 v144, v144, v128
    v_mfma_f32_32x32x16_bf16 v[80:95], v[32:35], a[8:11], v[80:95]
    ds_read_b64_tr_b16 v[48:49], v22 offset:12288
    ds_read_b64_tr_b16 v[50:51], v22 offset:13312
    v_add_f32 v145, v145, v129
    v_lshlrev_b32 v130, 16, v33
    v_and_b32 v131, 0xffff0000, v33
    v_mfma_f32_32x32x16_bf16 v[96:111], v[36:39], a[4:7], v[96:111]
    ds_read_b64_tr_b16 v[52:53], v23 offset:12288
    ds_read_b64_tr_b16 v[54:55], v23 offset:13312
    v_add_f32 v144, v144, v130
    v_add_f32 v145, v145, v131
    v_lshlrev_b32 v128, 16, v34
    v_and_b32 v129, 0xffff0000, v34
    v_mfma_f32_32x32x16_bf16 v[112:127], v[36:39], a[8:11], v[112:127]
    v_add_f32 v144, v144, v128
    v_add_f32 v145, v145, v129
    v_lshlrev_b32 v130, 16, v35
    v_and_b32 v131, 0xffff0000, v35
    v_add_f32 v144, v144, v130
    v_add_f32 v145, v145, v131
    s_waitcnt lgkmcnt(6)
    v_mfma_f32_32x32x16_bf16 v[64:79], v[40:43], a[12:15], v[64:79]
    s_barrier
    ds_read_b128 a[4:7], v12 offset:32768
    ds_read_b128 a[8:11], v16 offset:32768
    v_lshlrev_b32 v128, 16, v40
    v_and_b32 v129, 0xffff0000, v40
    v_add_f32 v144, v144, v128
    v_mfma_f32_32x32x16_bf16 v[80:95], v[40:43], a[16:19], v[80:95]
    ds_read_b64_tr_b16 v[32:33], v22 offset:32768
    ds_read_b64_tr_b16 v[34:35], v22 offset:33792
    v_add_f32 v145, v145, v129
    v_lshlrev_b32 v130, 16, v41
    v_and_b32 v131, 0xffff0000, v41
    v_mfma_f32_32x32x16_bf16 v[96:111], v[44:47], a[12:15], v[96:111]
    ds_read_b64_tr_b16 v[36:37], v23 offset:32768
    ds_read_b64_tr_b16 v[38:39], v23 offset:33792
    v_add_f32 v144, v144, v130
    v_add_f32 v145, v145, v131
    v_lshlrev_b32 v128, 16, v42
    v_and_b32 v129, 0xffff0000, v42
    v_mfma_f32_32x32x16_bf16 v[112:127], v[44:47], a[16:19], v[112:127]
    v_add_f32 v144, v144, v128
    v_add_f32 v145, v145, v129
    v_lshlrev_b32 v130, 16, v43
    v_and_b32 v131, 0xffff0000, v43
    v_add_f32 v144, v144, v130
    v_add_f32 v145, v145, v131
    s_waitcnt lgkmcnt(6)
    v_mfma_f32_32x32x16_bf16 v[64:79], v[48:51], a[20:23], v[64:79]
    ds_read_b128 a[12:15], v13 offset:32768
    ds_read_b128 a[16:19], v17 offset:32768
    v_lshlrev_b32 v128, 16, v48
    v_and_b32 v129, 0xffff0000, v48
    v_add_f32 v144, v144, v128
    v_mfma_f32_32x32x16_bf16 v[80:95], v[48:51], a[24:27], v[80:95]
    ds_read_b64_tr_b16 v[40:41], v22 offset:36864
    ds_read_b64_tr_b16 v[42:43], v22 offset:37888
    v_add_f32 v145, v145, v129
    v_lshlrev_b32 v130, 16, v49
    v_and_b32 v131, 0xffff0000, v49
    v_mfma_f32_32x32x16_bf16 v[96:111], v[52:55], a[20:23], v[96:111]
    ds_read_b64_tr_b16 v[44:45], v23 offset:36864
    ds_read_b64_tr_b16 v[46:47], v23 offset:37888
    v_add_f32 v144, v144, v130
    v_add_f32 v145, v145, v131
    v_lshlrev_b32 v128, 16, v50
    v_and_b32 v129, 0xffff0000, v50
    v_mfma_f32_32x32x16_bf16 v[112:127], v[52:55], a[24:27], v[112:127]
    v_add_f32 v144, v144, v128
    v_add_f32 v145, v145, v129
    v_lshlrev_b32 v130, 16, v51
    v_and_b32 v131, 0xffff0000, v51
    v_add_f32 v144, v144, v130
    v_add_f32 v145, v145, v131
    s_waitcnt lgkmcnt(6)
    v_mfma_f32_32x32x16_bf16 v[64:79], v[32:35], a[4:7], v[64:79]
    ds_read_b128 a[20:23], v14 offset:32768
    ds_read_b128 a[24:27], v18 offset:32768
    v_lshlrev_b32 v128, 16, v32
    v_and_b32 v129, 0xffff0000, v32
    v_add_f32 v144, v144, v128
    v_mfma_f32_32x32x16_bf16 v[80:95], v[32:35], a[8:11], v[80:95]
    ds_read_b64_tr_b16 v[48:49], v22 offset:40960
    ds_read_b64_tr_b16 v[50:51], v22 offset:41984
    v_add_f32 v145, v145, v129
    v_lshlrev_b32 v130, 16, v33
    v_and_b32 v131, 0xffff0000, v33
    v_mfma_f32_32x32x16_bf16 v[96:111], v[36:39], a[4:7], v[96:111]
    ds_read_b64_tr_b16 v[52:53], v23 offset:40960
    ds_read_b64_tr_b16 v[54:55], v23 offset:41984
    v_add_f32 v144, v144, v130
    v_add_f32 v145, v145, v131
    v_lshlrev_b32 v128, 16, v34
    v_and_b32 v129, 0xffff0000, v34
    v_mfma_f32_32x32x16_bf16 v[112:127], v[36:39], a[8:11], v[112:127]
    v_add_f32 v144, v144, v128
    v_add_f32 v145, v145, v129
    v_lshlrev_b32 v130, 16, v35
    v_and_b32 v131, 0xffff0000, v35
    v_add_f32 v144, v144, v130
    v_add_f32 v145, v145, v131
    s_waitcnt lgkmcnt(6)
    v_mfma_f32_32x32x16_bf16 v[64:79], v[40:43], a[12:15], v[64:79]
    ds_read_b128 a[4:7], v15 offset:32768
    ds_read_b128 a[8:11], v19 offset:32768
    v_lshlrev_b32 v128, 16, v40
    v_and_b32 v129, 0xffff0000, v40
    v_add_f32 v144, v144, v128
    v_mfma_f32_32x32x16_bf16 v[80:95], v[40:43], a[16:19], v[80:95]
    ds_read_b64_tr_b16 v[32:33], v22 offset:45056
    ds_read_b64_tr_b16 v[34:35], v22 offset:46080
    v_add_f32 v145, v145, v129
    v_lshlrev_b32 v130, 16, v41
    v_and_b32 v131, 0xffff0000, v41
    v_mfma_f32_32x32x16_bf16 v[96:111], v[44:47], a[12:15], v[96:111]
    ds_read_b64_tr_b16 v[36:37], v23 offset:45056
    ds_read_b64_tr_b16 v[38:39], v23 offset:46080
    v_add_f32 v144, v144, v130
    v_add_f32 v145, v145, v131
    v_lshlrev_b32 v128, 16, v42
    v_and_b32 v129, 0xffff0000, v42
    v_mfma_f32_32x32x16_bf16 v[112:127], v[44:47], a[16:19], v[112:127]
    v_add_f32 v144, v144, v128
    v_add_f32 v145, v145, v129
    v_lshlrev_b32 v130, 16, v43
    v_and_b32 v131, 0xffff0000, v43
    v_add_f32 v144, v144, v130
    v_add_f32 v145, v145, v131
    s_waitcnt lgkmcnt(6)
    v_mfma_f32_32x32x16_bf16 v[64:79], v[48:51], a[20:23], v[64:79]
    s_barrier
    ds_read_b128 a[12:15], v4 offset:0
    ds_read_b128 a[16:19], v8 offset:0
    v_lshlrev_b32 v128, 16, v48
    v_and_b32 v129, 0xffff0000, v48
    v_add_f32 v144, v144, v128
    v_mfma_f32_32x32x16_bf16 v[80:95], v[48:51], a[24:27], v[80:95]
    ds_read_b64_tr_b16 v[40:41], v20 offset:0
    ds_read_b64_tr_b16 v[42:43], v20 offset:1024
    v_add_f32 v145, v145, v129
    v_lshlrev_b32 v130, 16, v49
    v_and_b32 v131, 0xffff0000, v49
    s_cmp_eq_u32 s100, 3
    s_cbranch_scc0 L_wo_19
    v_lshlrev_b32 v166, 21, v1
    s_mov_b64 exec, 0xfff
    buffer_load_dword v167, v166, s[80:83], 0 offen sc1
    s_mov_b64 exec, -1
L_wo_19:
    v_mfma_f32_32x32x16_bf16 v[96:111], v[52:55], a[20:23], v[96:111]
    ds_read_b64_tr_b16 v[44:45], v21 offset:0
    ds_read_b64_tr_b16 v[46:47], v21 offset:1024
    v_add_f32 v144, v144, v130
    v_add_f32 v145, v145, v131
    v_lshlrev_b32 v128, 16, v50
    v_and_b32 v129, 0xffff0000, v50
    v_mfma_f32_32x32x16_bf16 v[112:127], v[52:55], a[24:27], v[112:127]
    v_add_f32 v144, v144, v128
    v_add_f32 v145, v145, v129
    v_lshlrev_b32 v130, 16, v51
    v_and_b32 v131, 0xffff0000, v51
    v_add_f32 v144, v144, v130
    v_add_f32 v145, v145, v131
    s_waitcnt lgkmcnt(6)
    v_mfma_f32_32x32x16_bf16 v[64:79], v[32:35], a[4:7], v[64:79]
    ds_read_b128 a[20:23], v5 offset:0
    ds_read_b128 a[24:27], v9 offset:0
    v_lshlrev_b32 v128, 16, v32
    v_and_b32 v129, 0xffff0000, v32
    v_add_f32 v144, v144, v128
    v_mfma_f32_32x32x16_bf16 v[80:95], v[32:35], a[8:11], v[80:95]
    ds_read_b64_tr_b16 v[48:49], v20 offset:4096
    ds_read_b64_tr_b16 v[50:51], v20 offset:5120
    v_add_f32 v145, v145, v129
    v_lshlrev_b32 v130, 16, v33
    v_and_b32 v131, 0xffff0000, v33
    v_mfma_f32_32x32x16_bf16 v[96:111], v[36:39], a[4:7], v[96:111]
    ds_read_b64_tr_b16 v[52:53], v21 offset:4096
    ds_read_b64_tr_b16 v[54:55], v21 offset:5120
    v_add_f32 v144, v144, v130
    v_add_f32 v145, v145, v131
    v_lshlrev_b32 v128, 16, v34
    v_and_b32 v129, 0xffff0000, v34
    v_mfma_f32_32x32x16_bf16 v[112:127], v[36:39], a[8:11], v[112:127]
    v_add_f32 v144, v144, v128
    v_add_f32 v145, v145, v129
    v_lshlrev_b32 v130, 16, v35
    v_and_b32 v131, 0xffff0000, v35
    v_add_f32 v144, v144, v130
    v_add_f32 v145, v145, v131
    s_waitcnt lgkmcnt(6)
    v_mfma_f32_32x32x16_bf16 v[64:79], v[40:43], a[12:15], v[64:79]
    ds_read_b128 a[4:7], v6 offset:0
    ds_read_b128 a[8:11], v10 offset:0
    v_lshlrev_b32 v128, 16, v40
    v_and_b32 v129, 0xffff0000, v40
    v_add_f32 v144, v144, v128
    v_mfma_f32_32x32x16_bf16 v[80:95], v[40:43], a[16:19], v[80:95]
    ds_read_b64_tr_b16 v[32:33], v20 offset:8192
    ds_read_b64_tr_b16 v[34:35], v20 offset:9216
    v_add_f32 v145, v145, v129
    v_lshlrev_b32 v130, 16, v41
    v_and_b32 v131, 0xffff0000, v41
    v_mfma_f32_32x32x16_bf16 v[96:111], v[44:47], a[12:15], v[96:111]
    ds_read_b64_tr_b16 v[36:37], v21 offset:8192
    ds_read_b64_tr_b16 v[38:39], v21 offset:9216
    v_add_f32 v144, v144, v130
    v_add_f32 v145, v145, v131
    v_lshlrev_b32 v128, 16, v42
    v_and_b32 v129, 0xffff0000, v42
    v_mfma_f32_32x32x16_bf16 v[112:127], v[44:47], a[16:19], v[112:127]
    v_add_f32 v144, v144, v128
    v_add_f32 v145, v145, v129
    v_lshlrev_b32 v130, 16, v43
    v_and_b32 v131, 0xffff0000, v43
    v_add_f32 v144, v144, v130
    v_add_f32 v145, v145, v131
    s_waitcnt lgkmcnt(6)
    v_mfma_f32_32x32x16_bf16 v[64:79], v[48:51], a[20:23], v[64:79]
    ds_read_b128 a[12:15], v7 offset:0
    ds_read_b128 a[16:19], v11 offset:0
    v_lshlrev_b32 v128, 16, v48
    v_and_b32 v129, 0xffff0000, v48
    v_add_f32 v144, v144, v128
    v_mfma_f32_32x32x16_bf16 v[80:95], v[48:51], a[24:27], v[80:95]
    ds_read_b64_tr_b16 v[40:41], v20 offset:12288
    ds_read_b64_tr_b16 v[42:43], v20 offset:13312
    v_add_f32 v145, v145, v129
    v_lshlrev_b32 v130, 16, v49
    v_and_b32 v131, 0xffff0000, v49
    v_mfma_f32_32x32x16_bf16 v[96:111], v[52:55], a[20:23], v[96:111]
    ds_read_b64_tr_b16 v[44:45], v21 offset:12288
    ds_read_b64_tr_b16 v[46:47], v21 offset:13312
    v_add_f32 v144, v144, v130
    v_add_f32 v145, v145, v131
    v_lshlrev_b32 v128, 16, v50
    v_and_b32 v129, 0xffff0000, v50
    v_mfma_f32_32x32x16_bf16 v[112:127], v[52:55], a[24:27], v[112:127]
    v_add_f32 v144, v144, v128
    v_add_f32 v145, v145, v129
    v_lshlrev_b32 v130, 16, v51
    v_and_b32 v131, 0xffff0000, v51
    v_add_f32 v144, v144, v130
    v_add_f32 v145, v145, v131
    s_waitcnt lgkmcnt(6)
    v_mfma_f32_32x32x16_bf16 v[64:79], v[32:35], a[4:7], v[64:79]
    s_barrier
    ds_read_b128 a[20:23], v4 offset:32768
    ds_read_b128 a[24:27], v8 offset:32768
    v_lshlrev_b32 v128, 16, v32
    v_and_b32 v129, 0xffff0000, v32
    v_add_f32 v144, v144, v128
    v_mfma_f32_32x32x16_bf16 v[80:95], v[32:35], a[8:11], v[80:95]
    ds_read_b64_tr_b16 v[48:49], v20 offset:32768
    ds_read_b64_tr_b16 v[50:51], v20 offset:33792
    v_add_f32 v145, v145, v129
    v_lshlrev_b32 v130, 16, v33
    v_and_b32 v131, 0xffff0000, v33
    v_mfma_f32_32x32x16_bf16 v[96:111], v[36:39], a[4:7], v[96:111]
    ds_read_b64_tr_b16 v[52:53], v21 offset:32768
    ds_read_b64_tr_b16 v[54:55], v21 offset:33792
    v_add_f32 v144, v144, v130
    v_add_f32 v145, v145, v131
    v_lshlrev_b32 v128, 16, v34
    v_and_b32 v129, 0xffff0000, v34
    v_mfma_f32_32x32x16_bf16 v[112:127], v[36:39], a[8:11], v[112:127]
    v_add_f32 v144, v144, v128
    v_add_f32 v145, v145, v129
    v_lshlrev_b32 v130, 16, v35
    v_and_b32 v131, 0xffff0000, v35
    v_add_f32 v144, v144, v130
    v_add_f32 v145, v145, v131
    s_waitcnt lgkmcnt(6)
    v_mfma_f32_32x32x16_bf16 v[64:79], v[40:43], a[12:15], v[64:79]
    ds_read_b128 a[4:7], v5 offset:32768
    ds_read_b128 a[8:11], v9 offset:32768
    v_lshlrev_b32 v128, 16, v40
    v_and_b32 v129, 0xffff0000, v40
    v_add_f32 v144, v144, v128
    v_mfma_f32_32x32x16_bf16 v[80:95], v[40:43], a[16:19], v[80:95]
    ds_read_b64_tr_b16 v[32:33], v20 offset:36864
    ds_read_b64_tr_b16 v[34:35], v20 offset:37888
    v_add_f32 v145, v145, v129
    v_lshlrev_b32 v130, 16, v41
    v_and_b32 v131, 0xffff0000, v41
    v_mfma_f32_32x32x16_bf16 v[96:111], v[44:47], a[12:15], v[96:111]
    ds_read_b64_tr_b16 v[36:37], v21 offset:36864
    ds_read_b64_tr_b16 v[38:39], v21 offset:37888
    v_add_f32 v144, v144, v130
    v_add_f32 v145, v145, v131
    v_lshlrev_b32 v128, 16, v42
    v_and_b32 v129, 0xffff0000, v42
    v_mfma_f32_32x32x16_bf16 v[112:127], v[44:47], a[16:19], v[112:127]
    v_add_f32 v144, v144, v128
    v_add_f32 v145, v145, v129
    v_lshlrev_b32 v130, 16, v43
    v_and_b32 v131, 0xffff0000, v43
    v_add_f32 v144, v144, v130
    v_add_f32 v145, v145, v131
    s_waitcnt lgkmcnt(6)
    v_mfma_f32_32x32x16_bf16 v[64:79], v[48:51], a[20:23], v[64:79]
    ds_read_b128 a[12:15], v6 offset:32768
    ds_read_b128 a[16:19], v10 offset:32768
    v_lshlrev_b32 v128, 16, v48
    v_and_b32 v129, 0xffff0000, v48
    v_add_f32 v144, v144, v128
    v_mfma_f32_32x32x16_bf16 v[80:95], v[48:51], a[24:27], v[80:95]
    ds_read_b64_tr_b16 v[40:41], v20 offset:40960
    ds_read_b64_tr_b16 v[42:43], v20 offset:41984
    v_add_f32 v145, v145, v129
    v_lshlrev_b32 v130, 16, v49
    v_and_b32 v131, 0xffff0000, v49
    v_mfma_f32_32x32x16_bf16 v[96:111], v[52:55], a[20:23], v[96:111]
    ds_read_b64_tr_b16 v[44:45], v21 offset:40960
    ds_read_b64_tr_b16 v[46:47], v21 offset:41984
    v_add_f32 v144, v144, v130
    v_add_f32 v145, v145, v131
    v_lshlrev_b32 v128, 16, v50
    v_and_b32 v129, 0xffff0000, v50
    v_mfma_f32_32x32x16_bf16 v[112:127], v[52:55], a[24:27], v[112:127]
    v_add_f32 v144, v144, v128
    v_add_f32 v145, v145, v129
    v_lshlrev_b32 v130, 16, v51
    v_and_b32 v131, 0xffff0000, v51
    v_add_f32 v144, v144, v130
    v_add_f32 v145, v145, v131
    s_waitcnt lgkmcnt(6)
    v_mfma_f32_32x32x16_bf16 v[64:79], v[32:35], a[4:7], v[64:79]
    ds_read_b128 a[20:23], v7 offset:32768
    ds_read_b128 a[24:27], v11 offset:32768
    v_lshlrev_b32 v128, 16, v32
    v_and_b32 v129, 0xffff0000, v32
    v_add_f32 v144, v144, v128
    v_mfma_f32_32x32x16_bf16 v[80:95], v[32:35], a[8:11], v[80:95]
    ds_read_b64_tr_b16 v[48:49], v20 offset:45056
    ds_read_b64_tr_b16 v[50:51], v20 offset:46080
    v_add_f32 v145, v145, v129
    v_lshlrev_b32 v130, 16, v33
    v_and_b32 v131, 0xffff0000, v33
    v_mfma_f32_32x32x16_bf16 v[96:111], v[36:39], a[4:7], v[96:111]
    ds_read_b64_tr_b16 v[52:53], v21 offset:45056
    ds_read_b64_tr_b16 v[54:55], v21 offset:46080
    v_add_f32 v144, v144, v130
    v_add_f32 v145, v145, v131
    v_lshlrev_b32 v128, 16, v34
    v_and_b32 v129, 0xffff0000, v34
    v_mfma_f32_32x32x16_bf16 v[112:127], v[36:39], a[8:11], v[112:127]
    v_add_f32 v144, v144, v128
    v_add_f32 v145, v145, v129
    v_lshlrev_b32 v130, 16, v35
    v_and_b32 v131, 0xffff0000, v35
    v_add_f32 v144, v144, v130
    v_add_f32 v145, v145, v131
    s_waitcnt lgkmcnt(6)
    v_mfma_f32_32x32x16_bf16 v[64:79], v[40:43], a[12:15], v[64:79]
    s_barrier
    ds_read_b128 a[4:7], v12 offset:0
    ds_read_b128 a[8:11], v16 offset:0
    v_lshlrev_b32 v128, 16, v40
    v_and_b32 v129, 0xffff0000, v40
    v_add_f32 v144, v144, v128
    v_mfma_f32_32x32x16_bf16 v[80:95], v[40:43], a[16:19], v[80:95]
    ds_read_b64_tr_b16 v[32:33], v22 offset:0
    ds_read_b64_tr_b16 v[34:35], v22 offset:1024
    v_add_f32 v145, v145, v129
    v_lshlrev_b32 v130, 16, v41
    v_and_b32 v131, 0xffff0000, v41
    v_mfma_f32_32x32x16_bf16 v[96:111], v[44:47], a[12:15], v[96:111]
    ds_read_b64_tr_b16 v[36:37], v23 offset:0
    ds_read_b64_tr_b16 v[38:39], v23 offset:1024
    v_add_f32 v144, v144, v130
    v_add_f32 v145, v145, v131
    v_lshlrev_b32 v128, 16, v42
    v_and_b32 v129, 0xffff0000, v42
    v_mfma_f32_32x32x16_bf16 v[112:127], v[44:47], a[16:19], v[112:127]
    v_add_f32 v144, v144, v128
    v_add_f32 v145, v145, v129
    v_lshlrev_b32 v130, 16, v43
    v_and_b32 v131, 0xffff0000, v43
    v_add_f32 v144, v144, v130
    v_add_f32 v145, v145, v131
    s_waitcnt lgkmcnt(6)
    v_mfma_f32_32x32x16_bf16 v[64:79], v[48:51], a[20:23], v[64:79]
    ds_read_b128 a[12:15], v13 offset:0
    ds_read_b128 a[16:19], v17 offset:0
    v_lshlrev_b32 v128, 16, v48
    v_and_b32 v129, 0xffff0000, v48
    v_add_f32 v144, v144, v128
    v_mfma_f32_32x32x16_bf16 v[80:95], v[48:51], a[24:27], v[80:95]
    ds_read_b64_tr_b16 v[40:41], v22 offset:4096
    ds_read_b64_tr_b16 v[42:43], v22 offset:5120
    v_add_f32 v145, v145, v129
    v_lshlrev_b32 v130, 16, v49
    v_and_b32 v131, 0xffff0000, v49
    v_mfma_f32_32x32x16_bf16 v[96:111], v[52:55], a[20:23], v[96:111]
    ds_read_b64_tr_b16 v[44:45], v23 offset:4096
    ds_read_b64_tr_b16 v[46:47], v23 offset:5120
    v_add_f32 v144, v144, v130
    v_add_f32 v145, v145, v131
    v_lshlrev_b32 v128, 16, v50
    v_and_b32 v129, 0xffff0000, v50
    v_mfma_f32_32x32x16_bf16 v[112:127], v[52:55], a[24:27], v[112:127]
    v_add_f32 v144, v144, v128
    v_add_f32 v145, v145, v129
    v_lshlrev_b32 v130, 16, v51
    v_and_b32 v131, 0xffff0000, v51
    v_add_f32 v144, v144, v130
    v_add_f32 v145, v145, v131
    s_waitcnt lgkmcnt(6)
    v_mfma_f32_32x32x16_bf16 v[64:79], v[32:35], a[4:7], v[64:79]
    ds_read_b128 a[20:23], v14 offset:0
    ds_read_b128 a[24:27], v18 offset:0
    v_lshlrev_b32 v128, 16, v32
    v_and_b32 v129, 0xffff0000, v32
    v_add_f32 v144, v144, v128
    v_mfma_f32_32x32x16_bf16 v[80:95], v[32:35], a[8:11], v[80:95]
    ds_read_b64_tr_b16 v[48:49], v22 offset:8192
    ds_read_b64_tr_b16 v[50:51], v22 offset:9216
    v_add_f32 v145, v145, v129
    v_lshlrev_b32 v130, 16, v33
    v_and_b32 v131, 0xffff0000, v33
    v_mfma_f32_32x32x16_bf16 v[96:111], v[36:39], a[4:7], v[96:111]
    ds_read_b64_tr_b16 v[52:53], v23 offset:8192
    ds_read_b64_tr_b16 v[54:55], v23 offset:9216
    v_add_f32 v144, v144, v130
    v_add_f32 v145, v145, v131
    v_lshlrev_b32 v128, 16, v34
    v_and_b32 v129, 0xffff0000, v34
    v_mfma_f32_32x32x16_bf16 v[112:127], v[36:39], a[8:11], v[112:127]
    v_add_f32 v144, v144, v128
    v_add_f32 v145, v145, v129
    v_lshlrev_b32 v130, 16, v35
    v_and_b32 v131, 0xffff0000, v35
    v_add_f32 v144, v144, v130
    v_add_f32 v145, v145, v131
    s_waitcnt lgkmcnt(6)
    v_mfma_f32_32x32x16_bf16 v[64:79], v[40:43], a[12:15], v[64:79]
    ds_read_b128 a[4:7], v15 offset:0
    ds_read_b128 a[8:11], v19 offset:0
    v_lshlrev_b32 v128, 16, v40
    v_and_b32 v129, 0xffff0000, v40
    v_add_f32 v144, v144, v128
    v_mfma_f32_32x32x16_bf16 v[80:95], v[40:43], a[16:19], v[80:95]
    ds_read_b64_tr_b16 v[32:33], v22 offset:12288
    ds_read_b64_tr_b16 v[34:35], v22 offset:13312
    v_add_f32 v145, v145, v129
    v_lshlrev_b32 v130, 16, v41
    v_and_b32 v131, 0xffff0000, v41
    v_mfma_f32_32x32x16_bf16 v[96:111], v[44:47], a[12:15], v[96:111]
    ds_read_b64_tr_b16 v[36:37], v23 offset:12288
    ds_read_b64_tr_b16 v[38:39], v23 offset:13312
    v_add_f32 v144, v144, v130
    v_add_f32 v145, v145, v131
    v_lshlrev_b32 v128, 16, v42
    v_and_b32 v129, 0xffff0000, v42
    v_mfma_f32_32x32x16_bf16 v[112:127], v[44:47], a[16:19], v[112:127]
    v_add_f32 v144, v144, v128
    v_add_f32 v145, v145, v129
    v_lshlrev_b32 v130, 16, v43
    v_and_b32 v131, 0xffff0000, v43
    v_add_f32 v144, v144, v130
    v_add_f32 v145, v145, v131
    s_waitcnt lgkmcnt(6)
    v_mfma_f32_32x32x16_bf16 v[64:79], v[48:51], a[20:23], v[64:79]
    s_barrier
    ds_read_b128 a[12:15], v12 offset:32768
    ds_read_b128 a[16:19], v16 offset:32768
    v_lshlrev_b32 v128, 16, v48
    v_and_b32 v129, 0xffff0000, v48
    v_add_f32 v144, v144, v128
    v_mfma_f32_32x32x16_bf16 v[80:95], v[48:51], a[24:27], v[80:95]
    ds_read_b64_tr_b16 v[40:41], v22 offset:32768
    ds_read_b64_tr_b16 v[42:43], v22 offset:33792
    v_add_f32 v145, v145, v129
    v_lshlrev_b32 v130, 16, v49
    v_and_b32 v131, 0xffff0000, v49
    v_mfma_f32_32x32x16_bf16 v[96:111], v[52:55], a[20:23], v[96:111]
    ds_read_b64_tr_b16 v[44:45], v23 offset:32768
    ds_read_b64_tr_b16 v[46:47], v23 offset:33792
    v_add_f32 v144, v144, v130
    v_add_f32 v145, v145, v131
    v_lshlrev_b32 v128, 16, v50
    v_and_b32 v129, 0xffff0000, v50
    v_mfma_f32_32x32x16_bf16 v[112:127], v[52:55], a[24:27], v[112:127]
    v_add_f32 v144, v144, v128
    v_add_f32 v145, v145, v129
    v_lshlrev_b32 v130, 16, v51
    v_and_b32 v131, 0xffff0000, v51
    v_add_f32 v144, v144, v130
    v_add_f32 v145, v145, v131
    s_waitcnt lgkmcnt(6)
    v_mfma_f32_32x32x16_bf16 v[64:79], v[32:35], a[4:7], v[64:79]
    ds_read_b128 a[20:23], v13 offset:32768
    ds_read_b128 a[24:27], v17 offset:32768
    v_lshlrev_b32 v128, 16, v32
    v_and_b32 v129, 0xffff0000, v32
    v_add_f32 v144, v144, v128
    v_mfma_f32_32x32x16_bf16 v[80:95], v[32:35], a[8:11], v[80:95]
    ds_read_b64_tr_b16 v[48:49], v22 offset:36864
    ds_read_b64_tr_b16 v[50:51], v22 offset:37888
    v_add_f32 v145, v145, v129
    v_lshlrev_b32 v130, 16, v33
    v_and_b32 v131, 0xffff0000, v33
    v_mfma_f32_32x32x16_bf16 v[96:111], v[36:39], a[4:7], v[96:111]
    ds_read_b64_tr_b16 v[52:53], v23 offset:36864
    ds_read_b64_tr_b16 v[54:55], v23 offset:37888
    v_add_f32 v144, v144, v130
    v_add_f32 v145, v145, v131
    v_lshlrev_b32 v128, 16, v34
    v_and_b32 v129, 0xffff0000, v34
    v_mfma_f32_32x32x16_bf16 v[112:127], v[36:39], a[8:11], v[112:127]
    v_add_f32 v144, v144, v128
    v_add_f32 v145, v145, v129
    v_lshlrev_b32 v130, 16, v35
    v_and_b32 v131, 0xffff0000, v35
    v_add_f32 v144, v144, v130
    v_add_f32 v145, v145, v131
    s_waitcnt lgkmcnt(6)
    v_mfma_f32_32x32x16_bf16 v[64:79], v[40:43], a[12:15], v[64:79]
    ds_read_b128 a[4:7], v14 offset:32768
    ds_read_b128 a[8:11], v18 offset:32768
    v_lshlrev_b32 v128, 16, v40
    v_and_b32 v129, 0xffff0000, v40
    v_add_f32 v144, v144, v128
    v_mfma_f32_32x32x16_bf16 v[80:95], v[40:43], a[16:19], v[80:95]
    ds_read_b64_tr_b16 v[32:33], v22 offset:40960
    ds_read_b64_tr_b16 v[34:35], v22 offset:41984
    v_add_f32 v145, v145, v129
    v_lshlrev_b32 v130, 16, v41
    v_and_b32 v131, 0xffff0000, v41
    v_mfma_f32_32x32x16_bf16 v[96:111], v[44:47], a[12:15], v[96:111]
    ds_read_b64_tr_b16 v[36:37], v23 offset:40960
    ds_read_b64_tr_b16 v[38:39], v23 offset:41984
    v_add_f32 v144, v144, v130
    v_add_f32 v145, v145, v131
    v_lshlrev_b32 v128, 16, v42
    v_and_b32 v129, 0xffff0000, v42
    v_mfma_f32_32x32x16_bf16 v[112:127], v[44:47], a[16:19], v[112:127]
    v_add_f32 v144, v144, v128
    v_add_f32 v145, v145, v129
    v_lshlrev_b32 v130, 16, v43
    v_and_b32 v131, 0xffff0000, v43
    v_add_f32 v144, v144, v130
    v_add_f32 v145, v145, v131
    s_waitcnt lgkmcnt(6)
    v_mfma_f32_32x32x16_bf16 v[64:79], v[48:51], a[20:23], v[64:79]
    ds_read_b128 a[12:15], v15 offset:32768
    ds_read_b128 a[16:19], v19 offset:32768
    v_lshlrev_b32 v128, 16, v48
    v_and_b32 v129, 0xffff0000, v48
    v_add_f32 v144, v144, v128
    v_mfma_f32_32x32x16_bf16 v[80:95], v[48:51], a[24:27], v[80:95]
    ds_read_b64_tr_b16 v[40:41], v22 offset:45056
    ds_read_b64_tr_b16 v[42:43], v22 offset:46080
    v_add_f32 v145, v145, v129
    v_lshlrev_b32 v130, 16, v49
    v_and_b32 v131, 0xffff0000, v49
    v_mfma_f32_32x32x16_bf16 v[96:111], v[52:55], a[20:23], v[96:111]
    ds_read_b64_tr_b16 v[44:45], v23 offset:45056
    ds_read_b64_tr_b16 v[46:47], v23 offset:46080
    v_add_f32 v144, v144, v130
    v_add_f32 v145, v145, v131
    v_lshlrev_b32 v128, 16, v50
    v_and_b32 v129, 0xffff0000, v50
    v_mfma_f32_32x32x16_bf16 v[112:127], v[52:55], a[24:27], v[112:127]
    v_add_f32 v144, v144, v128
    v_add_f32 v145, v145, v129
    v_lshlrev_b32 v130, 16, v51
    v_and_b32 v131, 0xffff0000, v51
    v_add_f32 v144, v144, v130
    v_add_f32 v145, v145, v131
    s_waitcnt lgkmcnt(6)
    v_mfma_f32_32x32x16_bf16 v[64:79], v[32:35], a[4:7], v[64:79]
    s_barrier
    ds_read_b128 a[20:23], v4 offset:0
    ds_read_b128 a[24:27], v8 offset:0
    v_lshlrev_b32 v128, 16, v32
    v_and_b32 v129, 0xffff0000, v32
    v_add_f32 v144, v144, v128
    v_mfma_f32_32x32x16_bf16 v[80:95], v[32:35], a[8:11], v[80:95]
    ds_read_b64_tr_b16 v[48:49], v20 offset:0
    ds_read_b64_tr_b16 v[50:51], v20 offset:1024
    v_add_f32 v145, v145, v129
    v_lshlrev_b32 v130, 16, v33
    v_and_b32 v131, 0xffff0000, v33
    v_mfma_f32_32x32x16_bf16 v[96:111], v[36:39], a[4:7], v[96:111]
    ds_read_b64_tr_b16 v[52:53], v21 offset:0
    ds_read_b64_tr_b16 v[54:55], v21 offset:1024
    v_add_f32 v144, v144, v130
    v_add_f32 v145, v145, v131
    v_lshlrev_b32 v128, 16, v34
    v_and_b32 v129, 0xffff0000, v34
    v_mfma_f32_32x32x16_bf16 v[112:127], v[36:39], a[8:11], v[112:127]
    v_add_f32 v144, v144, v128
    v_add_f32 v145, v145, v129
    v_lshlrev_b32 v130, 16, v35
    v_and_b32 v131, 0xffff0000, v35
    v_add_f32 v144, v144, v130
    v_add_f32 v145, v145, v131
    s_waitcnt lgkmcnt(6)
    v_mfma_f32_32x32x16_bf16 v[64:79], v[40:43], a[12:15], v[64:79]
    ds_read_b128 a[4:7], v5 offset:0
    ds_read_b128 a[8:11], v9 offset:0
    v_lshlrev_b32 v128, 16, v40
    v_and_b32 v129, 0xffff0000, v40
    v_add_f32 v144, v144, v128
    v_mfma_f32_32x32x16_bf16 v[80:95], v[40:43], a[16:19], v[80:95]
    ds_read_b64_tr_b16 v[32:33], v20 offset:4096
    ds_read_b64_tr_b16 v[34:35], v20 offset:5120
    v_add_f32 v145, v145, v129
    v_lshlrev_b32 v130, 16, v41
    v_and_b32 v131, 0xffff0000, v41
    v_mfma_f32_32x32x16_bf16 v[96:111], v[44:47], a[12:15], v[96:111]
    ds_read_b64_tr_b16 v[36:37], v21 offset:4096
    ds_read_b64_tr_b16 v[38:39], v21 offset:5120
    v_add_f32 v144, v144, v130
    v_add_f32 v145, v145, v131
    v_lshlrev_b32 v128, 16, v42
    v_and_b32 v129, 0xffff0000, v42
    v_mfma_f32_32x32x16_bf16 v[112:127], v[44:47], a[16:19], v[112:127]
    v_add_f32 v144, v144, v128
    v_add_f32 v145, v145, v129
    v_lshlrev_b32 v130, 16, v43
    v_and_b32 v131, 0xffff0000, v43
    v_add_f32 v144, v144, v130
    v_add_f32 v145, v145, v131
    s_waitcnt lgkmcnt(6)
    v_mfma_f32_32x32x16_bf16 v[64:79], v[48:51], a[20:23], v[64:79]
    ds_read_b128 a[12:15], v6 offset:0
    ds_read_b128 a[16:19], v10 offset:0
    v_lshlrev_b32 v128, 16, v48
    v_and_b32 v129, 0xffff0000, v48
    v_add_f32 v144, v144, v128
    v_mfma_f32_32x32x16_bf16 v[80:95], v[48:51], a[24:27], v[80:95]
    ds_read_b64_tr_b16 v[40:41], v20 offset:8192
    ds_read_b64_tr_b16 v[42:43], v20 offset:9216
    v_add_f32 v145, v145, v129
    v_lshlrev_b32 v130, 16, v49
    v_and_b32 v131, 0xffff0000, v49
    v_mfma_f32_32x32x16_bf16 v[96:111], v[52:55], a[20:23], v[96:111]
    ds_read_b64_tr_b16 v[44:45], v21 offset:8192
    ds_read_b64_tr_b16 v[46:47], v21 offset:9216
    v_add_f32 v144, v144, v130
    v_add_f32 v145, v145, v131
    v_lshlrev_b32 v128, 16, v50
    v_and_b32 v129, 0xffff0000, v50
    v_mfma_f32_32x32x16_bf16 v[112:127], v[52:55], a[24:27], v[112:127]
    v_add_f32 v144, v144, v128
    v_add_f32 v145, v145, v129
    v_lshlrev_b32 v130, 16, v51
    v_and_b32 v131, 0xffff0000, v51
    v_add_f32 v144, v144, v130
    v_add_f32 v145, v145, v131
    s_waitcnt lgkmcnt(6)
    v_mfma_f32_32x32x16_bf16 v[64:79], v[32:35], a[4:7], v[64:79]
    ds_read_b128 a[20:23], v7 offset:0
    ds_read_b128 a[24:27], v11 offset:0
    v_lshlrev_b32 v128, 16, v32
    v_and_b32 v129, 0xffff0000, v32
    v_add_f32 v144, v144, v128
    v_mfma_f32_32x32x16_bf16 v[80:95], v[32:35], a[8:11], v[80:95]
    ds_read_b64_tr_b16 v[48:49], v20 offset:12288
    ds_read_b64_tr_b16 v[50:51], v20 offset:13312
    v_add_f32 v145, v145, v129
    v_lshlrev_b32 v130, 16, v33
    v_and_b32 v131, 0xffff0000, v33
    v_mfma_f32_32x32x16_bf16 v[96:111], v[36:39], a[4:7], v[96:111]
    ds_read_b64_tr_b16 v[52:53], v21 offset:12288
    ds_read_b64_tr_b16 v[54:55], v21 offset:13312
    v_add_f32 v144, v144, v130
    v_add_f32 v145, v145, v131
    v_lshlrev_b32 v128, 16, v34
    v_and_b32 v129, 0xffff0000, v34
    v_mfma_f32_32x32x16_bf16 v[112:127], v[36:39], a[8:11], v[112:127]
    v_add_f32 v144, v144, v128
    v_add_f32 v145, v145, v129
    v_lshlrev_b32 v130, 16, v35
    v_and_b32 v131, 0xffff0000, v35
    v_add_f32 v144, v144, v130
    v_add_f32 v145, v145, v131
    s_waitcnt lgkmcnt(6)
    v_mfma_f32_32x32x16_bf16 v[64:79], v[40:43], a[12:15], v[64:79]
    s_barrier
    ds_read_b128 a[4:7], v4 offset:32768
    ds_read_b128 a[8:11], v8 offset:32768
    v_lshlrev_b32 v128, 16, v40
    v_and_b32 v129, 0xffff0000, v40
    v_add_f32 v144, v144, v128
    v_mfma_f32_32x32x16_bf16 v[80:95], v[40:43], a[16:19], v[80:95]
    ds_read_b64_tr_b16 v[32:33], v20 offset:32768
    ds_read_b64_tr_b16 v[34:35], v20 offset:33792
    v_add_f32 v145, v145, v129
    v_lshlrev_b32 v130, 16, v41
    v_and_b32 v131, 0xffff0000, v41
    v_mfma_f32_32x32x16_bf16 v[96:111], v[44:47], a[12:15], v[96:111]
    ds_read_b64_tr_b16 v[36:37], v21 offset:32768
    ds_read_b64_tr_b16 v[38:39], v21 offset:33792
    v_add_f32 v144, v144, v130
    v_add_f32 v145, v145, v131
    v_lshlrev_b32 v128, 16, v42
    v_and_b32 v129, 0xffff0000, v42
    v_mfma_f32_32x32x16_bf16 v[112:127], v[44:47], a[16:19], v[112:127]
    v_add_f32 v144, v144, v128
    v_add_f32 v145, v145, v129
    v_lshlrev_b32 v130, 16, v43
    v_and_b32 v131, 0xffff0000, v43
    v_add_f32 v144, v144, v130
    v_add_f32 v145, v145, v131
    s_waitcnt lgkmcnt(6)
    v_mfma_f32_32x32x16_bf16 v[64:79], v[48:51], a[20:23], v[64:79]
    ds_read_b128 a[12:15], v5 offset:32768
    ds_read_b128 a[16:19], v9 offset:32768
    v_lshlrev_b32 v128, 16, v48
    v_and_b32 v129, 0xffff0000, v48
    v_add_f32 v144, v144, v128
    v_mfma_f32_32x32x16_bf16 v[80:95], v[48:51], a[24:27], v[80:95]
    ds_read_b64_tr_b16 v[40:41], v20 offset:36864
    ds_read_b64_tr_b16 v[42:43], v20 offset:37888
    v_add_f32 v145, v145, v129
    v_lshlrev_b32 v130, 16, v49
    v_and_b32 v131, 0xffff0000, v49
    v_mfma_f32_32x32x16_bf16 v[96:111], v[52:55], a[20:23], v[96:111]
    ds_read_b64_tr_b16 v[44:45], v21 offset:36864
    ds_read_b64_tr_b16 v[46:47], v21 offset:37888
    v_add_f32 v144, v144, v130
    v_add_f32 v145, v145, v131
    v_lshlrev_b32 v128, 16, v50
    v_and_b32 v129, 0xffff0000, v50
    v_mfma_f32_32x32x16_bf16 v[112:127], v[52:55], a[24:27], v[112:127]
    v_add_f32 v144, v144, v128
    v_add_f32 v145, v145, v129
    v_lshlrev_b32 v130, 16, v51
    v_and_b32 v131, 0xffff0000, v51
    v_add_f32 v144, v144, v130
    v_add_f32 v145, v145, v131
    s_waitcnt lgkmcnt(6)
    v_mfma_f32_32x32x16_bf16 v[64:79], v[32:35], a[4:7], v[64:79]
    ds_read_b128 a[20:23], v6 offset:32768
    ds_read_b128 a[24:27], v10 offset:32768
    v_lshlrev_b32 v128, 16, v32
    v_and_b32 v129, 0xffff0000, v32
    v_add_f32 v144, v144, v128
    v_mfma_f32_32x32x16_bf16 v[80:95], v[32:35], a[8:11], v[80:95]
    ds_read_b64_tr_b16 v[48:49], v20 offset:40960
    ds_read_b64_tr_b16 v[50:51], v20 offset:41984
    v_add_f32 v145, v145, v129
    v_lshlrev_b32 v130, 16, v33
    v_and_b32 v131, 0xffff0000, v33
    v_mfma_f32_32x32x16_bf16 v[96:111], v[36:39], a[4:7], v[96:111]
    ds_read_b64_tr_b16 v[52:53], v21 offset:40960
    ds_read_b64_tr_b16 v[54:55], v21 offset:41984
    v_add_f32 v144, v144, v130
    v_add_f32 v145, v145, v131
    v_lshlrev_b32 v128, 16, v34
    v_and_b32 v129, 0xffff0000, v34
    v_mfma_f32_32x32x16_bf16 v[112:127], v[36:39], a[8:11], v[112:127]
    v_add_f32 v144, v144, v128
    v_add_f32 v145, v145, v129
    v_lshlrev_b32 v130, 16, v35
    v_and_b32 v131, 0xffff0000, v35
    v_add_f32 v144, v144, v130
    v_add_f32 v145, v145, v131
    s_waitcnt lgkmcnt(6)
    v_mfma_f32_32x32x16_bf16 v[64:79], v[40:43], a[12:15], v[64:79]
    ds_read_b128 a[4:7], v7 offset:32768
    ds_read_b128 a[8:11], v11 offset:32768
    v_lshlrev_b32 v128, 16, v40
    v_and_b32 v129, 0xffff0000, v40
    v_add_f32 v144, v144, v128
    v_mfma_f32_32x32x16_bf16 v[80:95], v[40:43], a[16:19], v[80:95]
    ds_read_b64_tr_b16 v[32:33], v20 offset:45056
    ds_read_b64_tr_b16 v[34:35], v20 offset:46080
    v_add_f32 v145, v145, v129
    v_lshlrev_b32 v130, 16, v41
    v_and_b32 v131, 0xffff0000, v41
    v_mfma_f32_32x32x16_bf16 v[96:111], v[44:47], a[12:15], v[96:111]
    ds_read_b64_tr_b16 v[36:37], v21 offset:45056
    ds_read_b64_tr_b16 v[38:39], v21 offset:46080
    v_add_f32 v144, v144, v130
    v_add_f32 v145, v145, v131
    v_lshlrev_b32 v128, 16, v42
    v_and_b32 v129, 0xffff0000, v42
    v_mfma_f32_32x32x16_bf16 v[112:127], v[44:47], a[16:19], v[112:127]
    v_add_f32 v144, v144, v128
    v_add_f32 v145, v145, v129
    v_lshlrev_b32 v130, 16, v43
    v_and_b32 v131, 0xffff0000, v43
    v_add_f32 v144, v144, v130
    v_add_f32 v145, v145, v131
    s_waitcnt lgkmcnt(6)
    v_mfma_f32_32x32x16_bf16 v[64:79], v[48:51], a[20:23], v[64:79]
    v_lshlrev_b32 v128, 16, v48
    v_and_b32 v129, 0xffff0000, v48
    v_add_f32 v144, v144, v128
    v_mfma_f32_32x32x16_bf16 v[80:95], v[48:51], a[24:27], v[80:95]
    v_add_f32 v145, v145, v129
    v_lshlrev_b32 v130, 16, v49
    v_and_b32 v131, 0xffff0000, v49
    v_mfma_f32_32x32x16_bf16 v[96:111], v[52:55], a[20:23], v[96:111]
    v_add_f32 v144, v144, v130
    v_add_f32 v145, v145, v131
    v_lshlrev_b32 v128, 16, v50
    v_and_b32 v129, 0xffff0000, v50
    v_mfma_f32_32x32x16_bf16 v[112:127], v[52:55], a[24:27], v[112:127]
    v_add_f32 v144, v144, v128
    v_add_f32 v145, v145, v129
    v_lshlrev_b32 v130, 16, v51
    v_and_b32 v131, 0xffff0000, v51
    v_add_f32 v144, v144, v130
    v_add_f32 v145, v145, v131
    s_waitcnt lgkmcnt(0)
    v_mfma_f32_32x32x16_bf16 v[64:79], v[32:35], a[4:7], v[64:79]
    v_lshlrev_b32 v128, 16, v32
    v_and_b32 v129, 0xffff0000, v32
    v_add_f32 v144, v144, v128
    v_mfma_f32_32x32x16_bf16 v[80:95], v[32:35], a[8:11], v[80:95]
    v_add_f32 v145, v145, v129
    v_lshlrev_b32 v130, 16, v33
    v_and_b32 v131, 0xffff0000, v33
    v_mfma_f32_32x32x16_bf16 v[96:111], v[36:39], a[4:7], v[96:111]
    v_add_f32 v144, v144, v130
    v_add_f32 v145, v145, v131
    v_lshlrev_b32 v128, 16, v34
    v_and_b32 v129, 0xffff0000, v34
    v_mfma_f32_32x32x16_bf16 v[112:127], v[36:39], a[8:11], v[112:127]
    v_add_f32 v144, v144, v128
    v_add_f32 v145, v145, v129
    v_lshlrev_b32 v130, 16, v35
    v_and_b32 v131, 0xffff0000, v35
    v_add_f32 v144, v144, v130
    v_add_f32 v145, v145, v131
    v_add_f32 v144, v144, v145
    s_nop 0
    v_mov_b32 v145, v144
    s_nop 1
    v_permlane32_swap_b32 v144, v145
    s_nop 1
    v_add_f32 v144, v144, v145
    s_lshl_b32 s23, s33, 8
    s_lshl_b32 s24, s32, 7
    s_add_u32 s23, s23, s24
    s_add_u32 s23, s23, 146432
    v_lshlrev_b32 v158, 2, v2
    v_add_u32 v159, s23, v158
    ds_write_b32 v159, v144
    s_waitcnt lgkmcnt(0)
    s_barrier
    s_lshl_b32 s24, s32, 8
    s_add_u32 s23, s24, 145408
    s_xor_b32 s24, s33, 0
    s_lshl_b32 s24, s24, 7
    s_add_u32 s23, s23, s24
    v_lshlrev_b32 v132, 2, v2
    v_add_u32 v132, s23, v132
    ds_read_b32 v128, v132
    ds_read_b32 v130, v132 offset:512
    s_lshl_b32 s24, s32, 8
    s_add_u32 s23, s24, 145408
    s_xor_b32 s24, s33, 1
    s_lshl_b32 s24, s24, 7
    s_add_u32 s23, s23, s24
    v_lshlrev_b32 v132, 2, v2
    v_add_u32 v132, s23, v132
    ds_read_b32 v129, v132
    ds_read_b32 v131, v132 offset:512
    s_lshl_b32 s24, s33, 8
    s_add_u32 s23, s24, 146432
    s_xor_b32 s24, s32, 0
    s_lshl_b32 s24, s24, 7
    s_add_u32 s23, s23, s24
    v_lshlrev_b32 v132, 4, v3
    v_add_u32 v132, s23, v132
    ds_read_b128 v[32:35], v132 offset:0
    ds_read_b128 v[36:39], v132 offset:32
    ds_read_b128 v[40:43], v132 offset:64
    ds_read_b128 v[44:47], v132 offset:96
    s_lshl_b32 s24, s33, 8
    s_add_u32 s23, s24, 146432
    s_xor_b32 s24, s32, 1
    s_lshl_b32 s24, s24, 7
    s_add_u32 s23, s23, s24
    v_lshlrev_b32 v132, 4, v3
    v_add_u32 v132, s23, v132
    ds_read_b128 v[48:51], v132 offset:0
    ds_read_b128 v[52:55], v132 offset:32
    ds_read_b128 v[56:59], v132 offset:64
    ds_read_b128 v[60:63], v132 offset:96
    s_waitcnt lgkmcnt(0)
    s_cmp_lt_u32 s34, 5
    s_cselect_b32 s23, 0x3ea52b5c, 1.0
    v_mul_f32 v130, s23, v130
    v_mul_f32 v131, s23, v131
    v_mov_b32 v146, v128
    v_mov_b32 v147, v128
    v_mov_b32 v150, v130
    v_mov_b32 v151, v130
    v_mov_b32 v148, v129
    v_mov_b32 v149, v129
    v_mov_b32 v152, v131
    v_mov_b32 v153, v131
    v_pk_fma_f32 v[64:65], v[146:147], v[32:33], v[64:65] neg_lo:[1,0,0] neg_hi:[1,0,0]
    v_pk_fma_f32 v[66:67], v[146:147], v[34:35], v[66:67] neg_lo:[1,0,0] neg_hi:[1,0,0]
    v_pk_fma_f32 v[68:69], v[146:147], v[36:37], v[68:69] neg_lo:[1,0,0] neg_hi:[1,0,0]
    v_pk_fma_f32 v[70:71], v[146:147], v[38:39], v[70:71] neg_lo:[1,0,0] neg_hi:[1,0,0]
    v_pk_fma_f32 v[72:73], v[146:147], v[40:41], v[72:73] neg_lo:[1,0,0] neg_hi:[1,0,0]
    v_pk_fma_f32 v[74:75], v[146:147], v[42:43], v[74:75] neg_lo:[1,0,0] neg_hi:[1,0,0]
    v_pk_fma_f32 v[76:77], v[146:147], v[44:45], v[76:77] neg_lo:[1,0,0] neg_hi:[1,0,0]
    v_pk_fma_f32 v[78:79], v[146:147], v[46:47], v[78:79] neg_lo:[1,0,0] neg_hi:[1,0,0]
    v_pk_mul_f32 v[64:65], v[64:65], v[150:151]
    v_pk_mul_f32 v[66:67], v[66:67], v[150:151]
    v_pk_mul_f32 v[68:69], v[68:69], v[150:151]
    v_pk_mul_f32 v[70:71], v[70:71], v[150:151]
    v_pk_mul_f32 v[72:73], v[72:73], v[150:151]
    v_pk_mul_f32 v[74:75], v[74:75], v[150:151]
    v_pk_mul_f32 v[76:77], v[76:77], v[150:151]
    v_pk_mul_f32 v[78:79], v[78:79], v[150:151]
    v_cvt_pk_bf16_f32 v136, v64, v65
    v_cvt_pk_bf16_f32 v137, v66, v67
    v_cvt_pk_bf16_f32 v138, v68, v69
    v_cvt_pk_bf16_f32 v139, v70, v71
    s_nop 0
    s_nop 0
    v_permlane32_swap_b32 v136, v138
    v_permlane32_swap_b32 v137, v139
    buffer_store_dwordx4 v[136:139], v24, s[16:19], s40 offen sc1
    v_cvt_pk_bf16_f32 v140, v72, v73
    v_cvt_pk_bf16_f32 v141, v74, v75
    v_cvt_pk_bf16_f32 v142, v76, v77
    v_cvt_pk_bf16_f32 v143, v78, v79
    s_nop 0
    s_nop 0
    v_permlane32_swap_b32 v140, v142
    v_permlane32_swap_b32 v141, v143
    buffer_store_dwordx4 v[140:143], v25, s[16:19], s40 offen sc1
    v_pk_fma_f32 v[80:81], v[148:149], v[32:33], v[80:81] neg_lo:[1,0,0] neg_hi:[1,0,0]
    v_pk_fma_f32 v[82:83], v[148:149], v[34:35], v[82:83] neg_lo:[1,0,0] neg_hi:[1,0,0]
    v_pk_fma_f32 v[84:85], v[148:149], v[36:37], v[84:85] neg_lo:[1,0,0] neg_hi:[1,0,0]
    v_pk_fma_f32 v[86:87], v[148:149], v[38:39], v[86:87] neg_lo:[1,0,0] neg_hi:[1,0,0]
    v_pk_fma_f32 v[88:89], v[148:149], v[40:41], v[88:89] neg_lo:[1,0,0] neg_hi:[1,0,0]
    v_pk_fma_f32 v[90:91], v[148:149], v[42:43], v[90:91] neg_lo:[1,0,0] neg_hi:[1,0,0]
    v_pk_fma_f32 v[92:93], v[148:149], v[44:45], v[92:93] neg_lo:[1,0,0] neg_hi:[1,0,0]
    v_pk_fma_f32 v[94:95], v[148:149], v[46:47], v[94:95] neg_lo:[1,0,0] neg_hi:[1,0,0]
    v_pk_mul_f32 v[80:81], v[80:81], v[152:153]
    v_pk_mul_f32 v[82:83], v[82:83], v[152:153]
    v_pk_mul_f32 v[84:85], v[84:85], v[152:153]
    v_pk_mul_f32 v[86:87], v[86:87], v[152:153]
    v_pk_mul_f32 v[88:89], v[88:89], v[152:153]
    v_pk_mul_f32 v[90:91], v[90:91], v[152:153]
    v_pk_mul_f32 v[92:93], v[92:93], v[152:153]
    v_pk_mul_f32 v[94:95], v[94:95], v[152:153]
    v_cvt_pk_bf16_f32 v136, v80, v81
    v_cvt_pk_bf16_f32 v137, v82, v83
    v_cvt_pk_bf16_f32 v138, v84, v85
    v_cvt_pk_bf16_f32 v139, v86, v87
    s_nop 0
    s_nop 0
    v_permlane32_swap_b32 v136, v138
    v_permlane32_swap_b32 v137, v139
    buffer_store_dwordx4 v[136:139], v24, s[16:19], s41 offen sc1
    v_cvt_pk_bf16_f32 v140, v88, v89
    v_cvt_pk_bf16_f32 v141, v90, v91
    v_cvt_pk_bf16_f32 v142, v92, v93
    v_cvt_pk_bf16_f32 v143, v94, v95
    s_nop 0
    s_nop 0
    v_permlane32_swap_b32 v140, v142
    v_permlane32_swap_b32 v141, v143
    buffer_store_dwordx4 v[140:143], v25, s[16:19], s41 offen sc1
    v_pk_fma_f32 v[96:97], v[146:147], v[48:49], v[96:97] neg_lo:[1,0,0] neg_hi:[1,0,0]
    v_pk_fma_f32 v[98:99], v[146:147], v[50:51], v[98:99] neg_lo:[1,0,0] neg_hi:[1,0,0]
    v_pk_fma_f32 v[100:101], v[146:147], v[52:53], v[100:101] neg_lo:[1,0,0] neg_hi:[1,0,0]
    v_pk_fma_f32 v[102:103], v[146:147], v[54:55], v[102:103] neg_lo:[1,0,0] neg_hi:[1,0,0]
    v_pk_fma_f32 v[104:105], v[146:147], v[56:57], v[104:105] neg_lo:[1,0,0] neg_hi:[1,0,0]
    v_pk_fma_f32 v[106:107], v[146:147], v[58:59], v[106:107] neg_lo:[1,0,0] neg_hi:[1,0,0]
    v_pk_fma_f32 v[108:109], v[146:147], v[60:61], v[108:109] neg_lo:[1,0,0] neg_hi:[1,0,0]
    v_pk_fma_f32 v[110:111], v[146:147], v[62:63], v[110:111] neg_lo:[1,0,0] neg_hi:[1,0,0]
    v_pk_mul_f32 v[96:97], v[96:97], v[150:151]
    v_pk_mul_f32 v[98:99], v[98:99], v[150:151]
    v_pk_mul_f32 v[100:101], v[100:101], v[150:151]
    v_pk_mul_f32 v[102:103], v[102:103], v[150:151]
    v_pk_mul_f32 v[104:105], v[104:105], v[150:151]
    v_pk_mul_f32 v[106:107], v[106:107], v[150:151]
    v_pk_mul_f32 v[108:109], v[108:109], v[150:151]
    v_pk_mul_f32 v[110:111], v[110:111], v[150:151]
    v_cvt_pk_bf16_f32 v136, v96, v97
    v_cvt_pk_bf16_f32 v137, v98, v99
    v_cvt_pk_bf16_f32 v138, v100, v101
    v_cvt_pk_bf16_f32 v139, v102, v103
    s_nop 0
    s_nop 0
    v_permlane32_swap_b32 v136, v138
    v_permlane32_swap_b32 v137, v139
    buffer_store_dwordx4 v[136:139], v26, s[16:19], s40 offen sc1
    v_cvt_pk_bf16_f32 v140, v104, v105
    v_cvt_pk_bf16_f32 v141, v106, v107
    v_cvt_pk_bf16_f32 v142, v108, v109
    v_cvt_pk_bf16_f32 v143, v110, v111
    s_nop 0
    s_nop 0
    v_permlane32_swap_b32 v140, v142
    v_permlane32_swap_b32 v141, v143
    buffer_store_dwordx4 v[140:143], v27, s[16:19], s40 offen sc1
    v_pk_fma_f32 v[112:113], v[148:149], v[48:49], v[112:113] neg_lo:[1,0,0] neg_hi:[1,0,0]
    v_pk_fma_f32 v[114:115], v[148:149], v[50:51], v[114:115] neg_lo:[1,0,0] neg_hi:[1,0,0]
    v_pk_fma_f32 v[116:117], v[148:149], v[52:53], v[116:117] neg_lo:[1,0,0] neg_hi:[1,0,0]
    v_pk_fma_f32 v[118:119], v[148:149], v[54:55], v[118:119] neg_lo:[1,0,0] neg_hi:[1,0,0]
    v_pk_fma_f32 v[120:121], v[148:149], v[56:57], v[120:121] neg_lo:[1,0,0] neg_hi:[1,0,0]
    v_pk_fma_f32 v[122:123], v[148:149], v[58:59], v[122:123] neg_lo:[1,0,0] neg_hi:[1,0,0]
    v_pk_fma_f32 v[124:125], v[148:149], v[60:61], v[124:125] neg_lo:[1,0,0] neg_hi:[1,0,0]
    v_pk_fma_f32 v[126:127], v[148:149], v[62:63], v[126:127] neg_lo:[1,0,0] neg_hi:[1,0,0]
    v_pk_mul_f32 v[112:113], v[112:113], v[152:153]
    v_pk_mul_f32 v[114:115], v[114:115], v[152:153]
    v_pk_mul_f32 v[116:117], v[116:117], v[152:153]
    v_pk_mul_f32 v[118:119], v[118:119], v[152:153]
    v_pk_mul_f32 v[120:121], v[120:121], v[152:153]
    v_pk_mul_f32 v[122:123], v[122:123], v[152:153]
    v_pk_mul_f32 v[124:125], v[124:125], v[152:153]
    v_pk_mul_f32 v[126:127], v[126:127], v[152:153]
    v_cvt_pk_bf16_f32 v136, v112, v113
    v_cvt_pk_bf16_f32 v137, v114, v115
    v_cvt_pk_bf16_f32 v138, v116, v117
    v_cvt_pk_bf16_f32 v139, v118, v119
    s_nop 0
    s_nop 0
    v_permlane32_swap_b32 v136, v138
    v_permlane32_swap_b32 v137, v139
    buffer_store_dwordx4 v[136:139], v26, s[16:19], s41 offen sc1
    v_cvt_pk_bf16_f32 v140, v120, v121
    v_cvt_pk_bf16_f32 v141, v122, v123
    v_cvt_pk_bf16_f32 v142, v124, v125
    v_cvt_pk_bf16_f32 v143, v126, v127
    s_nop 0
    s_nop 0
    v_permlane32_swap_b32 v140, v142
    v_permlane32_swap_b32 v141, v143
    buffer_store_dwordx4 v[140:143], v27, s[16:19], s41 offen sc1
    s_branch L_q_done
L_q_vpath:
    s_lshl_b32 s24, s33, 6
    s_add_u32 s23, s22, s24
    s_xor_b32 s24, s32, 0
    s_lshl_b32 s24, s24, 5
    s_add_u32 s23, s23, s24
    s_sub_u32 s23, s23, 1280
    v_add_u32 v128, s23, v2
    v_mul_u32_u24 v129, 0xcccd, v128
    v_lshrrev_b32 v129, 20, v129
    v_mul_u32_u24 v130, 20, v129
    v_sub_u32 v128, v128, v130
    v_lshlrev_b32 v128, 4, v128
    v_mul_u32_u24 v129, 0x14000, v129
    v_add_u32 v128, v128, v129
    v_mul_u32_u24 v129, 320, v3
    v_add_u32 v24, v128, v129
    s_lshl_b32 s24, s33, 6
    s_add_u32 s23, s22, s24
    s_xor_b32 s24, s32, 1
    s_lshl_b32 s24, s24, 5
    s_add_u32 s23, s23, s24
    s_sub_u32 s23, s23, 1280
    v_add_u32 v128, s23, v2
    v_mul_u32_u24 v129, 0xcccd, v128
    v_lshrrev_b32 v129, 20, v129
    v_mul_u32_u24 v130, 20, v129
    v_sub_u32 v128, v128, v130
    v_lshlrev_b32 v128, 4, v128
    v_mul_u32_u24 v129, 0x14000, v129
    v_add_u32 v128, v128, v129
    v_mul_u32_u24 v129, 320, v3
    v_add_u32 v25, v128, v129
    s_lshl_b32 s24, s32, 6
    s_add_u32 s23, s21, s24
    s_lshr_b32 s23, s23, 4
    s_lshl_b32 s24, s33, 1
    s_add_u32 s24, s24, s23
    s_mul_i32 s40, s24, 640
    s_add_u32 s41, s40, 640
    s_xor_b32 s24, s33, 1
    s_lshl_b32 s24, s24, 1
    s_add_u32 s24, s24, s23
    s_mul_i32 s42, s24, 640
    s_add_u32 s43, s42, 640
    s_add_u32 s16, s78, 0x500000
    s_addc_u32 s17, s79, 0
    s_and_b32 s17, s17, 0xffff
    s_mov_b32 s18, 0x280000
    s_mov_b32 s19, 0x20000
    v_mov_b32 v144, 0
    v_mov_b32 v145, 0
    s_barrier
    ds_read_b128 a[4:7], v4 offset:0
    ds_read_b128 a[8:11], v8 offset:0
    ds_read_b64_tr_b16 v[32:33], v20 offset:0
    ds_read_b64_tr_b16 v[34:35], v20 offset:1024
    ds_read_b64_tr_b16 v[36:37], v21 offset:0
    ds_read_b64_tr_b16 v[38:39], v21 offset:1024
    ds_read_b128 a[12:15], v5 offset:0
    ds_read_b128 a[16:19], v9 offset:0
    ds_read_b64_tr_b16 v[40:41], v20 offset:4096
    ds_read_b64_tr_b16 v[42:43], v20 offset:5120
    ds_read_b64_tr_b16 v[44:45], v21 offset:4096
    ds_read_b64_tr_b16 v[46:47], v21 offset:5120
    s_waitcnt lgkmcnt(6)
    v_mfma_f32_32x32x16_bf16 v[64:79], a[4:7], v[32:35], 0
    ds_read_b128 a[20:23], v6 offset:0
    ds_read_b128 a[24:27], v10 offset:0
    v_lshlrev_b32 v128, 16, v32
    v_and_b32 v129, 0xffff0000, v32
    v_add_f32 v144, v144, v128
    v_mfma_f32_32x32x16_bf16 v[80:95], a[8:11], v[32:35], 0
    ds_read_b64_tr_b16 v[48:49], v20 offset:8192
    ds_read_b64_tr_b16 v[50:51], v20 offset:9216
    v_add_f32 v145, v145, v129
    v_lshlrev_b32 v130, 16, v33
    v_and_b32 v131, 0xffff0000, v33
    v_mfma_f32_32x32x16_bf16 v[96:111], a[4:7], v[36:39], 0
    ds_read_b64_tr_b16 v[52:53], v21 offset:8192
    ds_read_b64_tr_b16 v[54:55], v21 offset:9216
    v_add_f32 v144, v144, v130
    v_add_f32 v145, v145, v131
    v_lshlrev_b32 v128, 16, v34
    v_and_b32 v129, 0xffff0000, v34
    v_mfma_f32_32x32x16_bf16 v[112:127], a[8:11], v[36:39], 0
    v_add_f32 v144, v144, v128
    v_add_f32 v145, v145, v129
    v_lshlrev_b32 v130, 16, v35
    v_and_b32 v131, 0xffff0000, v35
    v_add_f32 v144, v144, v130
    v_add_f32 v145, v145, v131
    s_waitcnt lgkmcnt(6)
    v_mfma_f32_32x32x16_bf16 v[64:79], a[12:15], v[40:43], v[64:79]
    ds_read_b128 a[4:7], v7 offset:0
    ds_read_b128 a[8:11], v11 offset:0
    v_lshlrev_b32 v128, 16, v40
    v_and_b32 v129, 0xffff0000, v40
    v_add_f32 v144, v144, v128
    v_mfma_f32_32x32x16_bf16 v[80:95], a[16:19], v[40:43], v[80:95]
    ds_read_b64_tr_b16 v[32:33], v20 offset:12288
    ds_read_b64_tr_b16 v[34:35], v20 offset:13312
    v_add_f32 v145, v145, v129
    v_lshlrev_b32 v130, 16, v41
    v_and_b32 v131, 0xffff0000, v41
    v_mfma_f32_32x32x16_bf16 v[96:111], a[12:15], v[44:47], v[96:111]
    ds_read_b64_tr_b16 v[36:37], v21 offset:12288
    ds_read_b64_tr_b16 v[38:39], v21 offset:13312
    v_add_f32 v144, v144, v130
    v_add_f32 v145, v145, v131
    v_lshlrev_b32 v128, 16, v42
    v_and_b32 v129, 0xffff0000, v42
    v_mfma_f32_32x32x16_bf16 v[112:127], a[16:19], v[44:47], v[112:127]
    v_add_f32 v144, v144, v128
    v_add_f32 v145, v145, v129
    v_lshlrev_b32 v130, 16, v43
    v_and_b32 v131, 0xffff0000, v43
    v_add_f32 v144, v144, v130
    v_add_f32 v145, v145, v131
    s_waitcnt lgkmcnt(6)
    v_mfma_f32_32x32x16_bf16 v[64:79], a[20:23], v[48:51], v[64:79]
    s_barrier
    ds_read_b128 a[12:15], v4 offset:32768
    ds_read_b128 a[16:19], v8 offset:32768
    v_lshlrev_b32 v128, 16, v48
    v_and_b32 v129, 0xffff0000, v48
    v_add_f32 v144, v144, v128
    v_mfma_f32_32x32x16_bf16 v[80:95], a[24:27], v[48:51], v[80:95]
    ds_read_b64_tr_b16 v[40:41], v20 offset:32768
    ds_read_b64_tr_b16 v[42:43], v20 offset:33792
    v_add_f32 v145, v145, v129
    v_lshlrev_b32 v130, 16, v49
    v_and_b32 v131, 0xffff0000, v49
    s_cmp_eq_u32 s100, 3
    s_cbranch_scc0 L_wo_20
    s_lshr_b32 s75, s2, 3
    v_lshlrev_b32 v166, 5, v1
    v_add_u32 v166, s75, v166
    v_lshlrev_b32 v166, 21, v166
    s_mov_b64 exec, 0x1
    buffer_load_dword v167, v166, s[80:83], 0 offen sc1
    s_mov_b64 exec, 3
    s_mov_b32 s8, s92
    s_mov_b32 s9, s93
    s_and_b32 s9, s9, 0xffff
    s_mov_b32 s10, 0x21c000
    s_mov_b32 s11, 0x20000
    buffer_load_dword v167, v166, s[8:11], 0 offen sc1
    s_mov_b32 s8, s94
    s_mov_b32 s9, s95
    s_and_b32 s9, s9, 0xffff
    s_mov_b32 s10, 0x21c000
    s_mov_b32 s11, 0x20000
    buffer_load_dword v167, v166, s[8:11], 0 offen sc1
    s_mov_b32 s8, s88
    s_mov_b32 s9, s89
    s_and_b32 s9, s9, 0xffff
    s_mov_b32 s10, 0xc8000
    s_mov_b32 s11, 0x20000
    buffer_load_dword v167, v166, s[8:11], 0 offen sc1
    s_mov_b32 s8, s96
    s_mov_b32 s9, s97
    s_and_b32 s9, s9, 0xffff
    s_mov_b32 s10, 0x280000
    s_mov_b32 s11, 0x20000
    buffer_load_dword v167, v166, s[8:11], 0 offen sc1
    s_mov_b64 exec, -1
L_wo_20:
    v_mfma_f32_32x32x16_bf16 v[96:111], a[20:23], v[52:55], v[96:111]
    ds_read_b64_tr_b16 v[44:45], v21 offset:32768
    ds_read_b64_tr_b16 v[46:47], v21 offset:33792
    v_add_f32 v144, v144, v130
    v_add_f32 v145, v145, v131
    v_lshlrev_b32 v128, 16, v50
    v_and_b32 v129, 0xffff0000, v50
    v_mfma_f32_32x32x16_bf16 v[112:127], a[24:27], v[52:55], v[112:127]
    v_add_f32 v144, v144, v128
    v_add_f32 v145, v145, v129
    v_lshlrev_b32 v130, 16, v51
    v_and_b32 v131, 0xffff0000, v51
    v_add_f32 v144, v144, v130
    v_add_f32 v145, v145, v131
    s_waitcnt lgkmcnt(6)
    v_mfma_f32_32x32x16_bf16 v[64:79], a[4:7], v[32:35], v[64:79]
    ds_read_b128 a[20:23], v5 offset:32768
    ds_read_b128 a[24:27], v9 offset:32768
    v_lshlrev_b32 v128, 16, v32
    v_and_b32 v129, 0xffff0000, v32
    v_add_f32 v144, v144, v128
    v_mfma_f32_32x32x16_bf16 v[80:95], a[8:11], v[32:35], v[80:95]
    ds_read_b64_tr_b16 v[48:49], v20 offset:36864
    ds_read_b64_tr_b16 v[50:51], v20 offset:37888
    v_add_f32 v145, v145, v129
    v_lshlrev_b32 v130, 16, v33
    v_and_b32 v131, 0xffff0000, v33
    v_mfma_f32_32x32x16_bf16 v[96:111], a[4:7], v[36:39], v[96:111]
    ds_read_b64_tr_b16 v[52:53], v21 offset:36864
    ds_read_b64_tr_b16 v[54:55], v21 offset:37888
    v_add_f32 v144, v144, v130
    v_add_f32 v145, v145, v131
    v_lshlrev_b32 v128, 16, v34
    v_and_b32 v129, 0xffff0000, v34
    v_mfma_f32_32x32x16_bf16 v[112:127], a[8:11], v[36:39], v[112:127]
    v_add_f32 v144, v144, v128
    v_add_f32 v145, v145, v129
    v_lshlrev_b32 v130, 16, v35
    v_and_b32 v131, 0xffff0000, v35
    v_add_f32 v144, v144, v130
    v_add_f32 v145, v145, v131
    s_waitcnt lgkmcnt(6)
    v_mfma_f32_32x32x16_bf16 v[64:79], a[12:15], v[40:43], v[64:79]
    ds_read_b128 a[4:7], v6 offset:32768
    ds_read_b128 a[8:11], v10 offset:32768
    v_lshlrev_b32 v128, 16, v40
    v_and_b32 v129, 0xffff0000, v40
    v_add_f32 v144, v144, v128
    v_mfma_f32_32x32x16_bf16 v[80:95], a[16:19], v[40:43], v[80:95]
    ds_read_b64_tr_b16 v[32:33], v20 offset:40960
    ds_read_b64_tr_b16 v[34:35], v20 offset:41984
    v_add_f32 v145, v145, v129
    v_lshlrev_b32 v130, 16, v41
    v_and_b32 v131, 0xffff0000, v41
    v_mfma_f32_32x32x16_bf16 v[96:111], a[12:15], v[44:47], v[96:111]
    ds_read_b64_tr_b16 v[36:37], v21 offset:40960
    ds_read_b64_tr_b16 v[38:39], v21 offset:41984
    v_add_f32 v144, v144, v130
    v_add_f32 v145, v145, v131
    v_lshlrev_b32 v128, 16, v42
    v_and_b32 v129, 0xffff0000, v42
    v_mfma_f32_32x32x16_bf16 v[112:127], a[16:19], v[44:47], v[112:127]
    v_add_f32 v144, v144, v128
    v_add_f32 v145, v145, v129
    v_lshlrev_b32 v130, 16, v43
    v_and_b32 v131, 0xffff0000, v43
    v_add_f32 v144, v144, v130
    v_add_f32 v145, v145, v131
    s_waitcnt lgkmcnt(6)
    v_mfma_f32_32x32x16_bf16 v[64:79], a[20:23], v[48:51], v[64:79]
    ds_read_b128 a[12:15], v7 offset:32768
    ds_read_b128 a[16:19], v11 offset:32768
    v_lshlrev_b32 v128, 16, v48
    v_and_b32 v129, 0xffff0000, v48
    v_add_f32 v144, v144, v128
    v_mfma_f32_32x32x16_bf16 v[80:95], a[24:27], v[48:51], v[80:95]
    ds_read_b64_tr_b16 v[40:41], v20 offset:45056
    ds_read_b64_tr_b16 v[42:43], v20 offset:46080
    v_add_f32 v145, v145, v129
    v_lshlrev_b32 v130, 16, v49
    v_and_b32 v131, 0xffff0000, v49
    v_mfma_f32_32x32x16_bf16 v[96:111], a[20:23], v[52:55], v[96:111]
    ds_read_b64_tr_b16 v[44:45], v21 offset:45056
    ds_read_b64_tr_b16 v[46:47], v21 offset:46080
    v_add_f32 v144, v144, v130
    v_add_f32 v145, v145, v131
    v_lshlrev_b32 v128, 16, v50
    v_and_b32 v129, 0xffff0000, v50
    v_mfma_f32_32x32x16_bf16 v[112:127], a[24:27], v[52:55], v[112:127]
    v_add_f32 v144, v144, v128
    v_add_f32 v145, v145, v129
    v_lshlrev_b32 v130, 16, v51
    v_and_b32 v131, 0xffff0000, v51
    v_add_f32 v144, v144, v130
    v_add_f32 v145, v145, v131
    s_waitcnt lgkmcnt(6)
    v_mfma_f32_32x32x16_bf16 v[64:79], a[4:7], v[32:35], v[64:79]
    s_barrier
    ds_read_b128 a[20:23], v12 offset:0
    ds_read_b128 a[24:27], v16 offset:0
    v_lshlrev_b32 v128, 16, v32
    v_and_b32 v129, 0xffff0000, v32
    v_add_f32 v144, v144, v128
    v_mfma_f32_32x32x16_bf16 v[80:95], a[8:11], v[32:35], v[80:95]
    ds_read_b64_tr_b16 v[48:49], v22 offset:0
    ds_read_b64_tr_b16 v[50:51], v22 offset:1024
    v_add_f32 v145, v145, v129
    v_lshlrev_b32 v130, 16, v33
    v_and_b32 v131, 0xffff0000, v33
    v_mfma_f32_32x32x16_bf16 v[96:111], a[4:7], v[36:39], v[96:111]
    ds_read_b64_tr_b16 v[52:53], v23 offset:0
    ds_read_b64_tr_b16 v[54:55], v23 offset:1024
    v_add_f32 v144, v144, v130
    v_add_f32 v145, v145, v131
    v_lshlrev_b32 v128, 16, v34
    v_and_b32 v129, 0xffff0000, v34
    v_mfma_f32_32x32x16_bf16 v[112:127], a[8:11], v[36:39], v[112:127]
    v_add_f32 v144, v144, v128
    v_add_f32 v145, v145, v129
    v_lshlrev_b32 v130, 16, v35
    v_and_b32 v131, 0xffff0000, v35
    v_add_f32 v144, v144, v130
    v_add_f32 v145, v145, v131
    s_waitcnt lgkmcnt(6)
    v_mfma_f32_32x32x16_bf16 v[64:79], a[12:15], v[40:43], v[64:79]
    ds_read_b128 a[4:7], v13 offset:0
    ds_read_b128 a[8:11], v17 offset:0
    v_lshlrev_b32 v128, 16, v40
    v_and_b32 v129, 0xffff0000, v40
    v_add_f32 v144, v144, v128
    v_mfma_f32_32x32x16_bf16 v[80:95], a[16:19], v[40:43], v[80:95]
    ds_read_b64_tr_b16 v[32:33], v22 offset:4096
    ds_read_b64_tr_b16 v[34:35], v22 offset:5120
    v_add_f32 v145, v145, v129
    v_lshlrev_b32 v130, 16, v41
    v_and_b32 v131, 0xffff0000, v41
    v_mfma_f32_32x32x16_bf16 v[96:111], a[12:15], v[44:47], v[96:111]
    ds_read_b64_tr_b16 v[36:37], v23 offset:4096
    ds_read_b64_tr_b16 v[38:39], v23 offset:5120
    v_add_f32 v144, v144, v130
    v_add_f32 v145, v145, v131
    v_lshlrev_b32 v128, 16, v42
    v_and_b32 v129, 0xffff0000, v42
    v_mfma_f32_32x32x16_bf16 v[112:127], a[16:19], v[44:47], v[112:127]
    v_add_f32 v144, v144, v128
    v_add_f32 v145, v145, v129
    v_lshlrev_b32 v130, 16, v43
    v_and_b32 v131, 0xffff0000, v43
    v_add_f32 v144, v144, v130
    v_add_f32 v145, v145, v131
    s_waitcnt lgkmcnt(6)
    v_mfma_f32_32x32x16_bf16 v[64:79], a[20:23], v[48:51], v[64:79]
    ds_read_b128 a[12:15], v14 offset:0
    ds_read_b128 a[16:19], v18 offset:0
    v_lshlrev_b32 v128, 16, v48
    v_and_b32 v129, 0xffff0000, v48
    v_add_f32 v144, v144, v128
    v_mfma_f32_32x32x16_bf16 v[80:95], a[24:27], v[48:51], v[80:95]
    ds_read_b64_tr_b16 v[40:41], v22 offset:8192
    ds_read_b64_tr_b16 v[42:43], v22 offset:9216
    v_add_f32 v145, v145, v129
    v_lshlrev_b32 v130, 16, v49
    v_and_b32 v131, 0xffff0000, v49
    v_mfma_f32_32x32x16_bf16 v[96:111], a[20:23], v[52:55], v[96:111]
    ds_read_b64_tr_b16 v[44:45], v23 offset:8192
    ds_read_b64_tr_b16 v[46:47], v23 offset:9216
    v_add_f32 v144, v144, v130
    v_add_f32 v145, v145, v131
    v_lshlrev_b32 v128, 16, v50
    v_and_b32 v129, 0xffff0000, v50
    v_mfma_f32_32x32x16_bf16 v[112:127], a[24:27], v[52:55], v[112:127]
    v_add_f32 v144, v144, v128
    v_add_f32 v145, v145, v129
    v_lshlrev_b32 v130, 16, v51
    v_and_b32 v131, 0xffff0000, v51
    v_add_f32 v144, v144, v130
    v_add_f32 v145, v145, v131
    s_waitcnt lgkmcnt(6)
    v_mfma_f32_32x32x16_bf16 v[64:79], a[4:7], v[32:35], v[64:79]
    ds_read_b128 a[20:23], v15 offset:0
    ds_read_b128 a[24:27], v19 offset:0
    v_lshlrev_b32 v128, 16, v32
    v_and_b32 v129, 0xffff0000, v32
    v_add_f32 v144, v144, v128
    v_mfma_f32_32x32x16_bf16 v[80:95], a[8:11], v[32:35], v[80:95]
    ds_read_b64_tr_b16 v[48:49], v22 offset:12288
    ds_read_b64_tr_b16 v[50:51], v22 offset:13312
    v_add_f32 v145, v145, v129
    v_lshlrev_b32 v130, 16, v33
    v_and_b32 v131, 0xffff0000, v33
    v_mfma_f32_32x32x16_bf16 v[96:111], a[4:7], v[36:39], v[96:111]
    ds_read_b64_tr_b16 v[52:53], v23 offset:12288
    ds_read_b64_tr_b16 v[54:55], v23 offset:13312
    v_add_f32 v144, v144, v130
    v_add_f32 v145, v145, v131
    v_lshlrev_b32 v128, 16, v34
    v_and_b32 v129, 0xffff0000, v34
    v_mfma_f32_32x32x16_bf16 v[112:127], a[8:11], v[36:39], v[112:127]
    v_add_f32 v144, v144, v128
    v_add_f32 v145, v145, v129
    v_lshlrev_b32 v130, 16, v35
    v_and_b32 v131, 0xffff0000, v35
    v_add_f32 v144, v144, v130
    v_add_f32 v145, v145, v131
    s_waitcnt lgkmcnt(6)
    v_mfma_f32_32x32x16_bf16 v[64:79], a[12:15], v[40:43], v[64:79]
    s_barrier
    ds_read_b128 a[4:7], v12 offset:32768
    ds_read_b128 a[8:11], v16 offset:32768
    v_lshlrev_b32 v128, 16, v40
    v_and_b32 v129, 0xffff0000, v40
    v_add_f32 v144, v144, v128
    v_mfma_f32_32x32x16_bf16 v[80:95], a[16:19], v[40:43], v[80:95]
    ds_read_b64_tr_b16 v[32:33], v22 offset:32768
    ds_read_b64_tr_b16 v[34:35], v22 offset:33792
    v_add_f32 v145, v145, v129
    v_lshlrev_b32 v130, 16, v41
    v_and_b32 v131, 0xffff0000, v41
    v_mfma_f32_32x32x16_bf16 v[96:111], a[12:15], v[44:47], v[96:111]
    ds_read_b64_tr_b16 v[36:37], v23 offset:32768
    ds_read_b64_tr_b16 v[38:39], v23 offset:33792
    v_add_f32 v144, v144, v130
    v_add_f32 v145, v145, v131
    v_lshlrev_b32 v128, 16, v42
    v_and_b32 v129, 0xffff0000, v42
    v_mfma_f32_32x32x16_bf16 v[112:127], a[16:19], v[44:47], v[112:127]
    v_add_f32 v144, v144, v128
    v_add_f32 v145, v145, v129
    v_lshlrev_b32 v130, 16, v43
    v_and_b32 v131, 0xffff0000, v43
    v_add_f32 v144, v144, v130
    v_add_f32 v145, v145, v131
    s_waitcnt lgkmcnt(6)
    v_mfma_f32_32x32x16_bf16 v[64:79], a[20:23], v[48:51], v[64:79]
    ds_read_b128 a[12:15], v13 offset:32768
    ds_read_b128 a[16:19], v17 offset:32768
    v_lshlrev_b32 v128, 16, v48
    v_and_b32 v129, 0xffff0000, v48
    v_add_f32 v144, v144, v128
    v_mfma_f32_32x32x16_bf16 v[80:95], a[24:27], v[48:51], v[80:95]
    ds_read_b64_tr_b16 v[40:41], v22 offset:36864
    ds_read_b64_tr_b16 v[42:43], v22 offset:37888
    v_add_f32 v145, v145, v129
    v_lshlrev_b32 v130, 16, v49
    v_and_b32 v131, 0xffff0000, v49
    v_mfma_f32_32x32x16_bf16 v[96:111], a[20:23], v[52:55], v[96:111]
    ds_read_b64_tr_b16 v[44:45], v23 offset:36864
    ds_read_b64_tr_b16 v[46:47], v23 offset:37888
    v_add_f32 v144, v144, v130
    v_add_f32 v145, v145, v131
    v_lshlrev_b32 v128, 16, v50
    v_and_b32 v129, 0xffff0000, v50
    v_mfma_f32_32x32x16_bf16 v[112:127], a[24:27], v[52:55], v[112:127]
    v_add_f32 v144, v144, v128
    v_add_f32 v145, v145, v129
    v_lshlrev_b32 v130, 16, v51
    v_and_b32 v131, 0xffff0000, v51
    v_add_f32 v144, v144, v130
    v_add_f32 v145, v145, v131
    s_waitcnt lgkmcnt(6)
    v_mfma_f32_32x32x16_bf16 v[64:79], a[4:7], v[32:35], v[64:79]
    ds_read_b128 a[20:23], v14 offset:32768
    ds_read_b128 a[24:27], v18 offset:32768
    v_lshlrev_b32 v128, 16, v32
    v_and_b32 v129, 0xffff0000, v32
    v_add_f32 v144, v144, v128
    v_mfma_f32_32x32x16_bf16 v[80:95], a[8:11], v[32:35], v[80:95]
    ds_read_b64_tr_b16 v[48:49], v22 offset:40960
    ds_read_b64_tr_b16 v[50:51], v22 offset:41984
    v_add_f32 v145, v145, v129
    v_lshlrev_b32 v130, 16, v33
    v_and_b32 v131, 0xffff0000, v33
    v_mfma_f32_32x32x16_bf16 v[96:111], a[4:7], v[36:39], v[96:111]
    ds_read_b64_tr_b16 v[52:53], v23 offset:40960
    ds_read_b64_tr_b16 v[54:55], v23 offset:41984
    v_add_f32 v144, v144, v130
    v_add_f32 v145, v145, v131
    v_lshlrev_b32 v128, 16, v34
    v_and_b32 v129, 0xffff0000, v34
    v_mfma_f32_32x32x16_bf16 v[112:127], a[8:11], v[36:39], v[112:127]
    v_add_f32 v144, v144, v128
    v_add_f32 v145, v145, v129
    v_lshlrev_b32 v130, 16, v35
    v_and_b32 v131, 0xffff0000, v35
    v_add_f32 v144, v144, v130
    v_add_f32 v145, v145, v131
    s_waitcnt lgkmcnt(6)
    v_mfma_f32_32x32x16_bf16 v[64:79], a[12:15], v[40:43], v[64:79]
    ds_read_b128 a[4:7], v15 offset:32768
    ds_read_b128 a[8:11], v19 offset:32768
    v_lshlrev_b32 v128, 16, v40
    v_and_b32 v129, 0xffff0000, v40
    v_add_f32 v144, v144, v128
    v_mfma_f32_32x32x16_bf16 v[80:95], a[16:19], v[40:43], v[80:95]
    ds_read_b64_tr_b16 v[32:33], v22 offset:45056
    ds_read_b64_tr_b16 v[34:35], v22 offset:46080
    v_add_f32 v145, v145, v129
    v_lshlrev_b32 v130, 16, v41
    v_and_b32 v131, 0xffff0000, v41
    v_mfma_f32_32x32x16_bf16 v[96:111], a[12:15], v[44:47], v[96:111]
    ds_read_b64_tr_b16 v[36:37], v23 offset:45056
    ds_read_b64_tr_b16 v[38:39], v23 offset:46080
    v_add_f32 v144, v144, v130
    v_add_f32 v145, v145, v131
    v_lshlrev_b32 v128, 16, v42
    v_and_b32 v129, 0xffff0000, v42
    v_mfma_f32_32x32x16_bf16 v[112:127], a[16:19], v[44:47], v[112:127]
    v_add_f32 v144, v144, v128
    v_add_f32 v145, v145, v129
    v_lshlrev_b32 v130, 16, v43
    v_and_b32 v131, 0xffff0000, v43
    v_add_f32 v144, v144, v130
    v_add_f32 v145, v145, v131
    s_waitcnt lgkmcnt(6)
    v_mfma_f32_32x32x16_bf16 v[64:79], a[20:23], v[48:51], v[64:79]
    s_barrier
    ds_read_b128 a[12:15], v4 offset:0
    ds_read_b128 a[16:19], v8 offset:0
    v_lshlrev_b32 v128, 16, v48
    v_and_b32 v129, 0xffff0000, v48
    v_add_f32 v144, v144, v128
    v_mfma_f32_32x32x16_bf16 v[80:95], a[24:27], v[48:51], v[80:95]
    ds_read_b64_tr_b16 v[40:41], v20 offset:0
    ds_read_b64_tr_b16 v[42:43], v20 offset:1024
    v_add_f32 v145, v145, v129
    v_lshlrev_b32 v130, 16, v49
    v_and_b32 v131, 0xffff0000, v49
    s_cmp_eq_u32 s100, 3
    s_cbranch_scc0 L_wo_21
    v_lshlrev_b32 v166, 21, v1
    s_mov_b64 exec, 0xfff
    buffer_load_dword v167, v166, s[80:83], 0 offen sc1
    s_mov_b64 exec, -1
L_wo_21:
    v_mfma_f32_32x32x16_bf16 v[96:111], a[20:23], v[52:55], v[96:111]
    ds_read_b64_tr_b16 v[44:45], v21 offset:0
    ds_read_b64_tr_b16 v[46:47], v21 offset:1024
    v_add_f32 v144, v144, v130
    v_add_f32 v145, v145, v131
    v_lshlrev_b32 v128, 16, v50
    v_and_b32 v129, 0xffff0000, v50
    v_mfma_f32_32x32x16_bf16 v[112:127], a[24:27], v[52:55], v[112:127]
    v_add_f32 v144, v144, v128
    v_add_f32 v145, v145, v129
    v_lshlrev_b32 v130, 16, v51
    v_and_b32 v131, 0xffff0000, v51
    v_add_f32 v144, v144, v130
    v_add_f32 v145, v145, v131
    s_waitcnt lgkmcnt(6)
    v_mfma_f32_32x32x16_bf16 v[64:79], a[4:7], v[32:35], v[64:79]
    ds_read_b128 a[20:23], v5 offset:0
    ds_read_b128 a[24:27], v9 offset:0
    v_lshlrev_b32 v128, 16, v32
    v_and_b32 v129, 0xffff0000, v32
    v_add_f32 v144, v144, v128
    v_mfma_f32_32x32x16_bf16 v[80:95], a[8:11], v[32:35], v[80:95]
    ds_read_b64_tr_b16 v[48:49], v20 offset:4096
    ds_read_b64_tr_b16 v[50:51], v20 offset:5120
    v_add_f32 v145, v145, v129
    v_lshlrev_b32 v130, 16, v33
    v_and_b32 v131, 0xffff0000, v33
    v_mfma_f32_32x32x16_bf16 v[96:111], a[4:7], v[36:39], v[96:111]
    ds_read_b64_tr_b16 v[52:53], v21 offset:4096
    ds_read_b64_tr_b16 v[54:55], v21 offset:5120
    v_add_f32 v144, v144, v130
    v_add_f32 v145, v145, v131
    v_lshlrev_b32 v128, 16, v34
    v_and_b32 v129, 0xffff0000, v34
    v_mfma_f32_32x32x16_bf16 v[112:127], a[8:11], v[36:39], v[112:127]
    v_add_f32 v144, v144, v128
    v_add_f32 v145, v145, v129
    v_lshlrev_b32 v130, 16, v35
    v_and_b32 v131, 0xffff0000, v35
    v_add_f32 v144, v144, v130
    v_add_f32 v145, v145, v131
    s_waitcnt lgkmcnt(6)
    v_mfma_f32_32x32x16_bf16 v[64:79], a[12:15], v[40:43], v[64:79]
    ds_read_b128 a[4:7], v6 offset:0
    ds_read_b128 a[8:11], v10 offset:0
    v_lshlrev_b32 v128, 16, v40
    v_and_b32 v129, 0xffff0000, v40
    v_add_f32 v144, v144, v128
    v_mfma_f32_32x32x16_bf16 v[80:95], a[16:19], v[40:43], v[80:95]
    ds_read_b64_tr_b16 v[32:33], v20 offset:8192
    ds_read_b64_tr_b16 v[34:35], v20 offset:9216
    v_add_f32 v145, v145, v129
    v_lshlrev_b32 v130, 16, v41
    v_and_b32 v131, 0xffff0000, v41
    v_mfma_f32_32x32x16_bf16 v[96:111], a[12:15], v[44:47], v[96:111]
    ds_read_b64_tr_b16 v[36:37], v21 offset:8192
    ds_read_b64_tr_b16 v[38:39], v21 offset:9216
    v_add_f32 v144, v144, v130
    v_add_f32 v145, v145, v131
    v_lshlrev_b32 v128, 16, v42
    v_and_b32 v129, 0xffff0000, v42
    v_mfma_f32_32x32x16_bf16 v[112:127], a[16:19], v[44:47], v[112:127]
    v_add_f32 v144, v144, v128
    v_add_f32 v145, v145, v129
    v_lshlrev_b32 v130, 16, v43
    v_and_b32 v131, 0xffff0000, v43
    v_add_f32 v144, v144, v130
    v_add_f32 v145, v145, v131
    s_waitcnt lgkmcnt(6)
    v_mfma_f32_32x32x16_bf16 v[64:79], a[20:23], v[48:51], v[64:79]
    ds_read_b128 a[12:15], v7 offset:0
    ds_read_b128 a[16:19], v11 offset:0
    v_lshlrev_b32 v128, 16, v48
    v_and_b32 v129, 0xffff0000, v48
    v_add_f32 v144, v144, v128
    v_mfma_f32_32x32x16_bf16 v[80:95], a[24:27], v[48:51], v[80:95]
    ds_read_b64_tr_b16 v[40:41], v20 offset:12288
    ds_read_b64_tr_b16 v[42:43], v20 offset:13312
    v_add_f32 v145, v145, v129
    v_lshlrev_b32 v130, 16, v49
    v_and_b32 v131, 0xffff0000, v49
    v_mfma_f32_32x32x16_bf16 v[96:111], a[20:23], v[52:55], v[96:111]
    ds_read_b64_tr_b16 v[44:45], v21 offset:12288
    ds_read_b64_tr_b16 v[46:47], v21 offset:13312
    v_add_f32 v144, v144, v130
    v_add_f32 v145, v145, v131
    v_lshlrev_b32 v128, 16, v50
    v_and_b32 v129, 0xffff0000, v50
    v_mfma_f32_32x32x16_bf16 v[112:127], a[24:27], v[52:55], v[112:127]
    v_add_f32 v144, v144, v128
    v_add_f32 v145, v145, v129
    v_lshlrev_b32 v130, 16, v51
    v_and_b32 v131, 0xffff0000, v51
    v_add_f32 v144, v144, v130
    v_add_f32 v145, v145, v131
    s_waitcnt lgkmcnt(6)
    v_mfma_f32_32x32x16_bf16 v[64:79], a[4:7], v[32:35], v[64:79]
    s_barrier
    ds_read_b128 a[20:23], v4 offset:32768
    ds_read_b128 a[24:27], v8 offset:32768
    v_lshlrev_b32 v128, 16, v32
    v_and_b32 v129, 0xffff0000, v32
    v_add_f32 v144, v144, v128
    v_mfma_f32_32x32x16_bf16 v[80:95], a[8:11], v[32:35], v[80:95]
    ds_read_b64_tr_b16 v[48:49], v20 offset:32768
    ds_read_b64_tr_b16 v[50:51], v20 offset:33792
    v_add_f32 v145, v145, v129
    v_lshlrev_b32 v130, 16, v33
    v_and_b32 v131, 0xffff0000, v33
    v_mfma_f32_32x32x16_bf16 v[96:111], a[4:7], v[36:39], v[96:111]
    ds_read_b64_tr_b16 v[52:53], v21 offset:32768
    ds_read_b64_tr_b16 v[54:55], v21 offset:33792
    v_add_f32 v144, v144, v130
    v_add_f32 v145, v145, v131
    v_lshlrev_b32 v128, 16, v34
    v_and_b32 v129, 0xffff0000, v34
    v_mfma_f32_32x32x16_bf16 v[112:127], a[8:11], v[36:39], v[112:127]
    v_add_f32 v144, v144, v128
    v_add_f32 v145, v145, v129
    v_lshlrev_b32 v130, 16, v35
    v_and_b32 v131, 0xffff0000, v35
    v_add_f32 v144, v144, v130
    v_add_f32 v145, v145, v131
    s_waitcnt lgkmcnt(6)
    v_mfma_f32_32x32x16_bf16 v[64:79], a[12:15], v[40:43], v[64:79]
    ds_read_b128 a[4:7], v5 offset:32768
    ds_read_b128 a[8:11], v9 offset:32768
    v_lshlrev_b32 v128, 16, v40
    v_and_b32 v129, 0xffff0000, v40
    v_add_f32 v144, v144, v128
    v_mfma_f32_32x32x16_bf16 v[80:95], a[16:19], v[40:43], v[80:95]
    ds_read_b64_tr_b16 v[32:33], v20 offset:36864
    ds_read_b64_tr_b16 v[34:35], v20 offset:37888
    v_add_f32 v145, v145, v129
    v_lshlrev_b32 v130, 16, v41
    v_and_b32 v131, 0xffff0000, v41
    v_mfma_f32_32x32x16_bf16 v[96:111], a[12:15], v[44:47], v[96:111]
    ds_read_b64_tr_b16 v[36:37], v21 offset:36864
    ds_read_b64_tr_b16 v[38:39], v21 offset:37888
    v_add_f32 v144, v144, v130
    v_add_f32 v145, v145, v131
    v_lshlrev_b32 v128, 16, v42
    v_and_b32 v129, 0xffff0000, v42
    v_mfma_f32_32x32x16_bf16 v[112:127], a[16:19], v[44:47], v[112:127]
    v_add_f32 v144, v144, v128
    v_add_f32 v145, v145, v129
    v_lshlrev_b32 v130, 16, v43
    v_and_b32 v131, 0xffff0000, v43
    v_add_f32 v144, v144, v130
    v_add_f32 v145, v145, v131
    s_waitcnt lgkmcnt(6)
    v_mfma_f32_32x32x16_bf16 v[64:79], a[20:23], v[48:51], v[64:79]
    ds_read_b128 a[12:15], v6 offset:32768
    ds_read_b128 a[16:19], v10 offset:32768
    v_lshlrev_b32 v128, 16, v48
    v_and_b32 v129, 0xffff0000, v48
    v_add_f32 v144, v144, v128
    v_mfma_f32_32x32x16_bf16 v[80:95], a[24:27], v[48:51], v[80:95]
    ds_read_b64_tr_b16 v[40:41], v20 offset:40960
    ds_read_b64_tr_b16 v[42:43], v20 offset:41984
    v_add_f32 v145, v145, v129
    v_lshlrev_b32 v130, 16, v49
    v_and_b32 v131, 0xffff0000, v49
    v_mfma_f32_32x32x16_bf16 v[96:111], a[20:23], v[52:55], v[96:111]
    ds_read_b64_tr_b16 v[44:45], v21 offset:40960
    ds_read_b64_tr_b16 v[46:47], v21 offset:41984
    v_add_f32 v144, v144, v130
    v_add_f32 v145, v145, v131
    v_lshlrev_b32 v128, 16, v50
    v_and_b32 v129, 0xffff0000, v50
    v_mfma_f32_32x32x16_bf16 v[112:127], a[24:27], v[52:55], v[112:127]
    v_add_f32 v144, v144, v128
    v_add_f32 v145, v145, v129
    v_lshlrev_b32 v130, 16, v51
    v_and_b32 v131, 0xffff0000, v51
    v_add_f32 v144, v144, v130
    v_add_f32 v145, v145, v131
    s_waitcnt lgkmcnt(6)
    v_mfma_f32_32x32x16_bf16 v[64:79], a[4:7], v[32:35], v[64:79]
    ds_read_b128 a[20:23], v7 offset:32768
    ds_read_b128 a[24:27], v11 offset:32768
    v_lshlrev_b32 v128, 16, v32
    v_and_b32 v129, 0xffff0000, v32
    v_add_f32 v144, v144, v128
    v_mfma_f32_32x32x16_bf16 v[80:95], a[8:11], v[32:35], v[80:95]
    ds_read_b64_tr_b16 v[48:49], v20 offset:45056
    ds_read_b64_tr_b16 v[50:51], v20 offset:46080
    v_add_f32 v145, v145, v129
    v_lshlrev_b32 v130, 16, v33
    v_and_b32 v131, 0xffff0000, v33
    v_mfma_f32_32x32x16_bf16 v[96:111], a[4:7], v[36:39], v[96:111]
    ds_read_b64_tr_b16 v[52:53], v21 offset:45056
    ds_read_b64_tr_b16 v[54:55], v21 offset:46080
    v_add_f32 v144, v144, v130
    v_add_f32 v145, v145, v131
    v_lshlrev_b32 v128, 16, v34
    v_and_b32 v129, 0xffff0000, v34
    v_mfma_f32_32x32x16_bf16 v[112:127], a[8:11], v[36:39], v[112:127]
    v_add_f32 v144, v144, v128
    v_add_f32 v145, v145, v129
    v_lshlrev_b32 v130, 16, v35
    v_and_b32 v131, 0xffff0000, v35
    v_add_f32 v144, v144, v130
    v_add_f32 v145, v145, v131
    s_waitcnt lgkmcnt(6)
    v_mfma_f32_32x32x16_bf16 v[64:79], a[12:15], v[40:43], v[64:79]
    s_barrier
    ds_read_b128 a[4:7], v12 offset:0
    ds_read_b128 a[8:11], v16 offset:0
    v_lshlrev_b32 v128, 16, v40
    v_and_b32 v129, 0xffff0000, v40
    v_add_f32 v144, v144, v128
    v_mfma_f32_32x32x16_bf16 v[80:95], a[16:19], v[40:43], v[80:95]
    ds_read_b64_tr_b16 v[32:33], v22 offset:0
    ds_read_b64_tr_b16 v[34:35], v22 offset:1024
    v_add_f32 v145, v145, v129
    v_lshlrev_b32 v130, 16, v41
    v_and_b32 v131, 0xffff0000, v41
    v_mfma_f32_32x32x16_bf16 v[96:111], a[12:15], v[44:47], v[96:111]
    ds_read_b64_tr_b16 v[36:37], v23 offset:0
    ds_read_b64_tr_b16 v[38:39], v23 offset:1024
    v_add_f32 v144, v144, v130
    v_add_f32 v145, v145, v131
    v_lshlrev_b32 v128, 16, v42
    v_and_b32 v129, 0xffff0000, v42
    v_mfma_f32_32x32x16_bf16 v[112:127], a[16:19], v[44:47], v[112:127]
    v_add_f32 v144, v144, v128
    v_add_f32 v145, v145, v129
    v_lshlrev_b32 v130, 16, v43
    v_and_b32 v131, 0xffff0000, v43
    v_add_f32 v144, v144, v130
    v_add_f32 v145, v145, v131
    s_waitcnt lgkmcnt(6)
    v_mfma_f32_32x32x16_bf16 v[64:79], a[20:23], v[48:51], v[64:79]
    ds_read_b128 a[12:15], v13 offset:0
    ds_read_b128 a[16:19], v17 offset:0
    v_lshlrev_b32 v128, 16, v48
    v_and_b32 v129, 0xffff0000, v48
    v_add_f32 v144, v144, v128
    v_mfma_f32_32x32x16_bf16 v[80:95], a[24:27], v[48:51], v[80:95]
    ds_read_b64_tr_b16 v[40:41], v22 offset:4096
    ds_read_b64_tr_b16 v[42:43], v22 offset:5120
    v_add_f32 v145, v145, v129
    v_lshlrev_b32 v130, 16, v49
    v_and_b32 v131, 0xffff0000, v49
    v_mfma_f32_32x32x16_bf16 v[96:111], a[20:23], v[52:55], v[96:111]
    ds_read_b64_tr_b16 v[44:45], v23 offset:4096
    ds_read_b64_tr_b16 v[46:47], v23 offset:5120
    v_add_f32 v144, v144, v130
    v_add_f32 v145, v145, v131
    v_lshlrev_b32 v128, 16, v50
    v_and_b32 v129, 0xffff0000, v50
    v_mfma_f32_32x32x16_bf16 v[112:127], a[24:27], v[52:55], v[112:127]
    v_add_f32 v144, v144, v128
    v_add_f32 v145, v145, v129
    v_lshlrev_b32 v130, 16, v51
    v_and_b32 v131, 0xffff0000, v51
    v_add_f32 v144, v144, v130
    v_add_f32 v145, v145, v131
    s_waitcnt lgkmcnt(6)
    v_mfma_f32_32x32x16_bf16 v[64:79], a[4:7], v[32:35], v[64:79]
    ds_read_b128 a[20:23], v14 offset:0
    ds_read_b128 a[24:27], v18 offset:0
    v_lshlrev_b32 v128, 16, v32
    v_and_b32 v129, 0xffff0000, v32
    v_add_f32 v144, v144, v128
    v_mfma_f32_32x32x16_bf16 v[80:95], a[8:11], v[32:35], v[80:95]
    ds_read_b64_tr_b16 v[48:49], v22 offset:8192
    ds_read_b64_tr_b16 v[50:51], v22 offset:9216
    v_add_f32 v145, v145, v129
    v_lshlrev_b32 v130, 16, v33
    v_and_b32 v131, 0xffff0000, v33
    v_mfma_f32_32x32x16_bf16 v[96:111], a[4:7], v[36:39], v[96:111]
    ds_read_b64_tr_b16 v[52:53], v23 offset:8192
    ds_read_b64_tr_b16 v[54:55], v23 offset:9216
    v_add_f32 v144, v144, v130
    v_add_f32 v145, v145, v131
    v_lshlrev_b32 v128, 16, v34
    v_and_b32 v129, 0xffff0000, v34
    v_mfma_f32_32x32x16_bf16 v[112:127], a[8:11], v[36:39], v[112:127]
    v_add_f32 v144, v144, v128
    v_add_f32 v145, v145, v129
    v_lshlrev_b32 v130, 16, v35
    v_and_b32 v131, 0xffff0000, v35
    v_add_f32 v144, v144, v130
    v_add_f32 v145, v145, v131
    s_waitcnt lgkmcnt(6)
    v_mfma_f32_32x32x16_bf16 v[64:79], a[12:15], v[40:43], v[64:79]
    ds_read_b128 a[4:7], v15 offset:0
    ds_read_b128 a[8:11], v19 offset:0
    v_lshlrev_b32 v128, 16, v40
    v_and_b32 v129, 0xffff0000, v40
    v_add_f32 v144, v144, v128
    v_mfma_f32_32x32x16_bf16 v[80:95], a[16:19], v[40:43], v[80:95]
    ds_read_b64_tr_b16 v[32:33], v22 offset:12288
    ds_read_b64_tr_b16 v[34:35], v22 offset:13312
    v_add_f32 v145, v145, v129
    v_lshlrev_b32 v130, 16, v41
    v_and_b32 v131, 0xffff0000, v41
    v_mfma_f32_32x32x16_bf16 v[96:111], a[12:15], v[44:47], v[96:111]
    ds_read_b64_tr_b16 v[36:37], v23 offset:12288
    ds_read_b64_tr_b16 v[38:39], v23 offset:13312
    v_add_f32 v144, v144, v130
    v_add_f32 v145, v145, v131
    v_lshlrev_b32 v128, 16, v42
    v_and_b32 v129, 0xffff0000, v42
    v_mfma_f32_32x32x16_bf16 v[112:127], a[16:19], v[44:47], v[112:127]
    v_add_f32 v144, v144, v128
    v_add_f32 v145, v145, v129
    v_lshlrev_b32 v130, 16, v43
    v_and_b32 v131, 0xffff0000, v43
    v_add_f32 v144, v144, v130
    v_add_f32 v145, v145, v131
    s_waitcnt lgkmcnt(6)
    v_mfma_f32_32x32x16_bf16 v[64:79], a[20:23], v[48:51], v[64:79]
    s_barrier
    ds_read_b128 a[12:15], v12 offset:32768
    ds_read_b128 a[16:19], v16 offset:32768
    v_lshlrev_b32 v128, 16, v48
    v_and_b32 v129, 0xffff0000, v48
    v_add_f32 v144, v144, v128
    v_mfma_f32_32x32x16_bf16 v[80:95], a[24:27], v[48:51], v[80:95]
    ds_read_b64_tr_b16 v[40:41], v22 offset:32768
    ds_read_b64_tr_b16 v[42:43], v22 offset:33792
    v_add_f32 v145, v145, v129
    v_lshlrev_b32 v130, 16, v49
    v_and_b32 v131, 0xffff0000, v49
    v_mfma_f32_32x32x16_bf16 v[96:111], a[20:23], v[52:55], v[96:111]
    ds_read_b64_tr_b16 v[44:45], v23 offset:32768
    ds_read_b64_tr_b16 v[46:47], v23 offset:33792
    v_add_f32 v144, v144, v130
    v_add_f32 v145, v145, v131
    v_lshlrev_b32 v128, 16, v50
    v_and_b32 v129, 0xffff0000, v50
    v_mfma_f32_32x32x16_bf16 v[112:127], a[24:27], v[52:55], v[112:127]
    v_add_f32 v144, v144, v128
    v_add_f32 v145, v145, v129
    v_lshlrev_b32 v130, 16, v51
    v_and_b32 v131, 0xffff0000, v51
    v_add_f32 v144, v144, v130
    v_add_f32 v145, v145, v131
    s_waitcnt lgkmcnt(6)
    v_mfma_f32_32x32x16_bf16 v[64:79], a[4:7], v[32:35], v[64:79]
    ds_read_b128 a[20:23], v13 offset:32768
    ds_read_b128 a[24:27], v17 offset:32768
    v_lshlrev_b32 v128, 16, v32
    v_and_b32 v129, 0xffff0000, v32
    v_add_f32 v144, v144, v128
    v_mfma_f32_32x32x16_bf16 v[80:95], a[8:11], v[32:35], v[80:95]
    ds_read_b64_tr_b16 v[48:49], v22 offset:36864
    ds_read_b64_tr_b16 v[50:51], v22 offset:37888
    v_add_f32 v145, v145, v129
    v_lshlrev_b32 v130, 16, v33
    v_and_b32 v131, 0xffff0000, v33
    v_mfma_f32_32x32x16_bf16 v[96:111], a[4:7], v[36:39], v[96:111]
    ds_read_b64_tr_b16 v[52:53], v23 offset:36864
    ds_read_b64_tr_b16 v[54:55], v23 offset:37888
    v_add_f32 v144, v144, v130
    v_add_f32 v145, v145, v131
    v_lshlrev_b32 v128, 16, v34
    v_and_b32 v129, 0xffff0000, v34
    v_mfma_f32_32x32x16_bf16 v[112:127], a[8:11], v[36:39], v[112:127]
    v_add_f32 v144, v144, v128
    v_add_f32 v145, v145, v129
    v_lshlrev_b32 v130, 16, v35
    v_and_b32 v131, 0xffff0000, v35
    v_add_f32 v144, v144, v130
    v_add_f32 v145, v145, v131
    s_waitcnt lgkmcnt(6)
    v_mfma_f32_32x32x16_bf16 v[64:79], a[12:15], v[40:43], v[64:79]
    ds_read_b128 a[4:7], v14 offset:32768
    ds_read_b128 a[8:11], v18 offset:32768
    v_lshlrev_b32 v128, 16, v40
    v_and_b32 v129, 0xffff0000, v40
    v_add_f32 v144, v144, v128
    v_mfma_f32_32x32x16_bf16 v[80:95], a[16:19], v[40:43], v[80:95]
    ds_read_b64_tr_b16 v[32:33], v22 offset:40960
    ds_read_b64_tr_b16 v[34:35], v22 offset:41984
    v_add_f32 v145, v145, v129
    v_lshlrev_b32 v130, 16, v41
    v_and_b32 v131, 0xffff0000, v41
    v_mfma_f32_32x32x16_bf16 v[96:111], a[12:15], v[44:47], v[96:111]
    ds_read_b64_tr_b16 v[36:37], v23 offset:40960
    ds_read_b64_tr_b16 v[38:39], v23 offset:41984
    v_add_f32 v144, v144, v130
    v_add_f32 v145, v145, v131
    v_lshlrev_b32 v128, 16, v42
    v_and_b32 v129, 0xffff0000, v42
    v_mfma_f32_32x32x16_bf16 v[112:127], a[16:19], v[44:47], v[112:127]
    v_add_f32 v144, v144, v128
    v_add_f32 v145, v145, v129
    v_lshlrev_b32 v130, 16, v43
    v_and_b32 v131, 0xffff0000, v43
    v_add_f32 v144, v144, v130
    v_add_f32 v145, v145, v131
    s_waitcnt lgkmcnt(6)
    v_mfma_f32_32x32x16_bf16 v[64:79], a[20:23], v[48:51], v[64:79]
    ds_read_b128 a[12:15], v15 offset:32768
    ds_read_b128 a[16:19], v19 offset:32768
    v_lshlrev_b32 v128, 16, v48
    v_and_b32 v129, 0xffff0000, v48
    v_add_f32 v144, v144, v128
    v_mfma_f32_32x32x16_bf16 v[80:95], a[24:27], v[48:51], v[80:95]
    ds_read_b64_tr_b16 v[40:41], v22 offset:45056
    ds_read_b64_tr_b16 v[42:43], v22 offset:46080
    v_add_f32 v145, v145, v129
    v_lshlrev_b32 v130, 16, v49
    v_and_b32 v131, 0xffff0000, v49
    v_mfma_f32_32x32x16_bf16 v[96:111], a[20:23], v[52:55], v[96:111]
    ds_read_b64_tr_b16 v[44:45], v23 offset:45056
    ds_read_b64_tr_b16 v[46:47], v23 offset:46080
    v_add_f32 v144, v144, v130
    v_add_f32 v145, v145, v131
    v_lshlrev_b32 v128, 16, v50
    v_and_b32 v129, 0xffff0000, v50
    v_mfma_f32_32x32x16_bf16 v[112:127], a[24:27], v[52:55], v[112:127]
    v_add_f32 v144, v144, v128
    v_add_f32 v145, v145, v129
    v_lshlrev_b32 v130, 16, v51
    v_and_b32 v131, 0xffff0000, v51
    v_add_f32 v144, v144, v130
    v_add_f32 v145, v145, v131
    s_waitcnt lgkmcnt(6)
    v_mfma_f32_32x32x16_bf16 v[64:79], a[4:7], v[32:35], v[64:79]
    s_barrier
    ds_read_b128 a[20:23], v4 offset:0
    ds_read_b128 a[24:27], v8 offset:0
    v_lshlrev_b32 v128, 16, v32
    v_and_b32 v129, 0xffff0000, v32
    v_add_f32 v144, v144, v128
    v_mfma_f32_32x32x16_bf16 v[80:95], a[8:11], v[32:35], v[80:95]
    ds_read_b64_tr_b16 v[48:49], v20 offset:0
    ds_read_b64_tr_b16 v[50:51], v20 offset:1024
    v_add_f32 v145, v145, v129
    v_lshlrev_b32 v130, 16, v33
    v_and_b32 v131, 0xffff0000, v33
    v_mfma_f32_32x32x16_bf16 v[96:111], a[4:7], v[36:39], v[96:111]
    ds_read_b64_tr_b16 v[52:53], v21 offset:0
    ds_read_b64_tr_b16 v[54:55], v21 offset:1024
    v_add_f32 v144, v144, v130
    v_add_f32 v145, v145, v131
    v_lshlrev_b32 v128, 16, v34
    v_and_b32 v129, 0xffff0000, v34
    v_mfma_f32_32x32x16_bf16 v[112:127], a[8:11], v[36:39], v[112:127]
    v_add_f32 v144, v144, v128
    v_add_f32 v145, v145, v129
    v_lshlrev_b32 v130, 16, v35
    v_and_b32 v131, 0xffff0000, v35
    v_add_f32 v144, v144, v130
    v_add_f32 v145, v145, v131
    s_waitcnt lgkmcnt(6)
    v_mfma_f32_32x32x16_bf16 v[64:79], a[12:15], v[40:43], v[64:79]
    ds_read_b128 a[4:7], v5 offset:0
    ds_read_b128 a[8:11], v9 offset:0
    v_lshlrev_b32 v128, 16, v40
    v_and_b32 v129, 0xffff0000, v40
    v_add_f32 v144, v144, v128
    v_mfma_f32_32x32x16_bf16 v[80:95], a[16:19], v[40:43], v[80:95]
    ds_read_b64_tr_b16 v[32:33], v20 offset:4096
    ds_read_b64_tr_b16 v[34:35], v20 offset:5120
    v_add_f32 v145, v145, v129
    v_lshlrev_b32 v130, 16, v41
    v_and_b32 v131, 0xffff0000, v41
    v_mfma_f32_32x32x16_bf16 v[96:111], a[12:15], v[44:47], v[96:111]
    ds_read_b64_tr_b16 v[36:37], v21 offset:4096
    ds_read_b64_tr_b16 v[38:39], v21 offset:5120
    v_add_f32 v144, v144, v130
    v_add_f32 v145, v145, v131
    v_lshlrev_b32 v128, 16, v42
    v_and_b32 v129, 0xffff0000, v42
    v_mfma_f32_32x32x16_bf16 v[112:127], a[16:19], v[44:47], v[112:127]
    v_add_f32 v144, v144, v128
    v_add_f32 v145, v145, v129
    v_lshlrev_b32 v130, 16, v43
    v_and_b32 v131, 0xffff0000, v43
    v_add_f32 v144, v144, v130
    v_add_f32 v145, v145, v131
    s_waitcnt lgkmcnt(6)
    v_mfma_f32_32x32x16_bf16 v[64:79], a[20:23], v[48:51], v[64:79]
    ds_read_b128 a[12:15], v6 offset:0
    ds_read_b128 a[16:19], v10 offset:0
    v_lshlrev_b32 v128, 16, v48
    v_and_b32 v129, 0xffff0000, v48
    v_add_f32 v144, v144, v128
    v_mfma_f32_32x32x16_bf16 v[80:95], a[24:27], v[48:51], v[80:95]
    ds_read_b64_tr_b16 v[40:41], v20 offset:8192
    ds_read_b64_tr_b16 v[42:43], v20 offset:9216
    v_add_f32 v145, v145, v129
    v_lshlrev_b32 v130, 16, v49
    v_and_b32 v131, 0xffff0000, v49
    v_mfma_f32_32x32x16_bf16 v[96:111], a[20:23], v[52:55], v[96:111]
    ds_read_b64_tr_b16 v[44:45], v21 offset:8192
    ds_read_b64_tr_b16 v[46:47], v21 offset:9216
    v_add_f32 v144, v144, v130
    v_add_f32 v145, v145, v131
    v_lshlrev_b32 v128, 16, v50
    v_and_b32 v129, 0xffff0000, v50
    v_mfma_f32_32x32x16_bf16 v[112:127], a[24:27], v[52:55], v[112:127]
    v_add_f32 v144, v144, v128
    v_add_f32 v145, v145, v129
    v_lshlrev_b32 v130, 16, v51
    v_and_b32 v131, 0xffff0000, v51
    v_add_f32 v144, v144, v130
    v_add_f32 v145, v145, v131
    s_waitcnt lgkmcnt(6)
    v_mfma_f32_32x32x16_bf16 v[64:79], a[4:7], v[32:35], v[64:79]
    ds_read_b128 a[20:23], v7 offset:0
    ds_read_b128 a[24:27], v11 offset:0
    v_lshlrev_b32 v128, 16, v32
    v_and_b32 v129, 0xffff0000, v32
    v_add_f32 v144, v144, v128
    v_mfma_f32_32x32x16_bf16 v[80:95], a[8:11], v[32:35], v[80:95]
    ds_read_b64_tr_b16 v[48:49], v20 offset:12288
    ds_read_b64_tr_b16 v[50:51], v20 offset:13312
    v_add_f32 v145, v145, v129
    v_lshlrev_b32 v130, 16, v33
    v_and_b32 v131, 0xffff0000, v33
    v_mfma_f32_32x32x16_bf16 v[96:111], a[4:7], v[36:39], v[96:111]
    ds_read_b64_tr_b16 v[52:53], v21 offset:12288
    ds_read_b64_tr_b16 v[54:55], v21 offset:13312
    v_add_f32 v144, v144, v130
    v_add_f32 v145, v145, v131
    v_lshlrev_b32 v128, 16, v34
    v_and_b32 v129, 0xffff0000, v34
    v_mfma_f32_32x32x16_bf16 v[112:127], a[8:11], v[36:39], v[112:127]
    v_add_f32 v144, v144, v128
    v_add_f32 v145, v145, v129
    v_lshlrev_b32 v130, 16, v35
    v_and_b32 v131, 0xffff0000, v35
    v_add_f32 v144, v144, v130
    v_add_f32 v145, v145, v131
    s_waitcnt lgkmcnt(6)
    v_mfma_f32_32x32x16_bf16 v[64:79], a[12:15], v[40:43], v[64:79]
    s_barrier
    ds_read_b128 a[4:7], v4 offset:32768
    ds_read_b128 a[8:11], v8 offset:32768
    v_lshlrev_b32 v128, 16, v40
    v_and_b32 v129, 0xffff0000, v40
    v_add_f32 v144, v144, v128
    v_mfma_f32_32x32x16_bf16 v[80:95], a[16:19], v[40:43], v[80:95]
    ds_read_b64_tr_b16 v[32:33], v20 offset:32768
    ds_read_b64_tr_b16 v[34:35], v20 offset:33792
    v_add_f32 v145, v145, v129
    v_lshlrev_b32 v130, 16, v41
    v_and_b32 v131, 0xffff0000, v41
    v_mfma_f32_32x32x16_bf16 v[96:111], a[12:15], v[44:47], v[96:111]
    ds_read_b64_tr_b16 v[36:37], v21 offset:32768
    ds_read_b64_tr_b16 v[38:39], v21 offset:33792
    v_add_f32 v144, v144, v130
    v_add_f32 v145, v145, v131
    v_lshlrev_b32 v128, 16, v42
    v_and_b32 v129, 0xffff0000, v42
    v_mfma_f32_32x32x16_bf16 v[112:127], a[16:19], v[44:47], v[112:127]
    v_add_f32 v144, v144, v128
    v_add_f32 v145, v145, v129
    v_lshlrev_b32 v130, 16, v43
    v_and_b32 v131, 0xffff0000, v43
    v_add_f32 v144, v144, v130
    v_add_f32 v145, v145, v131
    s_waitcnt lgkmcnt(6)
    v_mfma_f32_32x32x16_bf16 v[64:79], a[20:23], v[48:51], v[64:79]
    ds_read_b128 a[12:15], v5 offset:32768
    ds_read_b128 a[16:19], v9 offset:32768
    v_lshlrev_b32 v128, 16, v48
    v_and_b32 v129, 0xffff0000, v48
    v_add_f32 v144, v144, v128
    v_mfma_f32_32x32x16_bf16 v[80:95], a[24:27], v[48:51], v[80:95]
    ds_read_b64_tr_b16 v[40:41], v20 offset:36864
    ds_read_b64_tr_b16 v[42:43], v20 offset:37888
    v_add_f32 v145, v145, v129
    v_lshlrev_b32 v130, 16, v49
    v_and_b32 v131, 0xffff0000, v49
    v_mfma_f32_32x32x16_bf16 v[96:111], a[20:23], v[52:55], v[96:111]
    ds_read_b64_tr_b16 v[44:45], v21 offset:36864
    ds_read_b64_tr_b16 v[46:47], v21 offset:37888
    v_add_f32 v144, v144, v130
    v_add_f32 v145, v145, v131
    v_lshlrev_b32 v128, 16, v50
    v_and_b32 v129, 0xffff0000, v50
    v_mfma_f32_32x32x16_bf16 v[112:127], a[24:27], v[52:55], v[112:127]
    v_add_f32 v144, v144, v128
    v_add_f32 v145, v145, v129
    v_lshlrev_b32 v130, 16, v51
    v_and_b32 v131, 0xffff0000, v51
    v_add_f32 v144, v144, v130
    v_add_f32 v145, v145, v131
    s_waitcnt lgkmcnt(6)
    v_mfma_f32_32x32x16_bf16 v[64:79], a[4:7], v[32:35], v[64:79]
    ds_read_b128 a[20:23], v6 offset:32768
    ds_read_b128 a[24:27], v10 offset:32768
    v_lshlrev_b32 v128, 16, v32
    v_and_b32 v129, 0xffff0000, v32
    v_add_f32 v144, v144, v128
    v_mfma_f32_32x32x16_bf16 v[80:95], a[8:11], v[32:35], v[80:95]
    ds_read_b64_tr_b16 v[48:49], v20 offset:40960
    ds_read_b64_tr_b16 v[50:51], v20 offset:41984
    v_add_f32 v145, v145, v129
    v_lshlrev_b32 v130, 16, v33
    v_and_b32 v131, 0xffff0000, v33
    v_mfma_f32_32x32x16_bf16 v[96:111], a[4:7], v[36:39], v[96:111]
    ds_read_b64_tr_b16 v[52:53], v21 offset:40960
    ds_read_b64_tr_b16 v[54:55], v21 offset:41984
    v_add_f32 v144, v144, v130
    v_add_f32 v145, v145, v131
    v_lshlrev_b32 v128, 16, v34
    v_and_b32 v129, 0xffff0000, v34
    v_mfma_f32_32x32x16_bf16 v[112:127], a[8:11], v[36:39], v[112:127]
    v_add_f32 v144, v144, v128
    v_add_f32 v145, v145, v129
    v_lshlrev_b32 v130, 16, v35
    v_and_b32 v131, 0xffff0000, v35
    v_add_f32 v144, v144, v130
    v_add_f32 v145, v145, v131
    s_waitcnt lgkmcnt(6)
    v_mfma_f32_32x32x16_bf16 v[64:79], a[12:15], v[40:43], v[64:79]
    ds_read_b128 a[4:7], v7 offset:32768
    ds_read_b128 a[8:11], v11 offset:32768
    v_lshlrev_b32 v128, 16, v40
    v_and_b32 v129, 0xffff0000, v40
    v_add_f32 v144, v144, v128
    v_mfma_f32_32x32x16_bf16 v[80:95], a[16:19], v[40:43], v[80:95]
    ds_read_b64_tr_b16 v[32:33], v20 offset:45056
    ds_read_b64_tr_b16 v[34:35], v20 offset:46080
    v_add_f32 v145, v145, v129
    v_lshlrev_b32 v130, 16, v41
    v_and_b32 v131, 0xffff0000, v41
    v_mfma_f32_32x32x16_bf16 v[96:111], a[12:15], v[44:47], v[96:111]
    ds_read_b64_tr_b16 v[36:37], v21 offset:45056
    ds_read_b64_tr_b16 v[38:39], v21 offset:46080
    v_add_f32 v144, v144, v130
    v_add_f32 v145, v145, v131
    v_lshlrev_b32 v128, 16, v42
    v_and_b32 v129, 0xffff0000, v42
    v_mfma_f32_32x32x16_bf16 v[112:127], a[16:19], v[44:47], v[112:127]
    v_add_f32 v144, v144, v128
    v_add_f32 v145, v145, v129
    v_lshlrev_b32 v130, 16, v43
    v_and_b32 v131, 0xffff0000, v43
    v_add_f32 v144, v144, v130
    v_add_f32 v145, v145, v131
    s_waitcnt lgkmcnt(6)
    v_mfma_f32_32x32x16_bf16 v[64:79], a[20:23], v[48:51], v[64:79]
    v_lshlrev_b32 v128, 16, v48
    v_and_b32 v129, 0xffff0000, v48
    v_add_f32 v144, v144, v128
    v_mfma_f32_32x32x16_bf16 v[80:95], a[24:27], v[48:51], v[80:95]
    v_add_f32 v145, v145, v129
    v_lshlrev_b32 v130, 16, v49
    v_and_b32 v131, 0xffff0000, v49
    v_mfma_f32_32x32x16_bf16 v[96:111], a[20:23], v[52:55], v[96:111]
    v_add_f32 v144, v144, v130
    v_add_f32 v145, v145, v131
    v_lshlrev_b32 v128, 16, v50
    v_and_b32 v129, 0xffff0000, v50
    v_mfma_f32_32x32x16_bf16 v[112:127], a[24:27], v[52:55], v[112:127]
    v_add_f32 v144, v144, v128
    v_add_f32 v145, v145, v129
    v_lshlrev_b32 v130, 16, v51
    v_and_b32 v131, 0xffff0000, v51
    v_add_f32 v144, v144, v130
    v_add_f32 v145, v145, v131
    s_waitcnt lgkmcnt(0)
    v_mfma_f32_32x32x16_bf16 v[64:79], a[4:7], v[32:35], v[64:79]
    v_lshlrev_b32 v128, 16, v32
    v_and_b32 v129, 0xffff0000, v32
    v_add_f32 v144, v144, v128
    v_mfma_f32_32x32x16_bf16 v[80:95], a[8:11], v[32:35], v[80:95]
    v_add_f32 v145, v145, v129
    v_lshlrev_b32 v130, 16, v33
    v_and_b32 v131, 0xffff0000, v33
    v_mfma_f32_32x32x16_bf16 v[96:111], a[4:7], v[36:39], v[96:111]
    v_add_f32 v144, v144, v130
    v_add_f32 v145, v145, v131
    v_lshlrev_b32 v128, 16, v34
    v_and_b32 v129, 0xffff0000, v34
    v_mfma_f32_32x32x16_bf16 v[112:127], a[8:11], v[36:39], v[112:127]
    v_add_f32 v144, v144, v128
    v_add_f32 v145, v145, v129
    v_lshlrev_b32 v130, 16, v35
    v_and_b32 v131, 0xffff0000, v35
    v_add_f32 v144, v144, v130
    v_add_f32 v145, v145, v131
    v_add_f32 v144, v144, v145
    s_nop 0
    v_mov_b32 v145, v144
    s_nop 1
    v_permlane32_swap_b32 v144, v145
    s_nop 1
    v_add_f32 v144, v144, v145
    s_lshl_b32 s23, s33, 8
    s_lshl_b32 s24, s32, 7
    s_add_u32 s23, s23, s24
    s_add_u32 s23, s23, 146432
    v_lshlrev_b32 v158, 2, v2
    v_add_u32 v159, s23, v158
    ds_write_b32 v159, v144
    s_waitcnt lgkmcnt(0)
    s_barrier
    s_lshl_b32 s24, s33, 8
    s_add_u32 s23, s24, 146432
    s_xor_b32 s24, s32, 0
    s_lshl_b32 s24, s24, 7
    s_add_u32 s23, s23, s24
    v_lshlrev_b32 v132, 2, v2
    v_add_u32 v132, s23, v132
    ds_read_b32 v128, v132
    s_lshl_b32 s24, s33, 8
    s_add_u32 s23, s24, 146432
    s_xor_b32 s24, s32, 1
    s_lshl_b32 s24, s24, 7
    s_add_u32 s23, s23, s24
    v_lshlrev_b32 v132, 2, v2
    v_add_u32 v132, s23, v132
    ds_read_b32 v129, v132
    s_lshl_b32 s24, s32, 8
    s_add_u32 s23, s24, 145408
    s_xor_b32 s24, s33, 0
    s_lshl_b32 s24, s24, 7
    s_add_u32 s23, s23, s24
    v_lshlrev_b32 v132, 4, v3
    v_add_u32 v132, s23, v132
    ds_read_b128 v[32:35], v132 offset:0
    ds_read_b128 v[48:51], v132 offset:512
    ds_read_b128 v[36:39], v132 offset:32
    ds_read_b128 v[52:55], v132 offset:544
    ds_read_b128 v[40:43], v132 offset:64
    ds_read_b128 v[56:59], v132 offset:576
    ds_read_b128 v[44:47], v132 offset:96
    ds_read_b128 v[60:63], v132 offset:608
    s_waitcnt lgkmcnt(0)
    v_mov_b32 v146, v128
    v_mov_b32 v147, v128
    v_mov_b32 v148, v129
    v_mov_b32 v149, v129
    v_pk_fma_f32 v[64:65], v[32:33], v[146:147], v[64:65] neg_lo:[1,0,0] neg_hi:[1,0,0]
    v_pk_fma_f32 v[66:67], v[34:35], v[146:147], v[66:67] neg_lo:[1,0,0] neg_hi:[1,0,0]
    v_pk_fma_f32 v[68:69], v[36:37], v[146:147], v[68:69] neg_lo:[1,0,0] neg_hi:[1,0,0]
    v_pk_fma_f32 v[70:71], v[38:39], v[146:147], v[70:71] neg_lo:[1,0,0] neg_hi:[1,0,0]
    v_pk_fma_f32 v[72:73], v[40:41], v[146:147], v[72:73] neg_lo:[1,0,0] neg_hi:[1,0,0]
    v_pk_fma_f32 v[74:75], v[42:43], v[146:147], v[74:75] neg_lo:[1,0,0] neg_hi:[1,0,0]
    v_pk_fma_f32 v[76:77], v[44:45], v[146:147], v[76:77] neg_lo:[1,0,0] neg_hi:[1,0,0]
    v_pk_fma_f32 v[78:79], v[46:47], v[146:147], v[78:79] neg_lo:[1,0,0] neg_hi:[1,0,0]
    v_pk_mul_f32 v[64:65], v[64:65], v[48:49]
    v_pk_mul_f32 v[66:67], v[66:67], v[50:51]
    v_pk_mul_f32 v[68:69], v[68:69], v[52:53]
    v_pk_mul_f32 v[70:71], v[70:71], v[54:55]
    v_pk_mul_f32 v[72:73], v[72:73], v[56:57]
    v_pk_mul_f32 v[74:75], v[74:75], v[58:59]
    v_pk_mul_f32 v[76:77], v[76:77], v[60:61]
    v_pk_mul_f32 v[78:79], v[78:79], v[62:63]
    v_cvt_pk_bf16_f32 v136, v64, v65
    v_cvt_pk_bf16_f32 v137, v66, v67
    v_cvt_pk_bf16_f32 v138, v68, v69
    v_cvt_pk_bf16_f32 v139, v70, v71
    buffer_store_dwordx4 v[136:139], v24, s[16:19], s40 offen sc1
    v_cvt_pk_bf16_f32 v140, v72, v73
    v_cvt_pk_bf16_f32 v141, v74, v75
    v_cvt_pk_bf16_f32 v142, v76, v77
    v_cvt_pk_bf16_f32 v143, v78, v79
    buffer_store_dwordx4 v[140:143], v24, s[16:19], s41 offen sc1
    v_pk_fma_f32 v[96:97], v[32:33], v[148:149], v[96:97] neg_lo:[1,0,0] neg_hi:[1,0,0]
    v_pk_fma_f32 v[98:99], v[34:35], v[148:149], v[98:99] neg_lo:[1,0,0] neg_hi:[1,0,0]
    v_pk_fma_f32 v[100:101], v[36:37], v[148:149], v[100:101] neg_lo:[1,0,0] neg_hi:[1,0,0]
    v_pk_fma_f32 v[102:103], v[38:39], v[148:149], v[102:103] neg_lo:[1,0,0] neg_hi:[1,0,0]
    v_pk_fma_f32 v[104:105], v[40:41], v[148:149], v[104:105] neg_lo:[1,0,0] neg_hi:[1,0,0]
    v_pk_fma_f32 v[106:107], v[42:43], v[148:149], v[106:107] neg_lo:[1,0,0] neg_hi:[1,0,0]
    v_pk_fma_f32 v[108:109], v[44:45], v[148:149], v[108:109] neg_lo:[1,0,0] neg_hi:[1,0,0]
    v_pk_fma_f32 v[110:111], v[46:47], v[148:149], v[110:111] neg_lo:[1,0,0] neg_hi:[1,0,0]
    v_pk_mul_f32 v[96:97], v[96:97], v[48:49]
    v_pk_mul_f32 v[98:99], v[98:99], v[50:51]
    v_pk_mul_f32 v[100:101], v[100:101], v[52:53]
    v_pk_mul_f32 v[102:103], v[102:103], v[54:55]
    v_pk_mul_f32 v[104:105], v[104:105], v[56:57]
    v_pk_mul_f32 v[106:107], v[106:107], v[58:59]
    v_pk_mul_f32 v[108:109], v[108:109], v[60:61]
    v_pk_mul_f32 v[110:111], v[110:111], v[62:63]
    v_cvt_pk_bf16_f32 v136, v96, v97
    v_cvt_pk_bf16_f32 v137, v98, v99
    v_cvt_pk_bf16_f32 v138, v100, v101
    v_cvt_pk_bf16_f32 v139, v102, v103
    buffer_store_dwordx4 v[136:139], v25, s[16:19], s40 offen sc1
    v_cvt_pk_bf16_f32 v140, v104, v105
    v_cvt_pk_bf16_f32 v141, v106, v107
    v_cvt_pk_bf16_f32 v142, v108, v109
    v_cvt_pk_bf16_f32 v143, v110, v111
    buffer_store_dwordx4 v[140:143], v25, s[16:19], s41 offen sc1
    s_lshl_b32 s24, s32, 8
    s_add_u32 s23, s24, 145408
    s_xor_b32 s24, s33, 1
    s_lshl_b32 s24, s24, 7
    s_add_u32 s23, s23, s24
    v_lshlrev_b32 v132, 4, v3
    v_add_u32 v132, s23, v132
    ds_read_b128 v[32:35], v132 offset:0
    ds_read_b128 v[48:51], v132 offset:512
    ds_read_b128 v[36:39], v132 offset:32
    ds_read_b128 v[52:55], v132 offset:544
    ds_read_b128 v[40:43], v132 offset:64
    ds_read_b128 v[56:59], v132 offset:576
    ds_read_b128 v[44:47], v132 offset:96
    ds_read_b128 v[60:63], v132 offset:608
    s_waitcnt lgkmcnt(0)
    v_pk_fma_f32 v[80:81], v[32:33], v[146:147], v[80:81] neg_lo:[1,0,0] neg_hi:[1,0,0]
    v_pk_fma_f32 v[82:83], v[34:35], v[146:147], v[82:83] neg_lo:[1,0,0] neg_hi:[1,0,0]
    v_pk_fma_f32 v[84:85], v[36:37], v[146:147], v[84:85] neg_lo:[1,0,0] neg_hi:[1,0,0]
    v_pk_fma_f32 v[86:87], v[38:39], v[146:147], v[86:87] neg_lo:[1,0,0] neg_hi:[1,0,0]
    v_pk_fma_f32 v[88:89], v[40:41], v[146:147], v[88:89] neg_lo:[1,0,0] neg_hi:[1,0,0]
    v_pk_fma_f32 v[90:91], v[42:43], v[146:147], v[90:91] neg_lo:[1,0,0] neg_hi:[1,0,0]
    v_pk_fma_f32 v[92:93], v[44:45], v[146:147], v[92:93] neg_lo:[1,0,0] neg_hi:[1,0,0]
    v_pk_fma_f32 v[94:95], v[46:47], v[146:147], v[94:95] neg_lo:[1,0,0] neg_hi:[1,0,0]
    v_pk_mul_f32 v[80:81], v[80:81], v[48:49]
    v_pk_mul_f32 v[82:83], v[82:83], v[50:51]
    v_pk_mul_f32 v[84:85], v[84:85], v[52:53]
    v_pk_mul_f32 v[86:87], v[86:87], v[54:55]
    v_pk_mul_f32 v[88:89], v[88:89], v[56:57]
    v_pk_mul_f32 v[90:91], v[90:91], v[58:59]
    v_pk_mul_f32 v[92:93], v[92:93], v[60:61]
    v_pk_mul_f32 v[94:95], v[94:95], v[62:63]
    v_cvt_pk_bf16_f32 v136, v80, v81
    v_cvt_pk_bf16_f32 v137, v82, v83
    v_cvt_pk_bf16_f32 v138, v84, v85
    v_cvt_pk_bf16_f32 v139, v86, v87
    buffer_store_dwordx4 v[136:139], v24, s[16:19], s42 offen sc1
    v_cvt_pk_bf16_f32 v140, v88, v89
    v_cvt_pk_bf16_f32 v141, v90, v91
    v_cvt_pk_bf16_f32 v142, v92, v93
    v_cvt_pk_bf16_f32 v143, v94, v95
    buffer_store_dwordx4 v[140:143], v24, s[16:19], s43 offen sc1
    v_pk_fma_f32 v[112:113], v[32:33], v[148:149], v[112:113] neg_lo:[1,0,0] neg_hi:[1,0,0]
    v_pk_fma_f32 v[114:115], v[34:35], v[148:149], v[114:115] neg_lo:[1,0,0] neg_hi:[1,0,0]
    v_pk_fma_f32 v[116:117], v[36:37], v[148:149], v[116:117] neg_lo:[1,0,0] neg_hi:[1,0,0]
    v_pk_fma_f32 v[118:119], v[38:39], v[148:149], v[118:119] neg_lo:[1,0,0] neg_hi:[1,0,0]
    v_pk_fma_f32 v[120:121], v[40:41], v[148:149], v[120:121] neg_lo:[1,0,0] neg_hi:[1,0,0]
    v_pk_fma_f32 v[122:123], v[42:43], v[148:149], v[122:123] neg_lo:[1,0,0] neg_hi:[1,0,0]
    v_pk_fma_f32 v[124:125], v[44:45], v[148:149], v[124:125] neg_lo:[1,0,0] neg_hi:[1,0,0]
    v_pk_fma_f32 v[126:127], v[46:47], v[148:149], v[126:127] neg_lo:[1,0,0] neg_hi:[1,0,0]
    v_pk_mul_f32 v[112:113], v[112:113], v[48:49]
    v_pk_mul_f32 v[114:115], v[114:115], v[50:51]
    v_pk_mul_f32 v[116:117], v[116:117], v[52:53]
    v_pk_mul_f32 v[118:119], v[118:119], v[54:55]
    v_pk_mul_f32 v[120:121], v[120:121], v[56:57]
    v_pk_mul_f32 v[122:123], v[122:123], v[58:59]
    v_pk_mul_f32 v[124:125], v[124:125], v[60:61]
    v_pk_mul_f32 v[126:127], v[126:127], v[62:63]
    v_cvt_pk_bf16_f32 v136, v112, v113
    v_cvt_pk_bf16_f32 v137, v114, v115
    v_cvt_pk_bf16_f32 v138, v116, v117
    v_cvt_pk_bf16_f32 v139, v118, v119
    buffer_store_dwordx4 v[136:139], v25, s[16:19], s42 offen sc1
    v_cvt_pk_bf16_f32 v140, v120, v121
    v_cvt_pk_bf16_f32 v141, v122, v123
    v_cvt_pk_bf16_f32 v142, v124, v125
    v_cvt_pk_bf16_f32 v143, v126, v127
    buffer_store_dwordx4 v[140:143], v25, s[16:19], s43 offen sc1
L_q_done:
    buffer_load_dword v170, v171, s[44:47], 0 offen sc1
    s_waitcnt vmcnt(0)
    s_barrier
    s_cmp_eq_u32 s100, 0
    s_cbranch_scc0 L_attn
    s_mov_b32 s101, 0
    s_branch L_dbgc_24
L_dbgp_22:
    s_waitcnt vmcnt(0)
L_dbgc_24:
    v_readfirstlane_b32 s75, v170
    s_cmp_lg_u32 s75, 0
    s_cbranch_scc1 L_dbgok_23
    s_add_u32 s101, s101, 1
    s_cmp_gt_u32 s101, 262144
    s_cbranch_scc1 L_dbgok_23
    s_sleep 1
    buffer_load_dword v170, v171, s[44:47], 0 offen sc1
    s_branch L_dbgp_22
L_dbgok_23:
    s_add_u32 s40, s34, 9
    s_lshl_b32 s101, s40, 7
    s_add_u32 s101, s101, 23814144
    v_mov_b32 v4, s101
    v_mov_b32 v5, 1
    s_mov_b64 exec, 1
    buffer_atomic_add v5, v4, s[80:83], 0 offen sc1
    s_mov_b64 exec, -1
    s_branch L_attn
L_repack:
    s_xor_b32 s40, s2, 225
    s_or_b32 s40, s40, s100
    s_cmp_eq_u32 s40, 0
    s_cbranch_scc0 L_zc_25
    v_mov_b32 v4, 0
    v_mov_b32 v5, 0
    v_mov_b32 v6, 0
    v_mov_b32 v7, 0
    v_lshlrev_b32 v8, 4, v1
    s_mov_b32 s40, 23814144
    buffer_store_dwordx4 v[4:7], v8, s[80:83], s40 offen sc1
    s_add_u32 s40, s40, 1024
    buffer_store_dwordx4 v[4:7], v8, s[80:83], s40 offen sc1
    s_add_u32 s40, s40, 1024
    buffer_store_dwordx4 v[4:7], v8, s[80:83], s40 offen sc1
    s_add_u32 s40, s40, 1024
    buffer_store_dwordx4 v[4:7], v8, s[80:83], s40 offen sc1
    s_add_u32 s40, s40, 1024
    buffer_store_dwordx4 v[4:7], v8, s[80:83], s40 offen sc1
    s_add_u32 s40, s40, 1024
    buffer_store_dwordx4 v[4:7], v8, s[80:83], s40 offen sc1
    s_add_u32 s40, s40, 1024
    buffer_store_dwordx4 v[4:7], v8, s[80:83], s40 offen sc1
    s_add_u32 s40, s40, 1024
    buffer_store_dwordx4 v[4:7], v8, s[80:83], s40 offen sc1
    s_add_u32 s40, s40, 1024
    buffer_store_dwordx4 v[4:7], v8, s[80:83], s40 offen sc1
    s_add_u32 s40, s40, 1024
    buffer_store_dwordx4 v[4:7], v8, s[80:83], s40 offen sc1
    s_add_u32 s40, s40, 1024
    buffer_store_dwordx4 v[4:7], v8, s[80:83], s40 offen sc1
    s_add_u32 s40, s40, 1024
    buffer_store_dwordx4 v[4:7], v8, s[80:83], s40 offen sc1
    s_add_u32 s40, s40, 1024
    buffer_store_dwordx4 v[4:7], v8, s[80:83], s40 offen sc1
    s_add_u32 s40, s40, 1024
    buffer_store_dwordx4 v[4:7], v8, s[80:83], s40 offen sc1
    s_add_u32 s40, s40, 1024
    buffer_store_dwordx4 v[4:7], v8, s[80:83], s40 offen sc1
    s_add_u32 s40, s40, 1024
    buffer_store_dwordx4 v[4:7], v8, s[80:83], s40 offen sc1
    s_add_u32 s40, s40, 1024
    s_mov_b32 s8, s98
    s_mov_b32 s9, s99
    s_and_b32 s9, s9, 0xffff
    s_mov_b32 s10, 0x100
    s_mov_b32 s11, 0x20000
    s_waitcnt vmcnt(0)
    v_mov_b32 v4, 1
    v_mov_b32 v5, 0
    s_mov_b64 exec, 1
    buffer_store_dword v4, v5, s[8:11], 0 offen sc1
    s_mov_b64 exec, -1
L_zc_25:
    s_mov_b32 s44, s98
    s_mov_b32 s45, s99
    s_and_b32 s45, s45, 0xffff
    s_mov_b32 s46, 0x100
    s_mov_b32 s47, 0x20000
    v_lshlrev_b32 v71, 2, v1
    v_mov_b32 v70, 0
    s_and_b32 s21, s2, 7
    s_lshr_b32 s21, s21, 1
    s_lshl_b32 s21, s21, 2
    s_lshr_b32 s22, s2, 3
    s_and_b32 s22, s22, 3
    s_add_u32 s21, s21, s22
    s_mov_b32 s8, s84
    s_mov_b32 s9, s85
    s_and_b32 s9, s9, 0xffff
    s_mov_b32 s10, 0x280000
    s_mov_b32 s11, 0x20000
    v_lshrrev_b32 v2, 4, v1
    v_and_b32 v3, 15, v1
    s_lshl_b32 s40, s21, 7
    s_lshl_b32 s41, s100, 4
    s_add_u32 s40, s40, s41
    v_add_u32 v4, s40, v2
    v_mul_u32_u24 v5, 1280, v4
    v_lshlrev_b32 v6, 4, v3
    v_add_u32 v5, v5, v6
    s_mov_b32 s41, 0
    buffer_load_dwordx4 v[72:75], v5, s[8:11], s41 offen offset:0
    buffer_load_dwordx4 v[76:79], v5, s[8:11], s41 offen offset:256
    buffer_load_dwordx4 v[80:83], v5, s[8:11], s41 offen offset:512
    buffer_load_dwordx4 v[84:87], v5, s[8:11], s41 offen offset:768
    buffer_load_dwordx4 v[88:91], v5, s[8:11], s41 offen offset:1024
    s_mov_b32 s41, 5120
    buffer_load_dwordx4 v[92:95], v5, s[8:11], s41 offen offset:0
    buffer_load_dwordx4 v[96:99], v5, s[8:11], s41 offen offset:256
    buffer_load_dwordx4 v[100:103], v5, s[8:11], s41 offen offset:512
    buffer_load_dwordx4 v[104:107], v5, s[8:11], s41 offen offset:768
    buffer_load_dwordx4 v[108:111], v5, s[8:11], s41 offen offset:1024
    s_mov_b32 s41, 10240
    buffer_load_dwordx4 v[112:115], v5, s[8:11], s41 offen offset:0
    buffer_load_dwordx4 v[116:119], v5, s[8:11], s41 offen offset:256
    buffer_load_dwordx4 v[120:123], v5, s[8:11], s41 offen offset:512
    buffer_load_dwordx4 v[124:127], v5, s[8:11], s41 offen offset:768
    buffer_load_dwordx4 v[128:131], v5, s[8:11], s41 offen offset:1024
    s_mov_b32 s41, 15360
    buffer_load_dwordx4 v[132:135], v5, s[8:11], s41 offen offset:0
    buffer_load_dwordx4 v[136:139], v5, s[8:11], s41 offen offset:256
    buffer_load_dwordx4 v[140:143], v5, s[8:11], s41 offen offset:512
    buffer_load_dwordx4 v[144:147], v5, s[8:11], s41 offen offset:768
    buffer_load_dwordx4 v[148:151], v5, s[8:11], s41 offen offset:1024
    s_waitcnt vmcnt(15)
    v_lshlrev_b32 v12, 16, v72
    v_and_b32 v13, 0xffff0000, v72
    v_mov_b32 v8, v12
    v_mul_f32 v9, v12, v12
    v_mov_b32 v10, v13
    v_mul_f32 v11, v13, v13
    v_lshlrev_b32 v14, 16, v73
    v_and_b32 v15, 0xffff0000, v73
    v_add_f32 v8, v8, v14
    v_fmac_f32 v9, v14, v14
    v_add_f32 v10, v10, v15
    v_fmac_f32 v11, v15, v15
    v_lshlrev_b32 v12, 16, v74
    v_and_b32 v13, 0xffff0000, v74
    v_add_f32 v8, v8, v12
    v_fmac_f32 v9, v12, v12
    v_add_f32 v10, v10, v13
    v_fmac_f32 v11, v13, v13
    v_lshlrev_b32 v14, 16, v75
    v_and_b32 v15, 0xffff0000, v75
    v_add_f32 v8, v8, v14
    v_fmac_f32 v9, v14, v14
    v_add_f32 v10, v10, v15
    v_fmac_f32 v11, v15, v15
    v_lshlrev_b32 v12, 16, v76
    v_and_b32 v13, 0xffff0000, v76
    v_add_f32 v8, v8, v12
    v_fmac_f32 v9, v12, v12
    v_add_f32 v10, v10, v13
    v_fmac_f32 v11, v13, v13
    v_lshlrev_b32 v14, 16, v77
    v_and_b32 v15, 0xffff0000, v77
    v_add_f32 v8, v8, v14
    v_fmac_f32 v9, v14, v14
    v_add_f32 v10, v10, v15
    v_fmac_f32 v11, v15, v15
    v_lshlrev_b32 v12, 16, v78
    v_and_b32 v13, 0xffff0000, v78
    v_add_f32 v8, v8, v12
    v_fmac_f32 v9, v12, v12
    v_add_f32 v10, v10, v13
    v_fmac_f32 v11, v13, v13
    v_lshlrev_b32 v14, 16, v79
    v_and_b32 v15, 0xffff0000, v79
    v_add_f32 v8, v8, v14
    v_fmac_f32 v9, v14, v14
    v_add_f32 v10, v10, v15
    v_fmac_f32 v11, v15, v15
    v_lshlrev_b32 v12, 16, v80
    v_and_b32 v13, 0xffff0000, v80
    v_add_f32 v8, v8, v12
    v_fmac_f32 v9, v12, v12
    v_add_f32 v10, v10, v13
    v_fmac_f32 v11, v13, v13
    v_lshlrev_b32 v14, 16, v81
    v_and_b32 v15, 0xffff0000, v81
    v_add_f32 v8, v8, v14
    v_fmac_f32 v9, v14, v14
    v_add_f32 v10, v10, v15
    v_fmac_f32 v11, v15, v15
    v_lshlrev_b32 v12, 16, v82
    v_and_b32 v13, 0xffff0000, v82
    v_add_f32 v8, v8, v12
    v_fmac_f32 v9, v12, v12
    v_add_f32 v10, v10, v13
    v_fmac_f32 v11, v13, v13
    v_lshlrev_b32 v14, 16, v83
    v_and_b32 v15, 0xffff0000, v83
    v_add_f32 v8, v8, v14
    v_fmac_f32 v9, v14, v14
    v_add_f32 v10, v10, v15
    v_fmac_f32 v11, v15, v15
    v_lshlrev_b32 v12, 16, v84
    v_and_b32 v13, 0xffff0000, v84
    v_add_f32 v8, v8, v12
    v_fmac_f32 v9, v12, v12
    v_add_f32 v10, v10, v13
    v_fmac_f32 v11, v13, v13
    v_lshlrev_b32 v14, 16, v85
    v_and_b32 v15, 0xffff0000, v85
    v_add_f32 v8, v8, v14
    v_fmac_f32 v9, v14, v14
    v_add_f32 v10, v10, v15
    v_fmac_f32 v11, v15, v15
    v_lshlrev_b32 v12, 16, v86
    v_and_b32 v13, 0xffff0000, v86
    v_add_f32 v8, v8, v12
    v_fmac_f32 v9, v12, v12
    v_add_f32 v10, v10, v13
    v_fmac_f32 v11, v13, v13
    v_lshlrev_b32 v14, 16, v87
    v_and_b32 v15, 0xffff0000, v87
    v_add_f32 v8, v8, v14
    v_fmac_f32 v9, v14, v14
    v_add_f32 v10, v10, v15
    v_fmac_f32 v11, v15, v15
    v_lshlrev_b32 v12, 16, v88
    v_and_b32 v13, 0xffff0000, v88
    v_add_f32 v8, v8, v12
    v_fmac_f32 v9, v12, v12
    v_add_f32 v10, v10, v13
    v_fmac_f32 v11, v13, v13
    v_lshlrev_b32 v14, 16, v89
    v_and_b32 v15, 0xffff0000, v89
    v_add_f32 v8, v8, v14
    v_fmac_f32 v9, v14, v14
    v_add_f32 v10, v10, v15
    v_fmac_f32 v11, v15, v15
    v_lshlrev_b32 v12, 16, v90
    v_and_b32 v13, 0xffff0000, v90
    v_add_f32 v8, v8, v12
    v_fmac_f32 v9, v12, v12
    v_add_f32 v10, v10, v13
    v_fmac_f32 v11, v13, v13
    v_lshlrev_b32 v14, 16, v91
    v_and_b32 v15, 0xffff0000, v91
    v_add_f32 v8, v8, v14
    v_fmac_f32 v9, v14, v14
    v_add_f32 v10, v10, v15
    v_fmac_f32 v11, v15, v15
    v_add_f32 v8, v8, v10
    v_add_f32 v9, v9, v11
    s_nop 1
    v_add_f32_dpp v8, v8, v8 row_shr:1 row_mask:0xf bank_mask:0xf bound_ctrl:0
    v_add_f32_dpp v9, v9, v9 row_shr:1 row_mask:0xf bank_mask:0xf bound_ctrl:0
    s_nop 0
    v_add_f32_dpp v8, v8, v8 row_shr:2 row_mask:0xf bank_mask:0xf bound_ctrl:0
    v_add_f32_dpp v9, v9, v9 row_shr:2 row_mask:0xf bank_mask:0xf bound_ctrl:0
    s_nop 0
    v_add_f32_dpp v8, v8, v8 row_shr:4 row_mask:0xf bank_mask:0xf bound_ctrl:0
    v_add_f32_dpp v9, v9, v9 row_shr:4 row_mask:0xf bank_mask:0xf bound_ctrl:0
    s_nop 0
    v_add_f32_dpp v8, v8, v8 row_shr:8 row_mask:0xf bank_mask:0xf bound_ctrl:0
    v_add_f32_dpp v9, v9, v9 row_shr:8 row_mask:0xf bank_mask:0xf bound_ctrl:0
    s_nop 0
    v_mul_f32 v8, 0x3acccccd, v8
    v_mul_f32 v9, 0x3acccccd, v9
    v_fma_f32 v9, -v8, v8, v9
    v_max_f32 v9, 0, v9
    v_add_f32 v9, 0x3727c5ac, v9
    v_rsq_f32 v9, v9
    v_mov_b32 v16, v8
    v_add_u32 v14, 0, v4
    v_lshlrev_b32 v14, 3, v14
    v_mov_b32 v17, v9
    s_mov_b32 s41, 20185088
    s_mov_b32 exec_lo, 0x80008000
    s_mov_b32 exec_hi, 0x80008000
    buffer_store_dwordx2 v[16:17], v14, s[80:83], s41 offen sc1
    s_mov_b64 exec, -1
    s_nop 1
    s_waitcnt vmcnt(11)
    v_lshlrev_b32 v12, 16, v92
    v_and_b32 v13, 0xffff0000, v92
    v_mov_b32 v8, v12
    v_mul_f32 v9, v12, v12
    v_mov_b32 v10, v13
    v_mul_f32 v11, v13, v13
    v_lshlrev_b32 v14, 16, v93
    v_and_b32 v15, 0xffff0000, v93
    v_add_f32 v8, v8, v14
    v_fmac_f32 v9, v14, v14
    v_add_f32 v10, v10, v15
    v_fmac_f32 v11, v15, v15
    v_lshlrev_b32 v12, 16, v94
    v_and_b32 v13, 0xffff0000, v94
    v_add_f32 v8, v8, v12
    v_fmac_f32 v9, v12, v12
    v_add_f32 v10, v10, v13
    v_fmac_f32 v11, v13, v13
    v_lshlrev_b32 v14, 16, v95
    v_and_b32 v15, 0xffff0000, v95
    v_add_f32 v8, v8, v14
    v_fmac_f32 v9, v14, v14
    v_add_f32 v10, v10, v15
    v_fmac_f32 v11, v15, v15
    v_lshlrev_b32 v12, 16, v96
    v_and_b32 v13, 0xffff0000, v96
    v_add_f32 v8, v8, v12
    v_fmac_f32 v9, v12, v12
    v_add_f32 v10, v10, v13
    v_fmac_f32 v11, v13, v13
    v_lshlrev_b32 v14, 16, v97
    v_and_b32 v15, 0xffff0000, v97
    v_add_f32 v8, v8, v14
    v_fmac_f32 v9, v14, v14
    v_add_f32 v10, v10, v15
    v_fmac_f32 v11, v15, v15
    v_lshlrev_b32 v12, 16, v98
    v_and_b32 v13, 0xffff0000, v98
    v_add_f32 v8, v8, v12
    v_fmac_f32 v9, v12, v12
    v_add_f32 v10, v10, v13
    v_fmac_f32 v11, v13, v13
    v_lshlrev_b32 v14, 16, v99
    v_and_b32 v15, 0xffff0000, v99
    v_add_f32 v8, v8, v14
    v_fmac_f32 v9, v14, v14
    v_add_f32 v10, v10, v15
    v_fmac_f32 v11, v15, v15
    v_lshlrev_b32 v12, 16, v100
    v_and_b32 v13, 0xffff0000, v100
    v_add_f32 v8, v8, v12
    v_fmac_f32 v9, v12, v12
    v_add_f32 v10, v10, v13
    v_fmac_f32 v11, v13, v13
    v_lshlrev_b32 v14, 16, v101
    v_and_b32 v15, 0xffff0000, v101
    v_add_f32 v8, v8, v14
    v_fmac_f32 v9, v14, v14
    v_add_f32 v10, v10, v15
    v_fmac_f32 v11, v15, v15
    v_lshlrev_b32 v12, 16, v102
    v_and_b32 v13, 0xffff0000, v102
    v_add_f32 v8, v8, v12
    v_fmac_f32 v9, v12, v12
    v_add_f32 v10, v10, v13
    v_fmac_f32 v11, v13, v13
    v_lshlrev_b32 v14, 16, v103
    v_and_b32 v15, 0xffff0000, v103
    v_add_f32 v8, v8, v14
    v_fmac_f32 v9, v14, v14
    v_add_f32 v10, v10, v15
    v_fmac_f32 v11, v15, v15
    v_lshlrev_b32 v12, 16, v104
    v_and_b32 v13, 0xffff0000, v104
    v_add_f32 v8, v8, v12
    v_fmac_f32 v9, v12, v12
    v_add_f32 v10, v10, v13
    v_fmac_f32 v11, v13, v13
    v_lshlrev_b32 v14, 16, v105
    v_and_b32 v15, 0xffff0000, v105
    v_add_f32 v8, v8, v14
    v_fmac_f32 v9, v14, v14
    v_add_f32 v10, v10, v15
    v_fmac_f32 v11, v15, v15
    v_lshlrev_b32 v12, 16, v106
    v_and_b32 v13, 0xffff0000, v106
    v_add_f32 v8, v8, v12
    v_fmac_f32 v9, v12, v12
    v_add_f32 v10, v10, v13
    v_fmac_f32 v11, v13, v13
    v_lshlrev_b32 v14, 16, v107
    v_and_b32 v15, 0xffff0000, v107
    v_add_f32 v8, v8, v14
    v_fmac_f32 v9, v14, v14
    v_add_f32 v10, v10, v15
    v_fmac_f32 v11, v15, v15
    v_lshlrev_b32 v12, 16, v108
    v_and_b32 v13, 0xffff0000, v108
    v_add_f32 v8, v8, v12
    v_fmac_f32 v9, v12, v12
    v_add_f32 v10, v10, v13
    v_fmac_f32 v11, v13, v13
    v_lshlrev_b32 v14, 16, v109
    v_and_b32 v15, 0xffff0000, v109
    v_add_f32 v8, v8, v14
    v_fmac_f32 v9, v14, v14
    v_add_f32 v10, v10, v15
    v_fmac_f32 v11, v15, v15
    v_lshlrev_b32 v12, 16, v110
    v_and_b32 v13, 0xffff0000, v110
    v_add_f32 v8, v8, v12
    v_fmac_f32 v9, v12, v12
    v_add_f32 v10, v10, v13
    v_fmac_f32 v11, v13, v13
    v_lshlrev_b32 v14, 16, v111
    v_and_b32 v15, 0xffff0000, v111
    v_add_f32 v8, v8, v14
    v_fmac_f32 v9, v14, v14
    v_add_f32 v10, v10, v15
    v_fmac_f32 v11, v15, v15
    v_add_f32 v8, v8, v10
    v_add_f32 v9, v9, v11
    s_nop 1
    v_add_f32_dpp v8, v8, v8 row_shr:1 row_mask:0xf bank_mask:0xf bound_ctrl:0
    v_add_f32_dpp v9, v9, v9 row_shr:1 row_mask:0xf bank_mask:0xf bound_ctrl:0
    s_nop 0
    v_add_f32_dpp v8, v8, v8 row_shr:2 row_mask:0xf bank_mask:0xf bound_ctrl:0
    v_add_f32_dpp v9, v9, v9 row_shr:2 row_mask:0xf bank_mask:0xf bound_ctrl:0
    s_nop 0
    v_add_f32_dpp v8, v8, v8 row_shr:4 row_mask:0xf bank_mask:0xf bound_ctrl:0
    v_add_f32_dpp v9, v9, v9 row_shr:4 row_mask:0xf bank_mask:0xf bound_ctrl:0
    s_nop 0
    v_add_f32_dpp v8, v8, v8 row_shr:8 row_mask:0xf bank_mask:0xf bound_ctrl:0
    v_add_f32_dpp v9, v9, v9 row_shr:8 row_mask:0xf bank_mask:0xf bound_ctrl:0
    s_nop 0
    v_mul_f32 v8, 0x3acccccd, v8
    v_mul_f32 v9, 0x3acccccd, v9
    v_fma_f32 v9, -v8, v8, v9
    v_max_f32 v9, 0, v9
    v_add_f32 v9, 0x3727c5ac, v9
    v_rsq_f32 v9, v9
    v_mov_b32 v16, v8
    v_add_u32 v14, 4, v4
    v_lshlrev_b32 v14, 3, v14
    v_mov_b32 v17, v9
    s_mov_b32 s41, 20185088
    s_mov_b32 exec_lo, 0x80008000
    s_mov_b32 exec_hi, 0x80008000
    buffer_store_dwordx2 v[16:17], v14, s[80:83], s41 offen sc1
    s_mov_b64 exec, -1
    s_nop 1
    s_waitcnt vmcnt(7)
    v_lshlrev_b32 v12, 16, v112
    v_and_b32 v13, 0xffff0000, v112
    v_mov_b32 v8, v12
    v_mul_f32 v9, v12, v12
    v_mov_b32 v10, v13
    v_mul_f32 v11, v13, v13
    v_lshlrev_b32 v14, 16, v113
    v_and_b32 v15, 0xffff0000, v113
    v_add_f32 v8, v8, v14
    v_fmac_f32 v9, v14, v14
    v_add_f32 v10, v10, v15
    v_fmac_f32 v11, v15, v15
    v_lshlrev_b32 v12, 16, v114
    v_and_b32 v13, 0xffff0000, v114
    v_add_f32 v8, v8, v12
    v_fmac_f32 v9, v12, v12
    v_add_f32 v10, v10, v13
    v_fmac_f32 v11, v13, v13
    v_lshlrev_b32 v14, 16, v115
    v_and_b32 v15, 0xffff0000, v115
    v_add_f32 v8, v8, v14
    v_fmac_f32 v9, v14, v14
    v_add_f32 v10, v10, v15
    v_fmac_f32 v11, v15, v15
    v_lshlrev_b32 v12, 16, v116
    v_and_b32 v13, 0xffff0000, v116
    v_add_f32 v8, v8, v12
    v_fmac_f32 v9, v12, v12
    v_add_f32 v10, v10, v13
    v_fmac_f32 v11, v13, v13
    v_lshlrev_b32 v14, 16, v117
    v_and_b32 v15, 0xffff0000, v117
    v_add_f32 v8, v8, v14
    v_fmac_f32 v9, v14, v14
    v_add_f32 v10, v10, v15
    v_fmac_f32 v11, v15, v15
    v_lshlrev_b32 v12, 16, v118
    v_and_b32 v13, 0xffff0000, v118
    v_add_f32 v8, v8, v12
    v_fmac_f32 v9, v12, v12
    v_add_f32 v10, v10, v13
    v_fmac_f32 v11, v13, v13
    v_lshlrev_b32 v14, 16, v119
    v_and_b32 v15, 0xffff0000, v119
    v_add_f32 v8, v8, v14
    v_fmac_f32 v9, v14, v14
    v_add_f32 v10, v10, v15
    v_fmac_f32 v11, v15, v15
    v_lshlrev_b32 v12, 16, v120
    v_and_b32 v13, 0xffff0000, v120
    v_add_f32 v8, v8, v12
    v_fmac_f32 v9, v12, v12
    v_add_f32 v10, v10, v13
    v_fmac_f32 v11, v13, v13
    v_lshlrev_b32 v14, 16, v121
    v_and_b32 v15, 0xffff0000, v121
    v_add_f32 v8, v8, v14
    v_fmac_f32 v9, v14, v14
    v_add_f32 v10, v10, v15
    v_fmac_f32 v11, v15, v15
    v_lshlrev_b32 v12, 16, v122
    v_and_b32 v13, 0xffff0000, v122
    v_add_f32 v8, v8, v12
    v_fmac_f32 v9, v12, v12
    v_add_f32 v10, v10, v13
    v_fmac_f32 v11, v13, v13
    v_lshlrev_b32 v14, 16, v123
    v_and_b32 v15, 0xffff0000, v123
    v_add_f32 v8, v8, v14
    v_fmac_f32 v9, v14, v14
    v_add_f32 v10, v10, v15
    v_fmac_f32 v11, v15, v15
    v_lshlrev_b32 v12, 16, v124
    v_and_b32 v13, 0xffff0000, v124
    v_add_f32 v8, v8, v12
    v_fmac_f32 v9, v12, v12
    v_add_f32 v10, v10, v13
    v_fmac_f32 v11, v13, v13
    v_lshlrev_b32 v14, 16, v125
    v_and_b32 v15, 0xffff0000, v125
    v_add_f32 v8, v8, v14
    v_fmac_f32 v9, v14, v14
    v_add_f32 v10, v10, v15
    v_fmac_f32 v11, v15, v15
    v_lshlrev_b32 v12, 16, v126
    v_and_b32 v13, 0xffff0000, v126
    v_add_f32 v8, v8, v12
    v_fmac_f32 v9, v12, v12
    v_add_f32 v10, v10, v13
    v_fmac_f32 v11, v13, v13
    v_lshlrev_b32 v14, 16, v127
    v_and_b32 v15, 0xffff0000, v127
    v_add_f32 v8, v8, v14
    v_fmac_f32 v9, v14, v14
    v_add_f32 v10, v10, v15
    v_fmac_f32 v11, v15, v15
    v_lshlrev_b32 v12, 16, v128
    v_and_b32 v13, 0xffff0000, v128
    v_add_f32 v8, v8, v12
    v_fmac_f32 v9, v12, v12
    v_add_f32 v10, v10, v13
    v_fmac_f32 v11, v13, v13
    v_lshlrev_b32 v14, 16, v129
    v_and_b32 v15, 0xffff0000, v129
    v_add_f32 v8, v8, v14
    v_fmac_f32 v9, v14, v14
    v_add_f32 v10, v10, v15
    v_fmac_f32 v11, v15, v15
    v_lshlrev_b32 v12, 16, v130
    v_and_b32 v13, 0xffff0000, v130
    v_add_f32 v8, v8, v12
    v_fmac_f32 v9, v12, v12
    v_add_f32 v10, v10, v13
    v_fmac_f32 v11, v13, v13
    v_lshlrev_b32 v14, 16, v131
    v_and_b32 v15, 0xffff0000, v131
    v_add_f32 v8, v8, v14
    v_fmac_f32 v9, v14, v14
    v_add_f32 v10, v10, v15
    v_fmac_f32 v11, v15, v15
    v_add_f32 v8, v8, v10
    v_add_f32 v9, v9, v11
    s_nop 1
    v_add_f32_dpp v8, v8, v8 row_shr:1 row_mask:0xf bank_mask:0xf bound_ctrl:0
    v_add_f32_dpp v9, v9, v9 row_shr:1 row_mask:0xf bank_mask:0xf bound_ctrl:0
    s_nop 0
    v_add_f32_dpp v8, v8, v8 row_shr:2 row_mask:0xf bank_mask:0xf bound_ctrl:0
    v_add_f32_dpp v9, v9, v9 row_shr:2 row_mask:0xf bank_mask:0xf bound_ctrl:0
    s_nop 0
    v_add_f32_dpp v8, v8, v8 row_shr:4 row_mask:0xf bank_mask:0xf bound_ctrl:0
    v_add_f32_dpp v9, v9, v9 row_shr:4 row_mask:0xf bank_mask:0xf bound_ctrl:0
    s_nop 0
    v_add_f32_dpp v8, v8, v8 row_shr:8 row_mask:0xf bank_mask:0xf bound_ctrl:0
    v_add_f32_dpp v9, v9, v9 row_shr:8 row_mask:0xf bank_mask:0xf bound_ctrl:0
    s_nop 0
    v_mul_f32 v8, 0x3acccccd, v8
    v_mul_f32 v9, 0x3acccccd, v9
    v_fma_f32 v9, -v8, v8, v9
    v_max_f32 v9, 0, v9
    v_add_f32 v9, 0x3727c5ac, v9
    v_rsq_f32 v9, v9
    v_mov_b32 v16, v8
    v_add_u32 v14, 8, v4
    v_lshlrev_b32 v14, 3, v14
    v_mov_b32 v17, v9
    s_mov_b32 s41, 20185088
    s_mov_b32 exec_lo, 0x80008000
    s_mov_b32 exec_hi, 0x80008000
    buffer_store_dwordx2 v[16:17], v14, s[80:83], s41 offen sc1
    s_mov_b64 exec, -1
    s_nop 1
    s_waitcnt vmcnt(3)
    v_lshlrev_b32 v12, 16, v132
    v_and_b32 v13, 0xffff0000, v132
    v_mov_b32 v8, v12
    v_mul_f32 v9, v12, v12
    v_mov_b32 v10, v13
    v_mul_f32 v11, v13, v13
    v_lshlrev_b32 v14, 16, v133
    v_and_b32 v15, 0xffff0000, v133
    v_add_f32 v8, v8, v14
    v_fmac_f32 v9, v14, v14
    v_add_f32 v10, v10, v15
    v_fmac_f32 v11, v15, v15
    v_lshlrev_b32 v12, 16, v134
    v_and_b32 v13, 0xffff0000, v134
    v_add_f32 v8, v8, v12
    v_fmac_f32 v9, v12, v12
    v_add_f32 v10, v10, v13
    v_fmac_f32 v11, v13, v13
    v_lshlrev_b32 v14, 16, v135
    v_and_b32 v15, 0xffff0000, v135
    v_add_f32 v8, v8, v14
    v_fmac_f32 v9, v14, v14
    v_add_f32 v10, v10, v15
    v_fmac_f32 v11, v15, v15
    v_lshlrev_b32 v12, 16, v136
    v_and_b32 v13, 0xffff0000, v136
    v_add_f32 v8, v8, v12
    v_fmac_f32 v9, v12, v12
    v_add_f32 v10, v10, v13
    v_fmac_f32 v11, v13, v13
    v_lshlrev_b32 v14, 16, v137
    v_and_b32 v15, 0xffff0000, v137
    v_add_f32 v8, v8, v14
    v_fmac_f32 v9, v14, v14
    v_add_f32 v10, v10, v15
    v_fmac_f32 v11, v15, v15
    v_lshlrev_b32 v12, 16, v138
    v_and_b32 v13, 0xffff0000, v138
    v_add_f32 v8, v8, v12
    v_fmac_f32 v9, v12, v12
    v_add_f32 v10, v10, v13
    v_fmac_f32 v11, v13, v13
    v_lshlrev_b32 v14, 16, v139
    v_and_b32 v15, 0xffff0000, v139
    v_add_f32 v8, v8, v14
    v_fmac_f32 v9, v14, v14
    v_add_f32 v10, v10, v15
    v_fmac_f32 v11, v15, v15
    v_lshlrev_b32 v12, 16, v140
    v_and_b32 v13, 0xffff0000, v140
    v_add_f32 v8, v8, v12
    v_fmac_f32 v9, v12, v12
    v_add_f32 v10, v10, v13
    v_fmac_f32 v11, v13, v13
    v_lshlrev_b32 v14, 16, v141
    v_and_b32 v15, 0xffff0000, v141
    v_add_f32 v8, v8, v14
    v_fmac_f32 v9, v14, v14
    v_add_f32 v10, v10, v15
    v_fmac_f32 v11, v15, v15
    v_lshlrev_b32 v12, 16, v142
    v_and_b32 v13, 0xffff0000, v142
    v_add_f32 v8, v8, v12
    v_fmac_f32 v9, v12, v12
    v_add_f32 v10, v10, v13
    v_fmac_f32 v11, v13, v13
    v_lshlrev_b32 v14, 16, v143
    v_and_b32 v15, 0xffff0000, v143
    v_add_f32 v8, v8, v14
    v_fmac_f32 v9, v14, v14
    v_add_f32 v10, v10, v15
    v_fmac_f32 v11, v15, v15
    v_lshlrev_b32 v12, 16, v144
    v_and_b32 v13, 0xffff0000, v144
    v_add_f32 v8, v8, v12
    v_fmac_f32 v9, v12, v12
    v_add_f32 v10, v10, v13
    v_fmac_f32 v11, v13, v13
    v_lshlrev_b32 v14, 16, v145
    v_and_b32 v15, 0xffff0000, v145
    v_add_f32 v8, v8, v14
    v_fmac_f32 v9, v14, v14
    v_add_f32 v10, v10, v15
    v_fmac_f32 v11, v15, v15
    v_lshlrev_b32 v12, 16, v146
    v_and_b32 v13, 0xffff0000, v146
    v_add_f32 v8, v8, v12
    v_fmac_f32 v9, v12, v12
    v_add_f32 v10, v10, v13
    v_fmac_f32 v11, v13, v13
    v_lshlrev_b32 v14, 16, v147
    v_and_b32 v15, 0xffff0000, v147
    v_add_f32 v8, v8, v14
    v_fmac_f32 v9, v14, v14
    v_add_f32 v10, v10, v15
    v_fmac_f32 v11, v15, v15
    v_lshlrev_b32 v12, 16, v148
    v_and_b32 v13, 0xffff0000, v148
    v_add_f32 v8, v8, v12
    v_fmac_f32 v9, v12, v12
    v_add_f32 v10, v10, v13
    v_fmac_f32 v11, v13, v13
    v_lshlrev_b32 v14, 16, v149
    v_and_b32 v15, 0xffff0000, v149
    v_add_f32 v8, v8, v14
    v_fmac_f32 v9, v14, v14
    v_add_f32 v10, v10, v15
    v_fmac_f32 v11, v15, v15
    v_lshlrev_b32 v12, 16, v150
    v_and_b32 v13, 0xffff0000, v150
    v_add_f32 v8, v8, v12
    v_fmac_f32 v9, v12, v12
    v_add_f32 v10, v10, v13
    v_fmac_f32 v11, v13, v13
    v_lshlrev_b32 v14, 16, v151
    v_and_b32 v15, 0xffff0000, v151
    v_add_f32 v8, v8, v14
    v_fmac_f32 v9, v14, v14
    v_add_f32 v10, v10, v15
    v_fmac_f32 v11, v15, v15
    v_add_f32 v8, v8, v10
    v_add_f32 v9, v9, v11
    s_nop 1
    v_add_f32_dpp v8, v8, v8 row_shr:1 row_mask:0xf bank_mask:0xf bound_ctrl:0
    v_add_f32_dpp v9, v9, v9 row_shr:1 row_mask:0xf bank_mask:0xf bound_ctrl:0
    s_nop 0
    v_add_f32_dpp v8, v8, v8 row_shr:2 row_mask:0xf bank_mask:0xf bound_ctrl:0
    v_add_f32_dpp v9, v9, v9 row_shr:2 row_mask:0xf bank_mask:0xf bound_ctrl:0
    s_nop 0
    v_add_f32_dpp v8, v8, v8 row_shr:4 row_mask:0xf bank_mask:0xf bound_ctrl:0
    v_add_f32_dpp v9, v9, v9 row_shr:4 row_mask:0xf bank_mask:0xf bound_ctrl:0
    s_nop 0
    v_add_f32_dpp v8, v8, v8 row_shr:8 row_mask:0xf bank_mask:0xf bound_ctrl:0
    v_add_f32_dpp v9, v9, v9 row_shr:8 row_mask:0xf bank_mask:0xf bound_ctrl:0
    s_nop 0
    v_mul_f32 v8, 0x3acccccd, v8
    v_mul_f32 v9, 0x3acccccd, v9
    v_fma_f32 v9, -v8, v8, v9
    v_max_f32 v9, 0, v9
    v_add_f32 v9, 0x3727c5ac, v9
    v_rsq_f32 v9, v9
    v_mov_b32 v16, v8
    v_add_u32 v14, 12, v4
    v_lshlrev_b32 v14, 3, v14
    v_mov_b32 v17, v9
    s_mov_b32 s41, 20185088
    s_mov_b32 exec_lo, 0x80008000
    s_mov_b32 exec_hi, 0x80008000
    buffer_store_dwordx2 v[16:17], v14, s[80:83], s41 offen sc1
    s_mov_b64 exec, -1
    s_nop 1
    s_waitcnt vmcnt(0)
    buffer_load_dword v70, v71, s[44:47], 0 offen sc1
    s_barrier
    s_cmp_eq_u32 s100, 0
    s_cbranch_scc0 L_wo_26
    s_mov_b32 s101, 0
L_dbgp_27:
    s_waitcnt vmcnt(0)
L_dbgc_29:
    v_readfirstlane_b32 s75, v70
    s_cmp_lg_u32 s75, 0
    s_cbranch_scc1 L_dbgok_28
    s_add_u32 s101, s101, 1
    s_cmp_gt_u32 s101, 262144
    s_cbranch_scc1 L_dbgok_28
    s_sleep 1
    buffer_load_dword v70, v71, s[44:47], 0 offen sc1
    s_branch L_dbgp_27
L_dbgok_28:
    s_add_u32 s76, s21, 64
    s_lshl_b32 s101, s76, 7
    s_add_u32 s101, s101, 23814144
    v_mov_b32 v64, s101
    v_mov_b32 v65, 1
    s_mov_b64 exec, 1
    buffer_atomic_add v65, v64, s[80:83], 0 offen sc1
    s_mov_b64 exec, -1
L_wo_26:
    s_cmp_eq_u32 s100, 7
    s_cbranch_scc0 L_wo_30
    s_mov_b64 exec, 7
    buffer_load_dword v70, v71, s[44:47], 0 offen sc1
    s_mov_b64 exec, -1
    s_mov_b32 s101, 0
L_dbgp_31:
    s_waitcnt vmcnt(0)
L_dbgc_33:
    v_readfirstlane_b32 s75, v70
    s_cmp_lg_u32 s75, 0
    s_cbranch_scc1 L_dbgok_32
    s_add_u32 s101, s101, 1
    s_cmp_gt_u32 s101, 262144
    s_cbranch_scc1 L_dbgok_32
    s_sleep 1
    buffer_load_dword v70, v71, s[44:47], 0 offen sc1
    s_branch L_dbgp_31
L_dbgok_32:
    s_getreg_b32 s72, hwreg(HW_REG_XCC_ID)
    s_and_b32 s72, s72, 7
    s_add_u32 s76, s72, 0
    s_lshl_b32 s76, s76, 7
    s_add_u32 s76, s76, 23814144
    v_mov_b32 v69, s76
    v_accvgpr_write_b32 a0, 1
    s_mov_b64 exec, 1
    s_nop 1
    buffer_atomic_add a0, v69, s[80:83], 0 offen sc0
    s_mov_b64 exec, -1
    s_waitcnt vmcnt(0)
    v_accvgpr_read_b32 v69, a0
    s_nop 1
    v_readfirstlane_b32 s73, v69
    s_cmp_eq_u32 s73, 31
    s_cbranch_scc0 L_r3a_34
    v_mov_b32 v69, 4
    v_mov_b32 v68, 1
    s_mov_b64 exec, 1
    buffer_atomic_add v68, v69, s[44:47], 0 offen sc1
    s_mov_b64 exec, -1
L_r3a_34:
    s_cmp_ge_u32 s73, 32
    s_cbranch_scc0 L_r3b_35
    v_mov_b32 v69, 8
    v_mov_b32 v68, 1
    s_mov_b64 exec, 1
    buffer_store_dword v68, v69, s[44:47], 0 offen sc1
    s_mov_b64 exec, -1
L_r3b_35:
    s_mov_b64 exec, 7
    buffer_load_dword v70, v71, s[44:47], 0 offen sc1
    s_mov_b64 exec, -1
    s_mov_b32 s101, 0
L_rp_36:
    s_waitcnt vmcnt(0)
    v_readlane_b32 s39, v70, 1
    v_readlane_b32 s40, v70, 2
    s_cmp_eq_u32 s39, 8
    s_cselect_b32 s38, 1, 0
    s_cmp_lg_u32 s40, 0
    s_cselect_b32 s38, 0, s38
    s_cbranch_scc1 L_rpok_37
    s_cmp_eq_u32 s38, 1
    s_cbranch_scc1 L_rpok_37
    s_add_u32 s101, s101, 1
    s_cmp_gt_u32 s101, 262144
    s_cbranch_scc1 L_rpok_37
    s_sleep 1
    s_mov_b64 exec, 7
    buffer_load_dword v70, v71, s[44:47], 0 offen sc1
    s_mov_b64 exec, -1
    s_branch L_rp_36
L_rpok_37:
    v_mov_b32 v64, s72
    v_mov_b32 v66, s38
    v_mov_b32 v65, s73
    v_mov_b32 v63, 149440
    ds_write_b96 v63, v[64:66]
    s_waitcnt lgkmcnt(0)
L_wo_30:
    s_cmp_ge_u32 s100, 4
    s_cbranch_scc0 L_rpl_38
    s_mul_i32 s75, s2, 768
    s_sub_u32 s76, s100, 4
    s_lshl_b32 s76, s76, 6
    s_add_u32 s75, s75, s76
    v_add_u32 v88, s75, v1
    v_add_u32 v89, 0, v88
    s_mov_b32 s75, 0x333334
    v_mul_hi_u32 v90, v89, s75
    v_mul_u32_u24 v91, 1280, v90
    v_sub_u32 v91, v89, v91
    v_mul_u32_u24 v92, 0xcccd, v91
    v_lshrrev_b32 v92, 19, v92
    v_mul_u32_u24 v93, 10, v92
    v_sub_u32 v93, v91, v93
    v_and_b32 v94, 0x73, v92
    v_and_b32 v97, 4, v92
    v_lshlrev_b32 v97, 1, v97
    v_or_b32 v94, v94, v97
    v_and_b32 v97, 8, v92
    v_lshrrev_b32 v97, 1, v97
    v_or_b32 v94, v94, v97
    v_lshlrev_b32 v110, 4, v89
    v_cmp_gt_u32 vcc, 40, v90
    v_subrev_u32 v97, 40, v90
    s_nop 0
    v_cndmask_b32 v97, v97, v90, vcc
    v_mul_u32_u24 v95, 0x4925, v97
    v_mul_u32_u24 v96, 0xcccd, v97
    v_cndmask_b32 v95, v95, v96, vcc
    v_lshrrev_b32 v95, 18, v95
    v_mov_b32 v96, 14
    v_cndmask_b32 v96, v96, 5, vcc
    v_mul_u32_u24 v96, v96, v95
    v_sub_u32 v96, v97, v96
    v_lshlrev_b32 v96, 7, v96
    v_add_u32 v94, v94, v96
    v_mul_u32_u24 v94, 1280, v94
    v_mul_u32_u24 v95, 160, v95
    v_lshlrev_b32 v93, 4, v93
    v_add3_u32 v94, v94, v95, v93
    v_mov_b32 v97, 0x7fffff00
    v_cndmask_b32 v95, v97, v94, vcc
    v_cndmask_b32 v94, v94, v97, vcc
    v_cmp_gt_u32 vcc, 152, v90
    s_nop 1
    v_cndmask_b32 v110, v97, v110, vcc
    v_mov_b32 v100, v95
    v_mov_b32 v101, v94
    v_mov_b32 v106, v90
    v_add_u32 v89, 256, v88
    s_mov_b32 s75, 0x333334
    v_mul_hi_u32 v90, v89, s75
    v_mul_u32_u24 v91, 1280, v90
    v_sub_u32 v91, v89, v91
    v_mul_u32_u24 v92, 0xcccd, v91
    v_lshrrev_b32 v92, 19, v92
    v_mul_u32_u24 v93, 10, v92
    v_sub_u32 v93, v91, v93
    v_and_b32 v94, 0x73, v92
    v_and_b32 v97, 4, v92
    v_lshlrev_b32 v97, 1, v97
    v_or_b32 v94, v94, v97
    v_and_b32 v97, 8, v92
    v_lshrrev_b32 v97, 1, v97
    v_or_b32 v94, v94, v97
    v_lshlrev_b32 v111, 4, v89
    v_cmp_gt_u32 vcc, 40, v90
    v_subrev_u32 v97, 40, v90
    s_nop 0
    v_cndmask_b32 v97, v97, v90, vcc
    v_mul_u32_u24 v95, 0x4925, v97
    v_mul_u32_u24 v96, 0xcccd, v97
    v_cndmask_b32 v95, v95, v96, vcc
    v_lshrrev_b32 v95, 18, v95
    v_mov_b32 v96, 14
    v_cndmask_b32 v96, v96, 5, vcc
    v_mul_u32_u24 v96, v96, v95
    v_sub_u32 v96, v97, v96
    v_lshlrev_b32 v96, 7, v96
    v_add_u32 v94, v94, v96
    v_mul_u32_u24 v94, 1280, v94
    v_mul_u32_u24 v95, 160, v95
    v_lshlrev_b32 v93, 4, v93
    v_add3_u32 v94, v94, v95, v93
    v_mov_b32 v97, 0x7fffff00
    v_cndmask_b32 v95, v97, v94, vcc
    v_cndmask_b32 v94, v94, v97, vcc
    v_cmp_gt_u32 vcc, 152, v90
    s_nop 1
    v_cndmask_b32 v111, v97, v111, vcc
    v_mov_b32 v102, v95
    v_mov_b32 v103, v94
    v_mov_b32 v107, v90
    v_add_u32 v89, 512, v88
    s_mov_b32 s75, 0x333334
    v_mul_hi_u32 v90, v89, s75
    v_mul_u32_u24 v91, 1280, v90
    v_sub_u32 v91, v89, v91
    v_mul_u32_u24 v92, 0xcccd, v91
    v_lshrrev_b32 v92, 19, v92
    v_mul_u32_u24 v93, 10, v92
    v_sub_u32 v93, v91, v93
    v_and_b32 v94, 0x73, v92
    v_and_b32 v97, 4, v92
    v_lshlrev_b32 v97, 1, v97
    v_or_b32 v94, v94, v97
    v_and_b32 v97, 8, v92
    v_lshrrev_b32 v97, 1, v97
    v_or_b32 v94, v94, v97
    v_lshlrev_b32 v112, 4, v89
    v_cmp_gt_u32 vcc, 40, v90
    v_subrev_u32 v97, 40, v90
    s_nop 0
    v_cndmask_b32 v97, v97, v90, vcc
    v_mul_u32_u24 v95, 0x4925, v97
    v_mul_u32_u24 v96, 0xcccd, v97
    v_cndmask_b32 v95, v95, v96, vcc
    v_lshrrev_b32 v95, 18, v95
    v_mov_b32 v96, 14
    v_cndmask_b32 v96, v96, 5, vcc
    v_mul_u32_u24 v96, v96, v95
    v_sub_u32 v96, v97, v96
    v_lshlrev_b32 v96, 7, v96
    v_add_u32 v94, v94, v96
    v_mul_u32_u24 v94, 1280, v94
    v_mul_u32_u24 v95, 160, v95
    v_lshlrev_b32 v93, 4, v93
    v_add3_u32 v94, v94, v95, v93
    v_mov_b32 v97, 0x7fffff00
    v_cndmask_b32 v95, v97, v94, vcc
    v_cndmask_b32 v94, v94, v97, vcc
    v_cmp_gt_u32 vcc, 152, v90
    s_nop 1
    v_cndmask_b32 v112, v97, v112, vcc
    v_mov_b32 v104, v95
    v_mov_b32 v105, v94
    v_mov_b32 v108, v90
    v_accvgpr_write_b32 a40, v110
    v_accvgpr_write_b32 a41, v111
    v_accvgpr_write_b32 a42, v112
    v_accvgpr_write_b32 a43, v100
    v_accvgpr_write_b32 a44, v101
    v_accvgpr_write_b32 a45, v102
    v_accvgpr_write_b32 a46, v103
    v_accvgpr_write_b32 a47, v104
    v_accvgpr_write_b32 a48, v105
    v_accvgpr_write_b32 a49, v106
    v_accvgpr_write_b32 a50, v107
    v_accvgpr_write_b32 a51, v108
    v_and_b32 v120, 31, v1
    v_mov_b32 v124, 0
    v_mov_b32 v123, 0x3f803f80
    v_cmp_eq_u32 vcc, 20, v120
    s_sub_u32 s75, s100, 4
    s_mul_i32 s75, s75, 4096
    s_add_u32 s75, s75, 12288
    v_cndmask_b32 v124, v124, v123, vcc
    v_lshlrev_b32 v123, 4, v1
    v_add_u32 v123, s75, v123
    v_mov_b32 v125, v124
    v_mov_b32 v126, v124
    v_mov_b32 v127, v124
    s_mov_b32 exec_lo, 0xfff00000
    s_mov_b32 exec_hi, 0xfff00000
    ds_write_b128 v123, v[124:127] offset:0
    ds_write_b128 v123, v[124:127] offset:1024
    ds_write_b128 v123, v[124:127] offset:2048
    ds_write_b128 v123, v[124:127] offset:3072
    ds_write_b128 v123, v[124:127] offset:28672
    ds_write_b128 v123, v[124:127] offset:29696
    ds_write_b128 v123, v[124:127] offset:30720
    ds_write_b128 v123, v[124:127] offset:31744
    ds_write_b128 v123, v[124:127] offset:57344
    ds_write_b128 v123, v[124:127] offset:58368
    ds_write_b128 v123, v[124:127] offset:59392
    ds_write_b128 v123, v[124:127] offset:60416
    v_add_u32 v123, 86016, v123
    ds_write_b128 v123, v[124:127] offset:0
    ds_write_b128 v123, v[124:127] offset:1024
    ds_write_b128 v123, v[124:127] offset:2048
    ds_write_b128 v123, v[124:127] offset:3072
    ds_write_b128 v123, v[124:127] offset:28672
    ds_write_b128 v123, v[124:127] offset:29696
    ds_write_b128 v123, v[124:127] offset:30720
    ds_write_b128 v123, v[124:127] offset:31744
    s_mov_b64 exec, -1
    v_mov_b32 v123, 143360
    v_mov_b32 v124, 0
    ds_write_b32 v123, v124
    s_waitcnt lgkmcnt(0)
L_rpl_38:
    s_cmp_eq_u32 s100, 4
    s_cbranch_scc0 L_wo_39
    buffer_load_dword v70, v71, s[44:47], 0 offen sc1
    s_mov_b32 s101, 0
L_dbgp_40:
    s_waitcnt vmcnt(0)
L_dbgc_42:
    v_readfirstlane_b32 s75, v70
    s_cmp_lg_u32 s75, 0
    s_cbranch_scc1 L_dbgok_41
    s_add_u32 s101, s101, 1
    s_cmp_gt_u32 s101, 262144
    s_cbranch_scc1 L_dbgok_41
    s_sleep 1
    buffer_load_dword v70, v71, s[44:47], 0 offen sc1
    s_branch L_dbgp_40
L_dbgok_41:
L_wo_39:
    s_barrier
L_attn:
    v_mbcnt_lo_u32_b32 v0, -1, 0
    v_mbcnt_hi_u32_b32 v0, -1, v0
    v_mbcnt_lo_u32_b32 v1, -1, 0
    v_mbcnt_hi_u32_b32 v1, -1, v1
    s_mov_b32 s38, 0x000fffff
    s_mov_b32 s39, 0x000fffff
    s_mov_b32 s32, 0
    s_lshr_b32 s35, s100, 2
    s_and_b32 s42, s100, 3
    v_lshlrev_b32 v2, 4, v0
    v_and_b32 v158, 31, v0
    v_lshrrev_b32 v159, 5, v0
    v_mul_u32_u24 v3, 320, v159
    v_lshlrev_b32 v160, 4, v158
    v_add_u32 v3, v3, v160
    s_add_u32 s8, s78, 0x280000
    s_addc_u32 s9, s79, 0
    s_and_b32 s9, s9, 0xffff
    s_mov_b32 s10, 0x280000
    s_mov_b32 s11, 0x20000
    s_add_u32 s12, s78, 0x500000
    s_addc_u32 s13, s79, 0
    s_and_b32 s13, s13, 0xffff
    s_mov_b32 s14, 0x280000
    s_mov_b32 s15, 0x20000
    s_mov_b32 s16, s78
    s_mov_b32 s17, s79
    s_and_b32 s17, s17, 0xffff
    s_mov_b32 s18, 0x280000
    s_mov_b32 s19, 0x20000
    s_add_u32 s20, s78, 0x780000
    s_addc_u32 s21, s79, 0
    s_and_b32 s21, s21, 0xffff
    s_mov_b32 s22, 0x280000
    s_mov_b32 s23, 0x20000
    s_mov_b32 s44, s92
    s_mov_b32 s45, s93
    s_and_b32 s45, s45, 0xffff
    s_mov_b32 s46, 0x21c000
    s_mov_b32 s47, 0x20000
    v_mov_b32 v126, 0
    v_mov_b32 v127, 0
    v_mov_b32 v128, 0
    v_mov_b32 v129, 0
    v_mov_b32 v130, 0
    v_mov_b32 v131, 0
    v_mov_b32 v132, 0
    v_mov_b32 v133, 0
    v_mov_b32 v134, 0
    v_mov_b32 v135, 0
    v_mov_b32 v136, 0
    v_mov_b32 v137, 0
    v_mov_b32 v138, 0
    v_mov_b32 v139, 0
    v_mov_b32 v140, 0
    v_mov_b32 v141, 0
    v_mov_b32 v142, 0
    v_mov_b32 v143, 0
    v_mov_b32 v144, 0
    v_mov_b32 v145, 0
    v_mov_b32 v146, 0
    v_mov_b32 v147, 0
    v_mov_b32 v148, 0
    v_mov_b32 v149, 0
    v_mov_b32 v150, 0
    v_mov_b32 v151, 0
    v_mov_b32 v152, 0
    v_mov_b32 v153, 0
    v_mov_b32 v154, 0
    v_mov_b32 v155, 0
    v_mov_b32 v156, 0
    v_mov_b32 v157, 0
    v_mov_b32 v90, 0
    v_mov_b32 v122, 0
    v_mov_b32 v91, 0
    v_mov_b32 v123, 0
    v_mov_b32 v92, 0
    v_mov_b32 v124, 0
    v_mov_b32 v93, 0
    v_mov_b32 v125, 0
    v_and_b32 v169, 7, v0
    v_lshlrev_b32 v169, 7, v169
    v_add_u32 v169, 23828480, v169
    v_mov_b32 v168, 0
    s_barrier
    v_mov_b32 v4, 149440
    ds_read_b96 v[6:8], v4
    s_waitcnt lgkmcnt(0)
    v_readfirstlane_b32 s72, v6
    v_readfirstlane_b32 s73, v7
    v_readfirstlane_b32 s74, v8
    s_and_b32 s27, s2, 7
    s_lshr_b32 s28, s2, 3
    s_cmp_eq_u32 s74, 0
    s_cselect_b32 s72, s27, s72
    s_cselect_b32 s73, s28, s73
    s_mov_b32 s25, s73
    s_mov_b32 s43, s72
    s_lshl_b32 s26, s43, 3
    s_and_b32 s41, s25, 1
    s_lshl_b32 s27, s41, 9
    s_mul_i32 s28, s35, 6144
    s_add_u32 s27, s27, s28
    v_add_u32 v4, s27, v2
    s_sub_u32 s27, 1, s41
    s_lshl_b32 s27, s27, 10
    s_lshl_b32 s29, s41, 3
    s_add_u32 s27, s27, s29
    s_add_u32 s27, s27, s28
    v_and_b32 v158, 31, v0
    v_lshlrev_b32 v5, 4, v158
    v_add_u32 v5, s27, v5
    s_lshl_b32 s27, s35, 13
    s_add_u32 s27, s27, 12288
    v_add_u32 v6, s27, v2
    s_mov_b32 s31, 57344
    s_lshr_b32 s27, s25, 1
    s_mul_i32 s27, s27, 163840
    s_mul_i32 s28, s100, 2560
    s_add_u32 s33, s27, s28
    s_lshl_b32 s28, s41, 10
    s_add_u32 s33, s33, s28
    s_mul_i32 s27, s25, 81920
    s_mul_i32 s28, s100, 1280
    s_add_u32 s34, s27, s28
    s_mov_b32 s40, 0
    v_add_u32 v7, 28672, v4
    v_add_u32 v172, 57344, v4
    v_add_u32 v8, 28672, v5
    v_add_u32 v173, 57344, v5
    v_add_u32 v9, 28672, v6
    v_add_u32 v174, 57344, v6
    s_lshl_b32 s27, s42, 1
    s_add_u32 s26, s26, s27
    v_lshlrev_b32 v171, 4, v158
    s_lshl_b32 s28, s41, 3
    s_add_u32 s28, s28, 1024
    v_add_u32 v171, s28, v171
    v_mov_b32 v167, 0x7fffff00
    v_cmp_gt_u32 vcc, 32, v0
    s_mul_i32 s28, s41, 1536
    v_cndmask_b32 v171, v167, v171, vcc
    v_add_u32 v170, s28, v2
    s_cmp_eq_u32 s100, 0
    s_cbranch_scc0 L_attw_43
    s_mul_i32 s27, s25, 20
    s_lshr_b32 s28, s27, 7
    s_add_u32 s27, s27, 19
    s_lshr_b32 s27, s27, 7
    v_and_b32 v161, 1, v0
    v_mov_b32 v162, s28
    v_mov_b32 v163, s27
    v_cmp_eq_u32 vcc, 1, v161
    v_lshrrev_b32 v164, 1, v0
    v_mul_u32_u24 v164, 5, v164
    v_cndmask_b32 v162, v162, v163, vcc
    v_add_u32 v162, v162, v164
    v_add_u32 v162, 9, v162
    v_lshlrev_b32 v162, 7, v162
    v_add_u32 v162, 23814144, v162
    v_mov_b32 v163, 16
    s_mov_b64 exec, 0x3f
    s_mov_b32 s101, 0
L_poll_44:
    buffer_load_dword v164, v162, s[80:83], 0 offen sc1
    s_waitcnt vmcnt(0)
    v_cmp_gt_u32 vcc, v163, v164
    s_nop 4
    s_cmp_eq_u64 vcc, 0
    s_cbranch_scc1 L_pollok_45
    s_add_u32 s101, s101, 1
    s_cmp_gt_u32 s101, 262144
    s_cbranch_scc1 L_pollok_45
    s_sleep 1
    s_branch L_poll_44
L_pollok_45:
    s_mov_b64 exec, -1
L_attw_43:
    s_waitcnt lgkmcnt(0)
    s_barrier
    s_mul_i32 s27, s100, 1536
    s_add_u32 m0, s40, s27
    s_nop 0
    buffer_load_dwordx4 v2, s[8:11], s33 offen  lds
    s_mov_b32 exec_hi, 0
    buffer_load_dwordx4 v2, s[8:11], s33 offen offset:1024  lds
    s_mov_b32 exec_hi, -1
    s_add_u32 s33, s33, 20480
    s_lshr_b32 s27, s25, 1
    s_mul_i32 s27, s27, 163840
    s_xor_b32 s28, s35, 0
    s_add_u32 s28, s28, s26
    s_mul_i32 s28, s28, 2560
    s_add_u32 s28, s28, s27
    buffer_load_dwordx4 v[10:13], v170, s[16:19], s28 offen
    buffer_load_dwordx2 v[18:19], v171, s[16:19], s28 offen
    s_xor_b32 s28, s35, 1
    s_add_u32 s28, s28, s26
    s_mul_i32 s28, s28, 2560
    s_add_u32 s28, s28, s27
    buffer_load_dwordx4 v[14:17], v170, s[16:19], s28 offen
    buffer_load_dwordx2 v[20:21], v171, s[16:19], s28 offen
    s_lshl_b32 s28, s100, 11
    s_add_u32 s28, s28, s40
    s_add_u32 m0, s28, 12288
    s_mov_b64 exec, s[38:39]
    buffer_load_dwordx4 v3, s[12:15], s34 offen  lds
    s_add_u32 m0, m0, 1024
    s_add_u32 s28, s34, 640
    buffer_load_dwordx4 v3, s[12:15], s28 offen  lds
    s_mov_b64 exec, -1
    s_add_u32 s34, s34, 10240
    s_add_u32 s40, s40, 28672
    s_cmp_ge_u32 s40, 143360
    s_cselect_b32 s40, 0, s40
    s_branch L_att_start
L_att_restart:
    v_mov_b32 v126, 0
    v_mov_b32 v127, 0
    v_mov_b32 v128, 0
    v_mov_b32 v129, 0
    v_mov_b32 v130, 0
    v_mov_b32 v131, 0
    v_mov_b32 v132, 0
    v_mov_b32 v133, 0
    v_mov_b32 v134, 0
    v_mov_b32 v135, 0
    v_mov_b32 v136, 0
    v_mov_b32 v137, 0
    v_mov_b32 v138, 0
    v_mov_b32 v139, 0
    v_mov_b32 v140, 0
    v_mov_b32 v141, 0
    v_mov_b32 v142, 0
    v_mov_b32 v143, 0
    v_mov_b32 v144, 0
    v_mov_b32 v145, 0
    v_mov_b32 v146, 0
    v_mov_b32 v147, 0
    v_mov_b32 v148, 0
    v_mov_b32 v149, 0
    v_mov_b32 v150, 0
    v_mov_b32 v151, 0
    v_mov_b32 v152, 0
    v_mov_b32 v153, 0
    v_mov_b32 v154, 0
    v_mov_b32 v155, 0
    v_mov_b32 v156, 0
    v_mov_b32 v157, 0
    v_mov_b32 v90, 0
    v_mov_b32 v122, 0
    v_mov_b32 v91, 0
    v_mov_b32 v123, 0
    v_mov_b32 v92, 0
    v_mov_b32 v124, 0
    v_mov_b32 v93, 0
    v_mov_b32 v125, 0
    s_lshl_b32 s27, s41, 9
    s_mul_i32 s28, s35, 6144
    s_add_u32 s27, s27, s28
    v_add_u32 v4, s27, v2
    s_sub_u32 s27, 1, s41
    s_lshl_b32 s27, s27, 10
    s_lshl_b32 s29, s41, 3
    s_add_u32 s27, s27, s29
    s_add_u32 s27, s27, s28
    v_and_b32 v158, 31, v0
    v_lshlrev_b32 v5, 4, v158
    v_add_u32 v5, s27, v5
    s_lshl_b32 s27, s35, 13
    s_add_u32 s27, s27, 12288
    v_add_u32 v6, s27, v2
    s_mov_b32 s31, 57344
    s_lshr_b32 s27, s25, 1
    s_mul_i32 s27, s27, 163840
    s_mul_i32 s28, s100, 2560
    s_add_u32 s33, s27, s28
    s_lshl_b32 s28, s41, 10
    s_add_u32 s33, s33, s28
    s_mul_i32 s27, s25, 81920
    s_mul_i32 s28, s100, 1280
    s_add_u32 s34, s27, s28
    s_mov_b32 s40, 0
    v_add_u32 v7, 28672, v4
    v_add_u32 v172, 57344, v4
    v_add_u32 v8, 28672, v5
    v_add_u32 v173, 57344, v5
    v_add_u32 v9, 28672, v6
    v_add_u32 v174, 57344, v6
    s_mul_i32 s27, s100, 1536
    s_add_u32 m0, s40, s27
    s_nop 0
    buffer_load_dwordx4 v2, s[8:11], s33 offen  lds
    s_mov_b32 exec_hi, 0
    buffer_load_dwordx4 v2, s[8:11], s33 offen offset:1024  lds
    s_mov_b32 exec_hi, -1
    s_add_u32 s33, s33, 20480
    s_lshl_b32 s28, s100, 11
    s_add_u32 s28, s28, s40
    s_add_u32 m0, s28, 12288
    s_mov_b64 exec, s[38:39]
    buffer_load_dwordx4 v3, s[12:15], s34 offen  lds
    s_add_u32 m0, m0, 1024
    s_add_u32 s28, s34, 640
    buffer_load_dwordx4 v3, s[12:15], s28 offen  lds
    s_mov_b64 exec, -1
    s_add_u32 s34, s34, 10240
    s_add_u32 s40, s40, 28672
    s_cmp_ge_u32 s40, 143360
    s_cselect_b32 s40, 0, s40
L_att_start:
    s_waitcnt vmcnt(2)
    s_barrier
    s_cmp_eq_u32 s32, 0
    s_cbranch_scc0 L_att_haveC
    s_mul_i32 s28, s35, 6144
    v_subrev_u32 v159, s28, v4
    v_subrev_u32 v160, s28, v5
    ds_read_b128 v[94:97], v159
    ds_read_b64 v[102:103], v160
    s_waitcnt lgkmcnt(0)
    v_mfma_f32_32x32x16_bf16 v[54:69], v[94:97], v[10:13], 0
    v_mfma_f32_32x32x16_bf16 v[70:85], v[94:97], v[14:17], 0
    v_mfma_f32_32x32x8_bf16 v[54:69], v[102:103], v[18:19], v[54:69]
    v_mfma_f32_32x32x8_bf16 v[70:85], v[102:103], v[20:21], v[70:85]
    ds_read_b128 v[94:97], v4
    ds_read2st64_b64 v[102:105], v5 offset0:0 offset1:3
    s_nop 13
    v_max3_f32 v158, v54, v55, v56
    v_max3_f32 v158, v158, v57, v58
    v_max3_f32 v158, v158, v59, v60
    v_max3_f32 v158, v158, v61, v62
    v_max3_f32 v158, v158, v63, v64
    v_max3_f32 v158, v158, v65, v66
    v_max3_f32 v158, v158, v67, v68
    v_max_f32 v158, v158, v69
    v_max3_f32 v160, v70, v71, v72
    v_max3_f32 v160, v160, v73, v74
    v_max3_f32 v160, v160, v75, v76
    v_max3_f32 v160, v160, v77, v78
    v_max3_f32 v160, v160, v79, v80
    v_max3_f32 v160, v160, v81, v82
    v_max3_f32 v160, v160, v83, v84
    v_max_f32 v160, v160, v85
    v_mov_b32 v159, v158
    v_mov_b32 v161, v160
    s_nop 1
    v_permlane32_swap_b32 v158, v159
    v_permlane32_swap_b32 v160, v161
    s_nop 1
    v_max_f32 v158, v158, v159
    v_max_f32 v160, v160, v161
    v_sub_f32 v22, 0, v158
    v_sub_f32 v38, 0, v160
    v_mov_b32 v23, v22
    v_mov_b32 v39, v38
    v_mov_b32 v24, v22
    v_mov_b32 v40, v38
    v_mov_b32 v25, v22
    v_mov_b32 v41, v38
    v_mov_b32 v26, v22
    v_mov_b32 v42, v38
    v_mov_b32 v27, v22
    v_mov_b32 v43, v38
    v_mov_b32 v28, v22
    v_mov_b32 v44, v38
    v_mov_b32 v29, v22
    v_mov_b32 v45, v38
    v_mov_b32 v30, v22
    v_mov_b32 v46, v38
    v_mov_b32 v31, v22
    v_mov_b32 v47, v38
    v_mov_b32 v32, v22
    v_mov_b32 v48, v38
    v_mov_b32 v33, v22
    v_mov_b32 v49, v38
    v_mov_b32 v34, v22
    v_mov_b32 v50, v38
    v_mov_b32 v35, v22
    v_mov_b32 v51, v38
    v_mov_b32 v36, v22
    v_mov_b32 v52, v38
    v_mov_b32 v37, v22
    v_mov_b32 v53, v38
    s_branch L_att_haveC2
L_att_haveC:
    ds_read_b128 v[94:97], v4
    ds_read2st64_b64 v[102:105], v5 offset0:0 offset1:3
L_att_haveC2:
    s_waitcnt lgkmcnt(0)
    v_mfma_f32_32x32x16_bf16 v[54:69], v[94:97], v[10:13], v[22:37]
    v_mfma_f32_32x32x8_bf16 v[54:69], v[102:103], v[18:19], v[54:69]
    s_waitcnt vmcnt(0)
    s_barrier
    ds_read_b128 v[110:113], v6
    ds_read_b128 v[114:117], v6 offset:1024
    s_mul_i32 s27, s100, 1536
    s_add_u32 m0, s40, s27
    s_nop 0
    buffer_load_dwordx4 v2, s[8:11], s33 offen  lds
    s_mov_b32 exec_hi, 0
    buffer_load_dwordx4 v2, s[8:11], s33 offen offset:1024  lds
    s_mov_b32 exec_hi, -1
    s_add_u32 s33, s33, 20480
    s_lshl_b32 s28, s100, 11
    s_add_u32 s28, s28, s40
    s_add_u32 m0, s28, 12288
    s_mov_b64 exec, s[38:39]
    buffer_load_dwordx4 v3, s[12:15], s34 offen  lds
    s_add_u32 m0, m0, 1024
    s_add_u32 s28, s34, 640
    buffer_load_dwordx4 v3, s[12:15], s28 offen  lds
    s_mov_b64 exec, -1
    s_add_u32 s34, s34, 10240
    s_add_u32 s40, s40, 28672
    s_cmp_ge_u32 s40, 143360
    s_cselect_b32 s40, 0, s40
    s_mov_b32 s30, 0
    s_waitcnt lgkmcnt(0)
    s_cmp_eq_u32 s35, 0
    s_cselect_b32 s36, 7, 0
    s_cselect_b32 s37, 0, 7
    .p2align 6
L_att_loop:
    s_bitcmp1_b32 0x7, s30
    s_cbranch_scc0 L_d0_46
    s_mul_i32 s27, s100, 1536
    s_add_u32 m0, s40, s27
    s_nop 0
    buffer_load_dwordx4 v2, s[8:11], s33 offen  lds
    s_mov_b32 exec_hi, 0
    buffer_load_dwordx4 v2, s[8:11], s33 offen offset:1024  lds
    s_mov_b32 exec_hi, -1
    s_add_u32 s33, s33, 20480
    s_lshl_b32 s28, s100, 11
    s_add_u32 s28, s28, s40
    s_add_u32 m0, s28, 12288
    s_mov_b64 exec, s[38:39]
    buffer_load_dwordx4 v3, s[12:15], s34 offen  lds
    s_add_u32 m0, m0, 1024
    s_add_u32 s28, s34, 640
    buffer_load_dwordx4 v3, s[12:15], s28 offen  lds
    s_mov_b64 exec, -1
    s_add_u32 s34, s34, 10240
    s_add_u32 s40, s40, 28672
    s_cmp_ge_u32 s40, 143360
    s_cselect_b32 s40, 0, s40
L_d0b_47:
    ds_read_b128 v[98:101], v4 offset:1536
    ds_read_b128 v[118:121], v6 offset:2048
    v_mfma_f32_32x32x16_bf16 v[70:85], v[94:97], v[14:17], v[38:53]
    v_exp_f32 v54, v54
    v_exp_f32 v55, v55
    v_exp_f32 v56, v56
    v_exp_f32 v57, v57
    v_mfma_f32_32x32x16_bf16 v[142:157], v[122:125], v[90:93], v[142:157]
    ds_read_b128 v[122:125], v6 offset:3072
    v_exp_f32 v58, v58
    v_exp_f32 v59, v59
    v_exp_f32 v60, v60
    v_exp_f32 v61, v61
    v_cvt_pk_bf16_f32 v86, v54, v55
    v_cvt_pk_bf16_f32 v87, v56, v57
    v_mfma_f32_32x32x8_bf16 v[70:85], v[102:103], v[20:21], v[70:85]
    v_cvt_pk_bf16_f32 v88, v58, v59
    v_cvt_pk_bf16_f32 v89, v60, v61
    v_exp_f32 v62, v62
    v_exp_f32 v63, v63
    v_exp_f32 v64, v64
    v_exp_f32 v65, v65
    v_mfma_f32_32x32x16_bf16 v[126:141], v[110:113], v[86:89], v[126:141]
    v_exp_f32 v66, v66
    v_exp_f32 v67, v67
    v_exp_f32 v68, v68
    v_exp_f32 v69, v69
    v_cvt_pk_bf16_f32 v90, v62, v63
    v_cvt_pk_bf16_f32 v91, v64, v65
    v_cvt_pk_bf16_f32 v92, v66, v67
    v_cvt_pk_bf16_f32 v93, v68, v69
    s_waitcnt lgkmcnt(0)
    v_mfma_f32_32x32x16_bf16 v[54:69], v[98:101], v[10:13], v[22:37]
    v_exp_f32 v70, v70
    v_exp_f32 v71, v71
    v_exp_f32 v72, v72
    v_exp_f32 v73, v73
    v_mfma_f32_32x32x16_bf16 v[126:141], v[114:117], v[90:93], v[126:141]
    v_exp_f32 v74, v74
    v_exp_f32 v75, v75
    v_exp_f32 v76, v76
    v_exp_f32 v77, v77
    v_cvt_pk_bf16_f32 v86, v70, v71
    v_cvt_pk_bf16_f32 v87, v72, v73
    v_mfma_f32_32x32x8_bf16 v[54:69], v[104:105], v[18:19], v[54:69]
    v_cvt_pk_bf16_f32 v88, v74, v75
    v_cvt_pk_bf16_f32 v89, v76, v77
    v_exp_f32 v78, v78
    v_exp_f32 v79, v79
    v_exp_f32 v80, v80
    v_exp_f32 v81, v81
    v_mfma_f32_32x32x16_bf16 v[142:157], v[110:113], v[86:89], v[142:157]
    v_exp_f32 v82, v82
    v_exp_f32 v83, v83
    v_exp_f32 v84, v84
    v_exp_f32 v85, v85
    v_cvt_pk_bf16_f32 v90, v78, v79
    v_cvt_pk_bf16_f32 v91, v80, v81
    v_cvt_pk_bf16_f32 v92, v82, v83
    v_cvt_pk_bf16_f32 v93, v84, v85
    ds_read_b128 v[94:97], v4 offset:3072
    ds_read2st64_b64 v[106:109], v5 offset0:6 offset1:9
    ds_read_b128 v[110:113], v6 offset:4096
    v_mfma_f32_32x32x16_bf16 v[70:85], v[98:101], v[14:17], v[38:53]
    v_exp_f32 v54, v54
    v_exp_f32 v55, v55
    v_exp_f32 v56, v56
    v_exp_f32 v57, v57
    v_mfma_f32_32x32x16_bf16 v[142:157], v[114:117], v[90:93], v[142:157]
    ds_read_b128 v[114:117], v6 offset:5120
    v_exp_f32 v58, v58
    v_exp_f32 v59, v59
    v_exp_f32 v60, v60
    v_exp_f32 v61, v61
    v_cvt_pk_bf16_f32 v86, v54, v55
    v_cvt_pk_bf16_f32 v87, v56, v57
    v_mfma_f32_32x32x8_bf16 v[70:85], v[104:105], v[20:21], v[70:85]
    v_cvt_pk_bf16_f32 v88, v58, v59
    v_cvt_pk_bf16_f32 v89, v60, v61
    v_exp_f32 v62, v62
    v_exp_f32 v63, v63
    v_exp_f32 v64, v64
    v_exp_f32 v65, v65
    v_mfma_f32_32x32x16_bf16 v[126:141], v[118:121], v[86:89], v[126:141]
    v_exp_f32 v66, v66
    v_exp_f32 v67, v67
    v_exp_f32 v68, v68
    v_exp_f32 v69, v69
    v_cvt_pk_bf16_f32 v90, v62, v63
    v_cvt_pk_bf16_f32 v91, v64, v65
    v_cvt_pk_bf16_f32 v92, v66, v67
    v_cvt_pk_bf16_f32 v93, v68, v69
    s_waitcnt lgkmcnt(0)
    v_mfma_f32_32x32x16_bf16 v[54:69], v[94:97], v[10:13], v[22:37]
    v_exp_f32 v70, v70
    v_exp_f32 v71, v71
    v_exp_f32 v72, v72
    v_exp_f32 v73, v73
    v_mfma_f32_32x32x16_bf16 v[126:141], v[122:125], v[90:93], v[126:141]
    v_exp_f32 v74, v74
    v_exp_f32 v75, v75
    v_exp_f32 v76, v76
    v_exp_f32 v77, v77
    v_cvt_pk_bf16_f32 v86, v70, v71
    v_cvt_pk_bf16_f32 v87, v72, v73
    v_mfma_f32_32x32x8_bf16 v[54:69], v[106:107], v[18:19], v[54:69]
    v_cvt_pk_bf16_f32 v88, v74, v75
    v_cvt_pk_bf16_f32 v89, v76, v77
    v_exp_f32 v78, v78
    v_exp_f32 v79, v79
    v_exp_f32 v80, v80
    v_exp_f32 v81, v81
    v_mfma_f32_32x32x16_bf16 v[142:157], v[118:121], v[86:89], v[142:157]
    v_exp_f32 v82, v82
    v_exp_f32 v83, v83
    v_exp_f32 v84, v84
    v_exp_f32 v85, v85
    v_cvt_pk_bf16_f32 v90, v78, v79
    v_cvt_pk_bf16_f32 v91, v80, v81
    v_cvt_pk_bf16_f32 v92, v82, v83
    v_cvt_pk_bf16_f32 v93, v84, v85
    ds_read_b128 v[98:101], v4 offset:4608
    ds_read_b128 v[118:121], v6 offset:6144
    v_mfma_f32_32x32x16_bf16 v[70:85], v[94:97], v[14:17], v[38:53]
    v_exp_f32 v54, v54
    v_exp_f32 v55, v55
    v_exp_f32 v56, v56
    v_exp_f32 v57, v57
    v_mfma_f32_32x32x16_bf16 v[142:157], v[122:125], v[90:93], v[142:157]
    ds_read_b128 v[122:125], v6 offset:7168
    v_exp_f32 v58, v58
    v_exp_f32 v59, v59
    v_exp_f32 v60, v60
    v_exp_f32 v61, v61
    v_cvt_pk_bf16_f32 v86, v54, v55
    v_cvt_pk_bf16_f32 v87, v56, v57
    v_mfma_f32_32x32x8_bf16 v[70:85], v[106:107], v[20:21], v[70:85]
    v_cvt_pk_bf16_f32 v88, v58, v59
    v_cvt_pk_bf16_f32 v89, v60, v61
    v_exp_f32 v62, v62
    v_exp_f32 v63, v63
    v_exp_f32 v64, v64
    v_exp_f32 v65, v65
    v_mfma_f32_32x32x16_bf16 v[126:141], v[110:113], v[86:89], v[126:141]
    v_exp_f32 v66, v66
    v_exp_f32 v67, v67
    v_exp_f32 v68, v68
    v_exp_f32 v69, v69
    v_cvt_pk_bf16_f32 v90, v62, v63
    v_cvt_pk_bf16_f32 v91, v64, v65
    v_cvt_pk_bf16_f32 v92, v66, v67
    v_cvt_pk_bf16_f32 v93, v68, v69
    s_waitcnt lgkmcnt(0)
    v_mfma_f32_32x32x16_bf16 v[54:69], v[98:101], v[10:13], v[22:37]
    v_exp_f32 v70, v70
    v_exp_f32 v71, v71
    v_exp_f32 v72, v72
    v_exp_f32 v73, v73
    v_mfma_f32_32x32x16_bf16 v[126:141], v[114:117], v[90:93], v[126:141]
    v_exp_f32 v74, v74
    v_exp_f32 v75, v75
    v_exp_f32 v76, v76
    v_exp_f32 v77, v77
    v_cvt_pk_bf16_f32 v86, v70, v71
    v_cvt_pk_bf16_f32 v87, v72, v73
    v_mfma_f32_32x32x8_bf16 v[54:69], v[108:109], v[18:19], v[54:69]
    v_cvt_pk_bf16_f32 v88, v74, v75
    v_cvt_pk_bf16_f32 v89, v76, v77
    v_exp_f32 v78, v78
    v_exp_f32 v79, v79
    v_exp_f32 v80, v80
    v_exp_f32 v81, v81
    v_mfma_f32_32x32x16_bf16 v[142:157], v[110:113], v[86:89], v[142:157]
    v_exp_f32 v82, v82
    v_exp_f32 v83, v83
    v_exp_f32 v84, v84
    v_exp_f32 v85, v85
    v_cvt_pk_bf16_f32 v90, v78, v79
    v_cvt_pk_bf16_f32 v91, v80, v81
    v_cvt_pk_bf16_f32 v92, v82, v83
    v_cvt_pk_bf16_f32 v93, v84, v85
    s_bitcmp1_b32 0x5, s30
    s_cbranch_scc1 L_c1_48
L_c1b_49:
    s_bitcmp1_b32 0x7, s30
    s_cbranch_scc0 L_d1_50
    s_mul_i32 s27, s100, 1536
    s_add_u32 m0, s40, s27
    s_nop 0
    buffer_load_dwordx4 v2, s[8:11], s33 offen  lds
    s_mov_b32 exec_hi, 0
    buffer_load_dwordx4 v2, s[8:11], s33 offen offset:1024  lds
    s_mov_b32 exec_hi, -1
    s_add_u32 s33, s33, 20480
    s_lshl_b32 s28, s100, 11
    s_add_u32 s28, s28, s40
    s_add_u32 m0, s28, 12288
    s_mov_b64 exec, s[38:39]
    buffer_load_dwordx4 v3, s[12:15], s34 offen  lds
    s_add_u32 m0, m0, 1024
    s_add_u32 s28, s34, 640
    buffer_load_dwordx4 v3, s[12:15], s28 offen  lds
    s_mov_b64 exec, -1
    s_add_u32 s34, s34, 10240
    s_add_u32 s40, s40, 28672
    s_cmp_ge_u32 s40, 143360
    s_cselect_b32 s40, 0, s40
L_d1b_51:
    ds_read_b128 v[94:97], v7 offset:0
    ds_read2st64_b64 v[102:105], v8 offset0:0 offset1:3
    ds_read_b128 v[110:113], v9 offset:0
    v_mfma_f32_32x32x16_bf16 v[70:85], v[98:101], v[14:17], v[38:53]
    v_exp_f32 v54, v54
    v_exp_f32 v55, v55
    v_exp_f32 v56, v56
    v_exp_f32 v57, v57
    v_mfma_f32_32x32x16_bf16 v[142:157], v[114:117], v[90:93], v[142:157]
    ds_read_b128 v[114:117], v9 offset:1024
    v_exp_f32 v58, v58
    v_exp_f32 v59, v59
    v_exp_f32 v60, v60
    v_exp_f32 v61, v61
    v_cvt_pk_bf16_f32 v86, v54, v55
    v_cvt_pk_bf16_f32 v87, v56, v57
    v_mfma_f32_32x32x8_bf16 v[70:85], v[108:109], v[20:21], v[70:85]
    v_cvt_pk_bf16_f32 v88, v58, v59
    v_cvt_pk_bf16_f32 v89, v60, v61
    v_exp_f32 v62, v62
    v_exp_f32 v63, v63
    v_exp_f32 v64, v64
    v_exp_f32 v65, v65
    v_mfma_f32_32x32x16_bf16 v[126:141], v[118:121], v[86:89], v[126:141]
    v_exp_f32 v66, v66
    v_exp_f32 v67, v67
    v_exp_f32 v68, v68
    v_exp_f32 v69, v69
    v_cvt_pk_bf16_f32 v90, v62, v63
    v_cvt_pk_bf16_f32 v91, v64, v65
    v_cvt_pk_bf16_f32 v92, v66, v67
    v_cvt_pk_bf16_f32 v93, v68, v69
    s_waitcnt lgkmcnt(0)
    v_mfma_f32_32x32x16_bf16 v[54:69], v[94:97], v[10:13], v[22:37]
    v_exp_f32 v70, v70
    v_exp_f32 v71, v71
    v_exp_f32 v72, v72
    v_exp_f32 v73, v73
    v_mfma_f32_32x32x16_bf16 v[126:141], v[122:125], v[90:93], v[126:141]
    v_exp_f32 v74, v74
    v_exp_f32 v75, v75
    v_exp_f32 v76, v76
    v_exp_f32 v77, v77
    v_cvt_pk_bf16_f32 v86, v70, v71
    v_cvt_pk_bf16_f32 v87, v72, v73
    v_mfma_f32_32x32x8_bf16 v[54:69], v[102:103], v[18:19], v[54:69]
    v_cvt_pk_bf16_f32 v88, v74, v75
    v_cvt_pk_bf16_f32 v89, v76, v77
    v_exp_f32 v78, v78
    v_exp_f32 v79, v79
    v_exp_f32 v80, v80
    v_exp_f32 v81, v81
    v_mfma_f32_32x32x16_bf16 v[142:157], v[118:121], v[86:89], v[142:157]
    v_exp_f32 v82, v82
    v_exp_f32 v83, v83
    v_exp_f32 v84, v84
    v_exp_f32 v85, v85
    v_cvt_pk_bf16_f32 v90, v78, v79
    v_cvt_pk_bf16_f32 v91, v80, v81
    v_cvt_pk_bf16_f32 v92, v82, v83
    v_cvt_pk_bf16_f32 v93, v84, v85
    ds_read_b128 v[98:101], v7 offset:1536
    ds_read_b128 v[118:121], v9 offset:2048
    v_mfma_f32_32x32x16_bf16 v[70:85], v[94:97], v[14:17], v[38:53]
    v_exp_f32 v54, v54
    v_exp_f32 v55, v55
    v_exp_f32 v56, v56
    v_exp_f32 v57, v57
    v_mfma_f32_32x32x16_bf16 v[142:157], v[122:125], v[90:93], v[142:157]
    ds_read_b128 v[122:125], v9 offset:3072
    v_exp_f32 v58, v58
    v_exp_f32 v59, v59
    v_exp_f32 v60, v60
    v_exp_f32 v61, v61
    v_cvt_pk_bf16_f32 v86, v54, v55
    v_cvt_pk_bf16_f32 v87, v56, v57
    v_mfma_f32_32x32x8_bf16 v[70:85], v[102:103], v[20:21], v[70:85]
    v_cvt_pk_bf16_f32 v88, v58, v59
    v_cvt_pk_bf16_f32 v89, v60, v61
    v_exp_f32 v62, v62
    v_exp_f32 v63, v63
    v_exp_f32 v64, v64
    v_exp_f32 v65, v65
    v_mfma_f32_32x32x16_bf16 v[126:141], v[110:113], v[86:89], v[126:141]
    v_exp_f32 v66, v66
    v_exp_f32 v67, v67
    v_exp_f32 v68, v68
    v_exp_f32 v69, v69
    v_cvt_pk_bf16_f32 v90, v62, v63
    v_cvt_pk_bf16_f32 v91, v64, v65
    v_cvt_pk_bf16_f32 v92, v66, v67
    v_cvt_pk_bf16_f32 v93, v68, v69
    s_waitcnt lgkmcnt(0)
    v_mfma_f32_32x32x16_bf16 v[54:69], v[98:101], v[10:13], v[22:37]
    v_exp_f32 v70, v70
    v_exp_f32 v71, v71
    v_exp_f32 v72, v72
    v_exp_f32 v73, v73
    v_mfma_f32_32x32x16_bf16 v[126:141], v[114:117], v[90:93], v[126:141]
    v_exp_f32 v74, v74
    v_exp_f32 v75, v75
    v_exp_f32 v76, v76
    v_exp_f32 v77, v77
    v_cvt_pk_bf16_f32 v86, v70, v71
    v_cvt_pk_bf16_f32 v87, v72, v73
    v_mfma_f32_32x32x8_bf16 v[54:69], v[104:105], v[18:19], v[54:69]
    v_cvt_pk_bf16_f32 v88, v74, v75
    v_cvt_pk_bf16_f32 v89, v76, v77
    v_exp_f32 v78, v78
    v_exp_f32 v79, v79
    v_exp_f32 v80, v80
    v_exp_f32 v81, v81
    v_mfma_f32_32x32x16_bf16 v[142:157], v[110:113], v[86:89], v[142:157]
    v_exp_f32 v82, v82
    v_exp_f32 v83, v83
    v_exp_f32 v84, v84
    v_exp_f32 v85, v85
    v_cvt_pk_bf16_f32 v90, v78, v79
    v_cvt_pk_bf16_f32 v91, v80, v81
    v_cvt_pk_bf16_f32 v92, v82, v83
    v_cvt_pk_bf16_f32 v93, v84, v85
    s_bitcmp1_b32 0x8, s30
    s_cbranch_scc1 L_pc_52
L_pcb_53:
    ds_read_b128 v[94:97], v7 offset:3072
    ds_read2st64_b64 v[106:109], v8 offset0:6 offset1:9
    ds_read_b128 v[110:113], v9 offset:4096
    v_mfma_f32_32x32x16_bf16 v[70:85], v[98:101], v[14:17], v[38:53]
    v_exp_f32 v54, v54
    v_exp_f32 v55, v55
    v_exp_f32 v56, v56
    v_exp_f32 v57, v57
    v_mfma_f32_32x32x16_bf16 v[142:157], v[114:117], v[90:93], v[142:157]
    ds_read_b128 v[114:117], v9 offset:5120
    v_exp_f32 v58, v58
    v_exp_f32 v59, v59
    v_exp_f32 v60, v60
    v_exp_f32 v61, v61
    v_cvt_pk_bf16_f32 v86, v54, v55
    v_cvt_pk_bf16_f32 v87, v56, v57
    v_mfma_f32_32x32x8_bf16 v[70:85], v[104:105], v[20:21], v[70:85]
    v_cvt_pk_bf16_f32 v88, v58, v59
    v_cvt_pk_bf16_f32 v89, v60, v61
    v_exp_f32 v62, v62
    v_exp_f32 v63, v63
    v_exp_f32 v64, v64
    v_exp_f32 v65, v65
    v_mfma_f32_32x32x16_bf16 v[126:141], v[118:121], v[86:89], v[126:141]
    v_exp_f32 v66, v66
    v_exp_f32 v67, v67
    v_exp_f32 v68, v68
    v_exp_f32 v69, v69
    v_cvt_pk_bf16_f32 v90, v62, v63
    v_cvt_pk_bf16_f32 v91, v64, v65
    v_cvt_pk_bf16_f32 v92, v66, v67
    v_cvt_pk_bf16_f32 v93, v68, v69
    s_waitcnt lgkmcnt(0)
    v_mfma_f32_32x32x16_bf16 v[54:69], v[94:97], v[10:13], v[22:37]
    v_exp_f32 v70, v70
    v_exp_f32 v71, v71
    v_exp_f32 v72, v72
    v_exp_f32 v73, v73
    v_mfma_f32_32x32x16_bf16 v[126:141], v[122:125], v[90:93], v[126:141]
    v_exp_f32 v74, v74
    v_exp_f32 v75, v75
    v_exp_f32 v76, v76
    v_exp_f32 v77, v77
    v_cvt_pk_bf16_f32 v86, v70, v71
    v_cvt_pk_bf16_f32 v87, v72, v73
    v_mfma_f32_32x32x8_bf16 v[54:69], v[106:107], v[18:19], v[54:69]
    v_cvt_pk_bf16_f32 v88, v74, v75
    v_cvt_pk_bf16_f32 v89, v76, v77
    v_exp_f32 v78, v78
    v_exp_f32 v79, v79
    v_exp_f32 v80, v80
    v_exp_f32 v81, v81
    v_mfma_f32_32x32x16_bf16 v[142:157], v[118:121], v[86:89], v[142:157]
    v_exp_f32 v82, v82
    v_exp_f32 v83, v83
    v_exp_f32 v84, v84
    v_exp_f32 v85, v85
    v_cvt_pk_bf16_f32 v90, v78, v79
    v_cvt_pk_bf16_f32 v91, v80, v81
    v_cvt_pk_bf16_f32 v92, v82, v83
    v_cvt_pk_bf16_f32 v93, v84, v85
    ds_read_b128 v[98:101], v7 offset:4608
    ds_read_b128 v[118:121], v9 offset:6144
    v_mfma_f32_32x32x16_bf16 v[70:85], v[94:97], v[14:17], v[38:53]
    v_exp_f32 v54, v54
    v_exp_f32 v55, v55
    v_exp_f32 v56, v56
    v_exp_f32 v57, v57
    v_mfma_f32_32x32x16_bf16 v[142:157], v[122:125], v[90:93], v[142:157]
    ds_read_b128 v[122:125], v9 offset:7168
    v_exp_f32 v58, v58
    v_exp_f32 v59, v59
    v_exp_f32 v60, v60
    v_exp_f32 v61, v61
    v_cvt_pk_bf16_f32 v86, v54, v55
    v_cvt_pk_bf16_f32 v87, v56, v57
    v_mfma_f32_32x32x8_bf16 v[70:85], v[106:107], v[20:21], v[70:85]
    v_cvt_pk_bf16_f32 v88, v58, v59
    v_cvt_pk_bf16_f32 v89, v60, v61
    v_exp_f32 v62, v62
    v_exp_f32 v63, v63
    v_exp_f32 v64, v64
    v_exp_f32 v65, v65
    v_mfma_f32_32x32x16_bf16 v[126:141], v[110:113], v[86:89], v[126:141]
    v_exp_f32 v66, v66
    v_exp_f32 v67, v67
    v_exp_f32 v68, v68
    v_exp_f32 v69, v69
    v_cvt_pk_bf16_f32 v90, v62, v63
    v_cvt_pk_bf16_f32 v91, v64, v65
    v_cvt_pk_bf16_f32 v92, v66, v67
    v_cvt_pk_bf16_f32 v93, v68, v69
    s_waitcnt lgkmcnt(0)
    v_mfma_f32_32x32x16_bf16 v[54:69], v[98:101], v[10:13], v[22:37]
    v_exp_f32 v70, v70
    v_exp_f32 v71, v71
    v_exp_f32 v72, v72
    v_exp_f32 v73, v73
    v_mfma_f32_32x32x16_bf16 v[126:141], v[114:117], v[90:93], v[126:141]
    v_exp_f32 v74, v74
    v_exp_f32 v75, v75
    v_exp_f32 v76, v76
    v_exp_f32 v77, v77
    v_cvt_pk_bf16_f32 v86, v70, v71
    v_cvt_pk_bf16_f32 v87, v72, v73
    v_mfma_f32_32x32x8_bf16 v[54:69], v[108:109], v[18:19], v[54:69]
    v_cvt_pk_bf16_f32 v88, v74, v75
    v_cvt_pk_bf16_f32 v89, v76, v77
    v_exp_f32 v78, v78
    v_exp_f32 v79, v79
    v_exp_f32 v80, v80
    v_exp_f32 v81, v81
    v_mfma_f32_32x32x16_bf16 v[142:157], v[110:113], v[86:89], v[142:157]
    v_exp_f32 v82, v82
    v_exp_f32 v83, v83
    v_exp_f32 v84, v84
    v_exp_f32 v85, v85
    v_cvt_pk_bf16_f32 v90, v78, v79
    v_cvt_pk_bf16_f32 v91, v80, v81
    v_cvt_pk_bf16_f32 v92, v82, v83
    v_cvt_pk_bf16_f32 v93, v84, v85
    s_bitcmp1_b32 0x8, s30
    s_cbranch_scc1 L_rpi_54
L_rpib_55:
    s_waitcnt vmcnt(0)
    s_barrier
    s_bitcmp1_b32 0xd, s30
    s_cbranch_scc1 L_rpc_56
L_rpcb_57:
    ds_read_b128 v[94:97], v172 offset:0
    ds_read2st64_b64 v[102:105], v173 offset0:0 offset1:3
    ds_read_b128 v[110:113], v174 offset:0
    v_mfma_f32_32x32x16_bf16 v[70:85], v[98:101], v[14:17], v[38:53]
    v_exp_f32 v54, v54
    v_exp_f32 v55, v55
    v_exp_f32 v56, v56
    v_exp_f32 v57, v57
    v_mfma_f32_32x32x16_bf16 v[142:157], v[114:117], v[90:93], v[142:157]
    ds_read_b128 v[114:117], v174 offset:1024
    v_exp_f32 v58, v58
    v_exp_f32 v59, v59
    v_exp_f32 v60, v60
    v_exp_f32 v61, v61
    v_cvt_pk_bf16_f32 v86, v54, v55
    v_cvt_pk_bf16_f32 v87, v56, v57
    v_mfma_f32_32x32x8_bf16 v[70:85], v[108:109], v[20:21], v[70:85]
    v_cvt_pk_bf16_f32 v88, v58, v59
    v_cvt_pk_bf16_f32 v89, v60, v61
    v_exp_f32 v62, v62
    v_exp_f32 v63, v63
    v_exp_f32 v64, v64
    v_exp_f32 v65, v65
    v_mfma_f32_32x32x16_bf16 v[126:141], v[118:121], v[86:89], v[126:141]
    v_exp_f32 v66, v66
    v_exp_f32 v67, v67
    v_exp_f32 v68, v68
    v_exp_f32 v69, v69
    v_cvt_pk_bf16_f32 v90, v62, v63
    v_cvt_pk_bf16_f32 v91, v64, v65
    v_cvt_pk_bf16_f32 v92, v66, v67
    v_cvt_pk_bf16_f32 v93, v68, v69
    s_waitcnt lgkmcnt(0)
    v_mfma_f32_32x32x16_bf16 v[54:69], v[94:97], v[10:13], v[22:37]
    v_exp_f32 v70, v70
    v_exp_f32 v71, v71
    v_exp_f32 v72, v72
    v_exp_f32 v73, v73
    v_mfma_f32_32x32x16_bf16 v[126:141], v[122:125], v[90:93], v[126:141]
    v_exp_f32 v74, v74
    v_exp_f32 v75, v75
    v_exp_f32 v76, v76
    v_exp_f32 v77, v77
    v_cvt_pk_bf16_f32 v86, v70, v71
    v_cvt_pk_bf16_f32 v87, v72, v73
    v_mfma_f32_32x32x8_bf16 v[54:69], v[102:103], v[18:19], v[54:69]
    v_cvt_pk_bf16_f32 v88, v74, v75
    v_cvt_pk_bf16_f32 v89, v76, v77
    v_exp_f32 v78, v78
    v_exp_f32 v79, v79
    v_exp_f32 v80, v80
    v_exp_f32 v81, v81
    v_mfma_f32_32x32x16_bf16 v[142:157], v[118:121], v[86:89], v[142:157]
    v_exp_f32 v82, v82
    v_exp_f32 v83, v83
    v_exp_f32 v84, v84
    v_exp_f32 v85, v85
    s_add_u32 s27, s31, 28672
    s_cmp_ge_u32 s27, 143360
    s_cselect_b32 s28, 143360, 0
    s_sub_u32 s27, s27, s28
    s_sub_u32 s28, s27, s31
    s_add_u32 s29, s27, 28672
    s_cmp_ge_u32 s29, 143360
    s_cselect_b32 s27, 143360, 0
    s_sub_u32 s29, s29, s27
    s_sub_u32 s27, s29, s31
    s_mov_b32 s31, s29
    v_mov_b32 v4, v172
    v_add_u32 v7, s28, v172
    v_add_u32 v172, s27, v172
    v_mov_b32 v5, v173
    v_add_u32 v8, s28, v173
    v_add_u32 v173, s27, v173
    v_mov_b32 v6, v174
    v_add_u32 v9, s28, v174
    v_add_u32 v174, s27, v174
    v_cvt_pk_bf16_f32 v90, v78, v79
    v_cvt_pk_bf16_f32 v91, v80, v81
    v_cvt_pk_bf16_f32 v92, v82, v83
    v_cvt_pk_bf16_f32 v93, v84, v85
    s_add_u32 s30, s30, 1
    s_cmp_lt_u32 s30, 4
    s_cbranch_scc1 L_att_loop
    s_waitcnt lgkmcnt(0)
    v_mfma_f32_32x32x16_bf16 v[142:157], v[122:125], v[90:93], v[142:157]
    s_branch L_att_post
L_d0_46:
    v_lshlrev_b32 v170, 7, v0
    s_mul_i32 s27, s73, 69120
    s_lshl_b32 s28, s100, 13
    s_add_u32 s27, s27, s28
    s_mov_b32 exec_lo, -1
    s_mov_b32 exec_hi, 0
    buffer_load_dword v171, v170, s[44:47], s27 offen sc1
    s_mov_b64 exec, -1
    s_branch L_d0b_47
L_c1_48:
    s_cmp_eq_u32 s30, 0
    s_cbranch_scc0 L_bpn_59
    s_waitcnt vmcnt(4)
    s_barrier
    s_branch L_bpe_58
L_bpn_59:
    s_cmp_eq_u32 s30, 2
    s_cbranch_scc0 L_bpn_60
    s_cmp_eq_u32 s32, 0
    s_cbranch_scc0 L_rse_61
    s_cmp_ge_u32 s100, 4
    s_cbranch_scc0 L_rse_61
    v_accvgpr_read_b32 v162, a40
    v_accvgpr_read_b32 v163, a41
    v_accvgpr_read_b32 v164, a42
    s_mov_b32 s76, 20701184
    buffer_store_dwordx4 a[28:31], v162, s[80:83], s76 offen sc1
    buffer_store_dwordx4 a[32:35], v163, s[80:83], s76 offen sc1
    buffer_store_dwordx4 a[36:39], v164, s[80:83], s76 offen sc1
L_rse_61:
    s_branch L_bpe_58
L_bpn_60:
L_bpe_58:
    s_branch L_c1b_49
L_d1_50:
    v_lshlrev_b32 v170, 7, v0
    s_mul_i32 s27, s73, 69120
    s_lshl_b32 s28, s100, 13
    s_add_u32 s27, s27, s28
    s_mov_b32 exec_lo, 0
    s_mov_b32 exec_hi, -1
    buffer_load_dword v171, v170, s[44:47], s27 offen sc1
    s_mov_b64 exec, -1
    s_branch L_d1b_51
L_pc_52:
    v_lshlrev_b32 v170, 7, v0
    s_cmp_ge_u32 s100, 5
    s_cbranch_scc1 L_pf5_62
    s_cmp_eq_u32 s100, 4
    s_cbranch_scc1 L_pf4_63
    s_mul_i32 s27, s73, 25600
    s_lshl_b32 s28, s100, 13
    s_add_u32 s27, s27, s28
    s_add_u32 s27, s27, 20701184
    buffer_load_dword v171, v170, s[80:83], s27 offen sc1
    s_branch L_pfe_64
L_pf4_63:
    s_mul_i32 s27, s73, 69120
    s_add_u32 s27, s27, 65536
    s_mov_b32 exec_hi, 0
    buffer_load_dword v171, v170, s[44:47], s27 offen sc1
    s_mov_b32 exec_hi, -1
    v_lshlrev_b32 v170, 21, v0
    s_mov_b64 exec, 0xfff
    buffer_load_dword v171, v170, s[80:83], 0 offen sc1
    s_mov_b64 exec, 3
    s_mov_b32 s16, s96
    s_mov_b32 s17, s97
    s_and_b32 s17, s17, 0xffff
    s_mov_b32 s18, 0x280000
    s_mov_b32 s19, 0x20000
    buffer_load_dword v171, v170, s[16:19], 0 offen sc1
    s_mov_b64 exec, -1
    s_branch L_pfe_64
L_pf5_62:
    s_sub_u32 s28, s100, 5
    s_lshl_b32 s28, s28, 5
    s_mul_i32 s27, s73, 80
    s_add_u32 s27, s27, s28
    v_and_b32 v166, 31, v0
    v_add_u32 v166, s27, v166
    v_lshrrev_b32 v167, 5, v166
    v_lshlrev_b32 v167, 15, v167
    v_and_b32 v166, 31, v166
    v_lshlrev_b32 v166, 7, v166
    v_add_u32 v166, v166, v167
    s_lshl_b32 s27, s72, 12
    s_mov_b32 exec_hi, 0
    buffer_load_dword v171, v166, s[20:23], s27 offen sc1
    s_mov_b32 exec_hi, -1
L_pfe_64:
    s_branch L_pcb_53
L_rpi_54:
    s_mov_b64 exec, 0xff
    buffer_load_dword v168, v169, s[80:83], 0 offen sc1
    s_mov_b64 exec, -1
    s_branch L_rpib_55
L_rpc_56:
    s_cmp_eq_u32 s30, 0
    s_cbranch_scc0 L_bpn_66
    s_cmp_eq_u32 s32, 0
    s_cbranch_scc0 L_rle_67
    s_cmp_ge_u32 s100, 4
    s_cbranch_scc0 L_rle_67
    v_accvgpr_read_b32 v162, a43
    v_accvgpr_read_b32 v163, a44
    v_accvgpr_read_b32 v164, a49
    s_mov_b32 s16, s88
    s_mov_b32 s17, s89
    s_and_b32 s17, s17, 0xffff
    s_mov_b32 s18, 0xc8000
    s_mov_b32 s19, 0x20000
    v_cmp_gt_u32 vcc, 40, v164
    s_nop 4
    s_mov_b64 s[76:77], vcc
    s_mov_b64 exec, vcc
    s_cbranch_execz L_rla_68
    buffer_load_dwordx4 a[28:31], v162, s[16:19], 0 offen
L_rla_68:
    s_mov_b32 s16, s94
    s_mov_b32 s17, s95
    s_and_b32 s17, s17, 0xffff
    s_mov_b32 s18, 0x21c000
    s_mov_b32 s19, 0x20000
    s_not_b64 exec, s[76:77]
    s_cbranch_execz L_rlb_69
    buffer_load_dwordx4 a[28:31], v163, s[16:19], 0 offen
L_rlb_69:
    s_mov_b64 exec, -1
    v_accvgpr_read_b32 v162, a45
    v_accvgpr_read_b32 v163, a46
    v_accvgpr_read_b32 v164, a50
    s_mov_b32 s16, s88
    s_mov_b32 s17, s89
    s_and_b32 s17, s17, 0xffff
    s_mov_b32 s18, 0xc8000
    s_mov_b32 s19, 0x20000
    v_cmp_gt_u32 vcc, 40, v164
    s_nop 4
    s_mov_b64 s[76:77], vcc
    s_mov_b64 exec, vcc
    s_cbranch_execz L_rla_70
    buffer_load_dwordx4 a[32:35], v162, s[16:19], 0 offen
L_rla_70:
    s_mov_b32 s16, s94
    s_mov_b32 s17, s95
    s_and_b32 s17, s17, 0xffff
    s_mov_b32 s18, 0x21c000
    s_mov_b32 s19, 0x20000
    s_not_b64 exec, s[76:77]
    s_cbranch_execz L_rlb_71
    buffer_load_dwordx4 a[32:35], v163, s[16:19], 0 offen
L_rlb_71:
    s_mov_b64 exec, -1
    v_accvgpr_read_b32 v162, a47
    v_accvgpr_read_b32 v163, a48
    v_accvgpr_read_b32 v164, a51
    s_mov_b32 s16, s88
    s_mov_b32 s17, s89
    s_and_b32 s17, s17, 0xffff
    s_mov_b32 s18, 0xc8000
    s_mov_b32 s19, 0x20000
    v_cmp_gt_u32 vcc, 40, v164
    s_nop 4
    s_mov_b64 s[76:77], vcc
    s_mov_b64 exec, vcc
    s_cbranch_execz L_rla_72
    buffer_load_dwordx4 a[36:39], v162, s[16:19], 0 offen
L_rla_72:
    s_mov_b32 s16, s94
    s_mov_b32 s17, s95
    s_and_b32 s17, s17, 0xffff
    s_mov_b32 s18, 0x21c000
    s_mov_b32 s19, 0x20000
    s_not_b64 exec, s[76:77]
    s_cbranch_execz L_rlb_73
    buffer_load_dwordx4 a[36:39], v163, s[16:19], 0 offen
L_rlb_73:
    s_mov_b64 exec, -1
    s_mul_i32 s76, s2, 8640
    s_sub_u32 s77, s100, 4
    s_mul_i32 s77, s77, 2176
    s_add_u32 s76, s76, s77
    v_lshlrev_b32 v162, 7, v0
    s_mov_b64 exec, 0x1ffff
    buffer_load_dword v163, v162, s[44:47], s76 offen sc1
    s_mov_b64 exec, -1
L_rle_67:
    s_branch L_bpe_65
L_bpn_66:
    s_cmp_eq_u32 s30, 2
    s_cbranch_scc0 L_bpn_74
    s_cmp_eq_u32 s32, 0
    s_cbranch_scc0 L_rae_75
    s_cmp_eq_u32 s100, 4
    s_cbranch_scc0 L_wo_76
    s_and_b32 s76, s2, 7
    s_add_u32 s76, s76, 112
    s_lshl_b32 s101, s76, 7
    s_add_u32 s101, s101, 23814144
    v_mov_b32 v162, s101
    v_mov_b32 v163, 1
    s_mov_b64 exec, 1
    buffer_atomic_add v163, v162, s[80:83], 0 offen sc1
    s_mov_b64 exec, -1
L_wo_76:
L_rae_75:
    s_branch L_bpe_65
L_bpn_74:
    s_cmp_eq_u32 s30, 3
    s_cbranch_scc0 L_bpn_77
    s_mov_b64 exec, 0xff
    v_cmp_gt_u32 vcc, 32, v168
    s_nop 4
    s_cmp_eq_u64 vcc, 0
    s_cbranch_scc1 L_rpok_78
    v_mov_b32 v167, 32
    s_mov_b64 exec, 0xff
    s_mov_b32 s101, 0
L_poll_79:
    buffer_load_dword v168, v169, s[80:83], 0 offen sc1
    s_waitcnt vmcnt(0)
    v_cmp_gt_u32 vcc, v167, v168
    s_nop 4
    s_cmp_eq_u64 vcc, 0
    s_cbranch_scc1 L_pollok_80
    s_add_u32 s101, s101, 1
    s_cmp_gt_u32 s101, 262144
    s_cbranch_scc1 L_pollok_80
    s_sleep 1
    s_branch L_poll_79
L_pollok_80:
    s_mov_b64 exec, -1
L_rpok_78:
    s_mov_b64 exec, -1
    s_branch L_bpe_65
L_bpn_77:
L_bpe_65:
    s_branch L_rpcb_57
L_att_post:
    s_barrier
    s_lshl_b32 s27, s42, 1
    s_add_u32 s28, s27, s35
    s_lshr_b32 s29, s28, 2
    s_mul_i32 s29, s29, 28672
    s_and_b32 s28, s28, 3
    s_mul_i32 s28, s28, 3072
    s_add_u32 s28, s28, s29
    v_add_u32 v158, s28, v2
    s_xor_b32 s28, s35, 1
    s_add_u32 s28, s28, s27
    s_lshr_b32 s29, s28, 2
    s_mul_i32 s29, s29, 28672
    s_and_b32 s28, s28, 3
    s_mul_i32 s28, s28, 3072
    s_add_u32 s28, s28, s29
    v_add_u32 v159, s28, v2
    s_nop 7
    ds_write_b128 v158, v[142:145] offset:0
    ds_write_b128 v158, v[146:149] offset:1024
    ds_write_b128 v158, v[150:153] offset:2048
    s_waitcnt lgkmcnt(0)
    s_barrier
    ds_read_b128 v[54:57], v159 offset:0
    ds_read_b128 v[58:61], v159 offset:1024
    ds_read_b128 v[62:65], v159 offset:2048
    s_waitcnt lgkmcnt(0)
    v_add_f32 v126, v126, v54
    v_add_f32 v127, v127, v55
    v_add_f32 v128, v128, v56
    v_add_f32 v129, v129, v57
    v_add_f32 v130, v130, v58
    v_add_f32 v131, v131, v59
    v_add_f32 v132, v132, v60
    v_add_f32 v133, v133, v61
    v_add_f32 v134, v134, v62
    v_add_f32 v135, v135, v63
    v_add_f32 v136, v136, v64
    v_add_f32 v137, v137, v65
    v_mov_b32 v158, 0
    v_fma_f32 v158, v126, 0, v158
    v_fma_f32 v158, v127, 0, v158
    v_fma_f32 v158, v128, 0, v158
    v_fma_f32 v158, v129, 0, v158
    v_fma_f32 v158, v130, 0, v158
    v_fma_f32 v158, v131, 0, v158
    v_fma_f32 v158, v132, 0, v158
    v_fma_f32 v158, v133, 0, v158
    v_fma_f32 v158, v134, 0, v158
    v_fma_f32 v158, v135, 0, v158
    v_fma_f32 v158, v136, 0, v158
    v_fma_f32 v158, v137, 0, v158
    s_cmp_eq_u32 s32, 0
    s_cbranch_scc0 L_att_store2
    v_cmp_u_f32 vcc, v158, v158
    s_nop 4
    s_cmp_eq_u64 vcc, 0
    s_cbranch_scc1 L_att_store2
    v_mov_b32 v159, 143360
    v_mov_b32 v160, 1
    ds_write_b32 v159, v160
    s_branch L_att_store2
L_att_redo:
    s_mov_b32 s32, 1
    v_mov_b32 v158, 0xff800000
    v_mov_b32 v159, 0xff800000
    s_lshr_b32 s27, s25, 1
    s_mul_i32 s27, s27, 163840
    s_mov_b32 s28, 0
    v_and_b32 v160, 31, v0
    v_lshlrev_b32 v160, 4, v160
    s_lshl_b32 s29, s41, 3
    s_add_u32 s29, s29, 1024
    v_add_u32 v160, s29, v160
    s_mul_i32 s29, s41, 1536
    v_add_u32 v161, s29, v2
L_att_maxloop:
    buffer_load_dwordx4 v[94:97], v161, s[8:11], s27 offen
    buffer_load_dwordx2 v[102:103], v160, s[8:11], s27 offen
    s_waitcnt vmcnt(0)
    v_mfma_f32_32x32x16_bf16 v[54:69], v[94:97], v[10:13], 0
    v_mfma_f32_32x32x8_bf16 v[54:69], v[102:103], v[18:19], v[54:69]
    v_mfma_f32_32x32x16_bf16 v[70:85], v[94:97], v[14:17], 0
    v_mfma_f32_32x32x8_bf16 v[70:85], v[102:103], v[20:21], v[70:85]
    s_nop 15
    v_max3_f32 v158, v158, v54, v55
    v_max3_f32 v158, v158, v56, v57
    v_max3_f32 v158, v158, v58, v59
    v_max3_f32 v158, v158, v60, v61
    v_max3_f32 v158, v158, v62, v63
    v_max3_f32 v158, v158, v64, v65
    v_max3_f32 v158, v158, v66, v67
    v_max3_f32 v158, v158, v68, v69
    v_max3_f32 v159, v159, v70, v71
    v_max3_f32 v159, v159, v72, v73
    v_max3_f32 v159, v159, v74, v75
    v_max3_f32 v159, v159, v76, v77
    v_max3_f32 v159, v159, v78, v79
    v_max3_f32 v159, v159, v80, v81
    v_max3_f32 v159, v159, v82, v83
    v_max3_f32 v159, v159, v84, v85
    s_add_u32 s27, s27, 2560
    s_add_u32 s28, s28, 1
    s_cmp_lt_u32 s28, 64
    s_cbranch_scc1 L_att_maxloop
    v_mov_b32 v160, v158
    s_nop 1
    v_permlane32_swap_b32 v158, v160
    s_nop 1
    v_max_f32 v160, v158, v160
    v_sub_f32 v22, 0, v160
    v_mov_b32 v23, v22
    v_mov_b32 v24, v22
    v_mov_b32 v25, v22
    v_mov_b32 v26, v22
    v_mov_b32 v27, v22
    v_mov_b32 v28, v22
    v_mov_b32 v29, v22
    v_mov_b32 v30, v22
    v_mov_b32 v31, v22
    v_mov_b32 v32, v22
    v_mov_b32 v33, v22
    v_mov_b32 v34, v22
    v_mov_b32 v35, v22
    v_mov_b32 v36, v22
    v_mov_b32 v37, v22
    v_mov_b32 v160, v159
    s_nop 1
    v_permlane32_swap_b32 v159, v160
    s_nop 1
    v_max_f32 v160, v159, v160
    v_sub_f32 v38, 0, v160
    v_mov_b32 v39, v38
    v_mov_b32 v40, v38
    v_mov_b32 v41, v38
    v_mov_b32 v42, v38
    v_mov_b32 v43, v38
    v_mov_b32 v44, v38
    v_mov_b32 v45, v38
    v_mov_b32 v46, v38
    v_mov_b32 v47, v38
    v_mov_b32 v48, v38
    v_mov_b32 v49, v38
    v_mov_b32 v50, v38
    v_mov_b32 v51, v38
    v_mov_b32 v52, v38
    v_mov_b32 v53, v38
    s_barrier
    s_branch L_att_restart
L_att_store2:
    v_mov_b32 v158, v134
    v_mov_b32 v159, v134
    s_nop 1
    v_permlane32_swap_b32 v158, v159
    s_nop 1
    v_rcp_f32 v159, v159
    v_lshrrev_b32 v160, 5, v0
    v_and_b32 v161, 31, v0
    s_add_u32 s27, s26, s35
    s_lshl_b32 s27, s27, 5
    v_add_u32 v161, s27, v161
    v_lshlrev_b32 v161, 4, v161
    s_mul_i32 s27, s25, 5
    v_add_u32 v160, s27, v160
    v_mul_f32 v126, v126, v159
    v_mul_f32 v127, v127, v159
    v_mul_f32 v128, v128, v159
    v_mul_f32 v129, v129, v159
    v_mul_f32 v130, v130, v159
    v_mul_f32 v131, v131, v159
    v_mul_f32 v132, v132, v159
    v_mul_f32 v133, v133, v159
    v_mul_f32 v134, v134, v159
    v_mul_f32 v135, v135, v159
    v_mul_f32 v136, v136, v159
    v_mul_f32 v137, v137, v159
    v_add_u32 v162, 0, v160
    v_lshrrev_b32 v163, 1, v162
    v_lshlrev_b32 v163, 15, v163
    v_and_b32 v162, 1, v162
    v_lshlrev_b32 v162, 3, v162
    v_add3_u32 v162, v162, v163, v161
    v_cvt_pk_bf16_f32 v164, v126, v127
    v_cvt_pk_bf16_f32 v165, v128, v129
    s_cmp_eq_u32 s74, 0
    s_cbranch_scc1 L_slow_81
    buffer_store_dwordx2 v[164:165], v162, s[20:23], 0 offen
    s_branch L_dd_82
L_slow_81:
    buffer_store_dwordx2 v[164:165], v162, s[20:23], 0 offen sc1
L_dd_82:
    v_add_u32 v162, 2, v160
    v_lshrrev_b32 v163, 1, v162
    v_lshlrev_b32 v163, 15, v163
    v_and_b32 v162, 1, v162
    v_lshlrev_b32 v162, 3, v162
    v_add3_u32 v162, v162, v163, v161
    v_cvt_pk_bf16_f32 v164, v130, v131
    v_cvt_pk_bf16_f32 v165, v132, v133
    s_cmp_eq_u32 s74, 0
    s_cbranch_scc1 L_slow_83
    buffer_store_dwordx2 v[164:165], v162, s[20:23], 0 offen
    s_branch L_dd_84
L_slow_83:
    buffer_store_dwordx2 v[164:165], v162, s[20:23], 0 offen sc1
L_dd_84:
    v_add_u32 v162, 4, v160
    v_lshrrev_b32 v163, 1, v162
    v_lshlrev_b32 v163, 15, v163
    v_and_b32 v162, 1, v162
    v_lshlrev_b32 v162, 3, v162
    v_add3_u32 v162, v162, v163, v161
    v_cvt_pk_bf16_f32 v164, v134, v135
    v_cvt_pk_bf16_f32 v165, v136, v137
    s_mov_b32 exec_hi, 0
    s_cmp_eq_u32 s74, 0
    s_cbranch_scc1 L_slow_85
    buffer_store_dwordx2 v[164:165], v162, s[20:23], 0 offen
    s_branch L_dd_86
L_slow_85:
    buffer_store_dwordx2 v[164:165], v162, s[20:23], 0 offen sc1
L_dd_86:
    s_mov_b64 exec, -1
    s_waitcnt vmcnt(0) lgkmcnt(0)
    s_barrier
    v_mov_b32 v159, 143360
    ds_read_b32 v160, v159
    s_waitcnt lgkmcnt(0)
    v_readfirstlane_b32 s27, v160
    s_cmp_eq_u32 s32, 0
    s_cselect_b32 s27, s27, 0
    s_cmp_lg_u32 s27, 0
    s_cbranch_scc1 L_att_redo
    s_add_u32 s76, s43, 24
    v_mbcnt_lo_u32_b32 v1, -1, 0
    v_mbcnt_hi_u32_b32 v1, -1, v1
    s_and_b32 s23, s73, 3
    s_lshl_b32 s21, s72, 2
    s_add_u32 s21, s21, s23
    s_lshl_b32 s21, s21, 6
    s_lshr_b32 s26, s73, 2
    s_mul_i32 s22, s26, 80
    s_mul_i32 s33, s23, 1
    s_mul_i32 s24, s26, 1
    s_add_u32 s33, s33, s24
    s_cmp_ge_u32 s33, 5
    s_cselect_b32 s24, 5, 0
    s_sub_u32 s33, s33, s24
    s_cmp_ge_u32 s33, 5
    s_cselect_b32 s24, 5, 0
    s_sub_u32 s33, s33, s24
    s_cmp_ge_u32 s100, 4
    s_cbranch_scc0 L_o_compute
    s_add_u32 s8, s78, 0x780000
    s_addc_u32 s9, s79, 0
    s_and_b32 s9, s9, 0xffff
    s_mov_b32 s10, 0x280000
    s_mov_b32 s11, 0x20000
    s_sub_u32 s20, s100, 4
    v_lshlrev_b32 v4, 4, v1
    s_lshl_b32 s23, s20, 17
    s_lshl_b32 s24, s21, 4
    s_add_u32 s29, s23, s24
    s_mul_i32 s23, s20, 5120
    s_mul_i32 s24, s26, 102400
    s_add_u32 s30, s23, s24
    s_add_u32 s30, s30, 20701184
    s_lshl_b32 s31, s20, 12
    s_add_u32 s32, s23, 16384
    s_mul_i32 s23, s33, 524288
    s_add_u32 s29, s29, s23
    s_mul_i32 s23, s33, 20480
    s_add_u32 s30, s30, s23
    s_mov_b32 s34, s33
    s_add_u32 m0, s32, 0
    s_add_u32 s23, s30, 4096
    buffer_load_dwordx4 v4, s[80:83], s30 offen offset:0 lds
    buffer_load_dwordx4 v4, s[80:83], s30 offen offset:1024 lds
    buffer_load_dwordx4 v4, s[80:83], s30 offen offset:2048 lds
    buffer_load_dwordx4 v4, s[80:83], s30 offen offset:3072 lds
    s_add_u32 m0, m0, 4096
    s_add_u32 s34, s34, 1
    buffer_load_dwordx4 v4, s[80:83], s23 offen lds
    s_cmp_eq_u32 s34, 5
    s_cselect_b32 s23, 102400, 0
    s_cselect_b32 s34, 0, s34
    s_add_u32 s30, s30, 20480
    s_sub_u32 s30, s30, s23
    s_add_u32 m0, s32, 36864
    s_add_u32 s23, s30, 4096
    buffer_load_dwordx4 v4, s[80:83], s30 offen offset:0 lds
    buffer_load_dwordx4 v4, s[80:83], s30 offen offset:1024 lds
    buffer_load_dwordx4 v4, s[80:83], s30 offen offset:2048 lds
    buffer_load_dwordx4 v4, s[80:83], s30 offen offset:3072 lds
    s_add_u32 m0, m0, 4096
    s_add_u32 s34, s34, 1
    buffer_load_dwordx4 v4, s[80:83], s23 offen lds
    s_cmp_eq_u32 s34, 5
    s_cselect_b32 s23, 102400, 0
    s_cselect_b32 s34, 0, s34
    s_add_u32 s30, s30, 20480
    s_sub_u32 s30, s30, s23
    s_cmp_eq_u32 s100, 4
    s_cbranch_scc0 L_ow_87
    s_add_u32 s40, s72, 24
    s_lshl_b32 s101, s40, 7
    s_add_u32 s101, s101, 23814144
    v_lshlrev_b32 v9, 2, v1
    v_add_u32 v9, s101, v9
    v_mov_b32 v10, 1
    s_mov_b64 exec, 0xffffffff
    s_mov_b32 s101, 0
L_poll_88:
    buffer_load_dword v8, v9, s[80:83], 0 offen sc1
    s_waitcnt vmcnt(0)
    v_cmp_gt_u32 vcc, v10, v8
    s_nop 4
    s_cmp_eq_u64 vcc, 0
    s_cbranch_scc1 L_pollok_89
    s_add_u32 s101, s101, 1
    s_cmp_gt_u32 s101, 262144
    s_cbranch_scc1 L_pollok_89
    s_sleep 1
    s_branch L_poll_88
L_pollok_89:
    s_mov_b64 exec, -1
L_ow_87:
    s_barrier
    s_add_u32 m0, s31, 0
    s_mov_b32 s23, s29
    buffer_load_dwordx4 v4, s[8:11], s23 offen lds
    s_add_u32 m0, m0, 1024
    s_add_u32 s23, s23, 32768
    buffer_load_dwordx4 v4, s[8:11], s23 offen lds
    s_add_u32 m0, m0, 1024
    s_add_u32 s23, s23, 32768
    buffer_load_dwordx4 v4, s[8:11], s23 offen lds
    s_add_u32 m0, m0, 1024
    s_add_u32 s23, s23, 32768
    buffer_load_dwordx4 v4, s[8:11], s23 offen lds
    s_add_u32 s33, s33, 1
    s_cmp_eq_u32 s33, 5
    s_cselect_b32 s23, 2621440, 0
    s_cselect_b32 s33, 0, s33
    s_add_u32 s29, s29, 524288
    s_sub_u32 s29, s29, s23
    s_add_u32 m0, s31, 36864
    s_mov_b32 s23, s29
    buffer_load_dwordx4 v4, s[8:11], s23 offen lds
    s_add_u32 m0, m0, 1024
    s_add_u32 s23, s23, 32768
    buffer_load_dwordx4 v4, s[8:11], s23 offen lds
    s_add_u32 m0, m0, 1024
    s_add_u32 s23, s23, 32768
    buffer_load_dwordx4 v4, s[8:11], s23 offen lds
    s_add_u32 m0, m0, 1024
    s_add_u32 s23, s23, 32768
    buffer_load_dwordx4 v4, s[8:11], s23 offen lds
    s_add_u32 s33, s33, 1
    s_cmp_eq_u32 s33, 5
    s_cselect_b32 s23, 2621440, 0
    s_cselect_b32 s33, 0, s33
    s_add_u32 s29, s29, 524288
    s_sub_u32 s29, s29, s23
    s_waitcnt vmcnt(4)
    s_barrier
    s_add_u32 m0, s31, 73728
    s_mov_b32 s23, s29
    buffer_load_dwordx4 v4, s[8:11], s23 offen lds
    s_add_u32 m0, m0, 1024
    s_add_u32 s23, s23, 32768
    buffer_load_dwordx4 v4, s[8:11], s23 offen lds
    s_add_u32 m0, m0, 1024
    s_add_u32 s23, s23, 32768
    buffer_load_dwordx4 v4, s[8:11], s23 offen lds
    s_add_u32 m0, m0, 1024
    s_add_u32 s23, s23, 32768
    buffer_load_dwordx4 v4, s[8:11], s23 offen lds
    s_add_u32 s33, s33, 1
    s_cmp_eq_u32 s33, 5
    s_cselect_b32 s23, 2621440, 0
    s_cselect_b32 s33, 0, s33
    s_add_u32 s29, s29, 524288
    s_sub_u32 s29, s29, s23
    s_add_u32 m0, s32, 73728
    s_add_u32 s23, s30, 4096
    buffer_load_dwordx4 v4, s[80:83], s30 offen offset:0 lds
    buffer_load_dwordx4 v4, s[80:83], s30 offen offset:1024 lds
    buffer_load_dwordx4 v4, s[80:83], s30 offen offset:2048 lds
    buffer_load_dwordx4 v4, s[80:83], s30 offen offset:3072 lds
    s_add_u32 m0, m0, 4096
    s_add_u32 s34, s34, 1
    buffer_load_dwordx4 v4, s[80:83], s23 offen lds
    s_cmp_eq_u32 s34, 5
    s_cselect_b32 s23, 102400, 0
    s_cselect_b32 s34, 0, s34
    s_add_u32 s30, s30, 20480
    s_sub_u32 s30, s30, s23
    s_waitcnt vmcnt(9)
    s_barrier
    s_add_u32 m0, s31, 110592
    s_mov_b32 s23, s29
    buffer_load_dwordx4 v4, s[8:11], s23 offen lds
    s_add_u32 m0, m0, 1024
    s_add_u32 s23, s23, 32768
    buffer_load_dwordx4 v4, s[8:11], s23 offen lds
    s_add_u32 m0, m0, 1024
    s_add_u32 s23, s23, 32768
    buffer_load_dwordx4 v4, s[8:11], s23 offen lds
    s_add_u32 m0, m0, 1024
    s_add_u32 s23, s23, 32768
    buffer_load_dwordx4 v4, s[8:11], s23 offen lds
    s_add_u32 s33, s33, 1
    s_cmp_eq_u32 s33, 5
    s_cselect_b32 s23, 2621440, 0
    s_cselect_b32 s33, 0, s33
    s_add_u32 s29, s29, 524288
    s_sub_u32 s29, s29, s23
    s_add_u32 m0, s32, 110592
    s_add_u32 s23, s30, 4096
    buffer_load_dwordx4 v4, s[80:83], s30 offen offset:0 lds
    buffer_load_dwordx4 v4, s[80:83], s30 offen offset:1024 lds
    buffer_load_dwordx4 v4, s[80:83], s30 offen offset:2048 lds
    buffer_load_dwordx4 v4, s[80:83], s30 offen offset:3072 lds
    s_add_u32 m0, m0, 4096
    s_add_u32 s34, s34, 1
    buffer_load_dwordx4 v4, s[80:83], s23 offen lds
    s_cmp_eq_u32 s34, 5
    s_cselect_b32 s23, 102400, 0
    s_cselect_b32 s34, 0, s34
    s_add_u32 s30, s30, 20480
    s_sub_u32 s30, s30, s23
    s_waitcnt vmcnt(9)
    s_barrier
    s_add_u32 m0, s31, 0
    s_mov_b32 s23, s29
    buffer_load_dwordx4 v4, s[8:11], s23 offen lds
    s_add_u32 m0, m0, 1024
    s_add_u32 s23, s23, 32768
    buffer_load_dwordx4 v4, s[8:11], s23 offen lds
    s_add_u32 m0, m0, 1024
    s_add_u32 s23, s23, 32768
    buffer_load_dwordx4 v4, s[8:11], s23 offen lds
    s_add_u32 m0, m0, 1024
    s_add_u32 s23, s23, 32768
    buffer_load_dwordx4 v4, s[8:11], s23 offen lds
    s_add_u32 s33, s33, 1
    s_cmp_eq_u32 s33, 5
    s_cselect_b32 s23, 2621440, 0
    s_cselect_b32 s33, 0, s33
    s_add_u32 s29, s29, 524288
    s_sub_u32 s29, s29, s23
    s_add_u32 m0, s32, 0
    s_add_u32 s23, s30, 4096
    buffer_load_dwordx4 v4, s[80:83], s30 offen offset:0 lds
    buffer_load_dwordx4 v4, s[80:83], s30 offen offset:1024 lds
    buffer_load_dwordx4 v4, s[80:83], s30 offen offset:2048 lds
    buffer_load_dwordx4 v4, s[80:83], s30 offen offset:3072 lds
    s_add_u32 m0, m0, 4096
    s_add_u32 s34, s34, 1
    buffer_load_dwordx4 v4, s[80:83], s23 offen lds
    s_cmp_eq_u32 s34, 5
    s_cselect_b32 s23, 102400, 0
    s_cselect_b32 s34, 0, s34
    s_add_u32 s30, s30, 20480
    s_sub_u32 s30, s30, s23
    s_waitcnt vmcnt(9)
    s_barrier
    s_waitcnt vmcnt(0)
    s_barrier
    s_barrier
    s_and_b32 s26, s73, 1
    s_lshl_b32 s21, s72, 1
    s_add_u32 s21, s21, s26
    s_lshl_b32 s21, s21, 7
    s_lshr_b32 s34, s73, 1
    s_cmp_ge_u32 s34, 14
    s_cbranch_scc1 L_o_ld_idle
    s_lshl_b32 s22, s34, 7
    s_mul_i32 s35, s34, 3
    s_mul_i32 s23, s26, 5
    s_add_u32 s35, s35, s23
    s_mul_i32 s23, s35, 0xcccd
    s_lshr_b32 s23, s23, 19
    s_mul_i32 s23, s23, 10
    s_sub_u32 s35, s35, s23
    s_sub_u32 s20, s100, 4
    s_add_u32 s8, s78, 0xa00000
    s_addc_u32 s9, s79, 0
    s_and_b32 s9, s9, 0xffff
    s_mov_b32 s10, 0x280000
    s_mov_b32 s11, 0x20000
    v_lshlrev_b32 v4, 4, v1
    v_add_u32 v5, 1024, v4
    s_lshl_b32 s23, s20, 16
    s_lshl_b32 s24, s21, 4
    s_add_u32 s29, s23, s24
    s_mov_b32 s12, s92
    s_mov_b32 s13, s93
    s_and_b32 s13, s13, 0xffff
    s_mov_b32 s14, 0x21c000
    s_mov_b32 s15, 0x20000
    v_lshrrev_b32 v2, 4, v1
    v_mul_u32_u24 v3, 3456, v2
    v_lshlrev_b32 v2, 2, v2
    v_and_b32 v7, 15, v1
    v_xor_b32 v2, v2, v7
    v_lshlrev_b32 v2, 4, v2
    v_add_u32 v6, v2, v3
    s_lshl_b32 s23, s20, 4
    s_mul_i32 s23, s23, 3456
    s_lshl_b32 s24, s22, 1
    s_add_u32 s30, s23, s24
    s_lshl_b32 s31, s20, 12
    s_mul_i32 s23, s35, 262144
    s_add_u32 s29, s29, s23
    s_mul_i32 s23, s35, 221184
    s_add_u32 s30, s30, s23
    s_mov_b32 s36, s35
    s_barrier
    s_add_u32 m0, s31, 16384
    s_mov_b32 s23, s30
    buffer_load_dwordx4 v6, s[12:15], s23 offen  lds
    s_add_u32 m0, m0, 1024
    s_add_u32 s23, s23, 13824
    buffer_load_dwordx4 v6, s[12:15], s23 offen  lds
    s_add_u32 m0, m0, 1024
    s_add_u32 s23, s23, 13824
    buffer_load_dwordx4 v6, s[12:15], s23 offen  lds
    s_add_u32 m0, m0, 1024
    s_add_u32 s23, s23, 13824
    buffer_load_dwordx4 v6, s[12:15], s23 offen  lds
    s_add_u32 s36, s36, 1
    s_cmp_eq_u32 s36, 10
    s_cselect_b32 s23, 2211840, 0
    s_cselect_b32 s36, 0, s36
    s_add_u32 s30, s30, 221184
    s_sub_u32 s30, s30, s23
    s_add_u32 m0, s31, 49152
    s_mov_b32 s23, s30
    buffer_load_dwordx4 v6, s[12:15], s23 offen  lds
    s_add_u32 m0, m0, 1024
    s_add_u32 s23, s23, 13824
    buffer_load_dwordx4 v6, s[12:15], s23 offen  lds
    s_add_u32 m0, m0, 1024
    s_add_u32 s23, s23, 13824
    buffer_load_dwordx4 v6, s[12:15], s23 offen  lds
    s_add_u32 m0, m0, 1024
    s_add_u32 s23, s23, 13824
    buffer_load_dwordx4 v6, s[12:15], s23 offen  lds
    s_add_u32 s36, s36, 1
    s_cmp_eq_u32 s36, 10
    s_cselect_b32 s23, 2211840, 0
    s_cselect_b32 s36, 0, s36
    s_add_u32 s30, s30, 221184
    s_sub_u32 s30, s30, s23
    s_branch L_f1_loader
L_o_ld_idle:
    s_barrier
    s_branch L_f2_loader0
L_o_compute:
    s_cmp_eq_u32 s100, 0
    s_cbranch_scc0 L_oa_90
    s_lshl_b32 s101, s76, 7
    s_add_u32 s101, s101, 23814144
    s_lshl_b32 s75, s73, 2
    s_add_u32 s101, s101, s75
    v_mov_b32 v4, s101
    v_mov_b32 v5, 1
    s_mov_b64 exec, 1
    s_cmp_eq_u32 s74, 0
    s_cbranch_scc1 L_slow_91
    buffer_store_dword v5, v4, s[80:83], 0 offen
    s_branch L_dd_92
L_slow_91:
    buffer_store_dword v5, v4, s[80:83], 0 offen sc1
L_dd_92:
    s_mov_b64 exec, -1
L_oa_90:
    v_and_b32 v2, 15, v1
    v_lshrrev_b32 v3, 4, v1
    s_lshr_b32 s24, s100, 1
    s_and_b32 s25, s100, 1
    s_lshl_b32 s23, s24, 5
    s_add_u32 s23, s23, s21
    v_add_u32 v84, s23, v2
    s_mul_i32 s29, s25, 48
    s_add_u32 s29, s29, s22
    v_mul_u32_u24 v85, 1280, v84
    v_lshlrev_b32 v87, 3, v3
    v_add_u32 v85, v85, v87
    s_lshl_b32 s23, s29, 1
    v_add_u32 v85, s23, v85
    v_lshrrev_b32 v87, 1, v3
    v_lshlrev_b32 v87, 15, v87
    v_lshlrev_b32 v86, 4, v84
    v_add_u32 v86, v86, v87
    v_and_b32 v87, 1, v3
    v_lshlrev_b32 v87, 3, v87
    v_add_u32 v86, v86, v87
    s_lshl_b32 s23, s29, 12
    v_add_u32 v86, s23, v86
    s_lshl_b32 s23, s24, 9
    v_lshlrev_b32 v4, 10, v3
    v_lshlrev_b32 v87, 4, v2
    v_add_u32 v4, v4, v87
    v_add_u32 v4, s23, v4
    v_lshrrev_b32 v87, 1, v3
    v_lshlrev_b32 v87, 4, v87
    v_and_b32 v88, 1, v3
    v_lshlrev_b32 v88, 2, v88
    v_add_u32 v87, v87, v88
    v_lshrrev_b32 v88, 2, v2
    v_add_u32 v87, v87, v88
    v_mul_u32_u24 v87, 160, v87
    v_and_b32 v88, 3, v1
    v_lshlrev_b32 v88, 3, v88
    v_add_u32 v87, v87, v88
    s_mul_i32 s23, s25, 96
    s_add_u32 s23, s23, 16384
    v_add_u32 v5, s23, v87
    s_mov_b32 s30, s25
    s_mov_b32 s40, s84
    s_mov_b32 s41, s85
    s_and_b32 s41, s41, 0xffff
    s_mov_b32 s42, 0x280000
    s_mov_b32 s43, 0x20000
    s_add_u32 s16, s78, 0xa00000
    s_addc_u32 s17, s79, 0
    s_and_b32 s17, s17, 0xffff
    s_mov_b32 s18, 0x280000
    s_mov_b32 s19, 0x20000
    s_cmp_eq_u32 s25, 1
    s_cselect_b32 s44, 0x7f000000, 0
    s_cselect_b64 s[46:47], -1, 0
    s_mov_b32 s23, 0
    buffer_load_dwordx2 v[70:71], v85, s[40:43], s23 offen
    s_mov_b32 s23, 20480
    buffer_load_dwordx2 v[72:73], v85, s[40:43], s23 offen
    s_mov_b32 s23, 32
    buffer_load_dwordx2 v[74:75], v85, s[40:43], s23 offen
    s_mov_b32 s23, 20512
    buffer_load_dwordx2 v[76:77], v85, s[40:43], s23 offen
    s_add_u32 s23, s44, 64
    buffer_load_dwordx2 v[78:79], v85, s[40:43], s23 offen
    s_add_u32 s23, s44, 20544
    buffer_load_dwordx2 v[80:81], v85, s[40:43], s23 offen
    s_barrier
    s_barrier
    v_add_u32 v6, 0, v4
    v_add_u32 v7, 0, v5
    ds_read_b128 v[8:11], v6 offset:0
    ds_read_b128 v[12:15], v6 offset:256
    ds_read_b64_tr_b16 v[32:33], v7 offset:0
    ds_read_b64_tr_b16 v[34:35], v7 offset:1280
    ds_read_b64_tr_b16 v[36:37], v7 offset:32
    ds_read_b64_tr_b16 v[38:39], v7 offset:1312
    ds_read_b64_tr_b16 v[40:41], v7 offset:64
    ds_read_b64_tr_b16 v[42:43], v7 offset:1344
    ds_read_b128 v[16:19], v6 offset:4096
    ds_read_b128 v[20:23], v6 offset:4352
    ds_read_b64_tr_b16 v[44:45], v7 offset:5120
    ds_read_b64_tr_b16 v[46:47], v7 offset:6400
    ds_read_b64_tr_b16 v[48:49], v7 offset:5152
    ds_read_b64_tr_b16 v[50:51], v7 offset:6432
    ds_read_b64_tr_b16 v[52:53], v7 offset:5184
    ds_read_b64_tr_b16 v[54:55], v7 offset:6464
    s_waitcnt lgkmcnt(8)
    v_mfma_f32_16x16x32_bf16 v[96:99], v[32:35], v[8:11], 0
    ds_read_b128 v[24:27], v6 offset:8192
    ds_read_b128 v[28:31], v6 offset:8448
    v_mfma_f32_16x16x32_bf16 v[100:103], v[32:35], v[12:15], 0
    ds_read_b64_tr_b16 v[56:57], v7 offset:10240
    ds_read_b64_tr_b16 v[58:59], v7 offset:11520
    v_mfma_f32_16x16x32_bf16 v[104:107], v[36:39], v[8:11], 0
    ds_read_b64_tr_b16 v[60:61], v7 offset:10272
    v_mfma_f32_16x16x32_bf16 v[108:111], v[36:39], v[12:15], 0
    ds_read_b64_tr_b16 v[62:63], v7 offset:11552
    v_mfma_f32_16x16x32_bf16 v[112:115], v[40:43], v[8:11], 0
    ds_read_b64_tr_b16 v[64:65], v7 offset:10304
    v_mfma_f32_16x16x32_bf16 v[116:119], v[40:43], v[12:15], 0
    ds_read_b64_tr_b16 v[66:67], v7 offset:11584
    s_waitcnt lgkmcnt(8)
    v_mfma_f32_16x16x32_bf16 v[96:99], v[44:47], v[16:19], v[96:99]
    ds_read_b128 v[8:11], v6 offset:12288
    ds_read_b128 v[12:15], v6 offset:12544
    v_mfma_f32_16x16x32_bf16 v[100:103], v[44:47], v[20:23], v[100:103]
    ds_read_b64_tr_b16 v[32:33], v7 offset:15360
    ds_read_b64_tr_b16 v[34:35], v7 offset:16640
    v_mfma_f32_16x16x32_bf16 v[104:107], v[48:51], v[16:19], v[104:107]
    ds_read_b64_tr_b16 v[36:37], v7 offset:15392
    v_mfma_f32_16x16x32_bf16 v[108:111], v[48:51], v[20:23], v[108:111]
    ds_read_b64_tr_b16 v[38:39], v7 offset:16672
    v_mfma_f32_16x16x32_bf16 v[112:115], v[52:55], v[16:19], v[112:115]
    ds_read_b64_tr_b16 v[40:41], v7 offset:15424
    v_mfma_f32_16x16x32_bf16 v[116:119], v[52:55], v[20:23], v[116:119]
    ds_read_b64_tr_b16 v[42:43], v7 offset:16704
    s_waitcnt lgkmcnt(8)
    v_mfma_f32_16x16x32_bf16 v[96:99], v[56:59], v[24:27], v[96:99]
    s_barrier
    v_add_u32 v120, 36864, v4
    v_add_u32 v121, 36864, v5
    ds_read_b128 v[16:19], v120 offset:0
    ds_read_b128 v[20:23], v120 offset:256
    v_mfma_f32_16x16x32_bf16 v[100:103], v[56:59], v[28:31], v[100:103]
    ds_read_b64_tr_b16 v[44:45], v121 offset:0
    ds_read_b64_tr_b16 v[46:47], v121 offset:1280
    v_mfma_f32_16x16x32_bf16 v[104:107], v[60:63], v[24:27], v[104:107]
    ds_read_b64_tr_b16 v[48:49], v121 offset:32
    v_mfma_f32_16x16x32_bf16 v[108:111], v[60:63], v[28:31], v[108:111]
    ds_read_b64_tr_b16 v[50:51], v121 offset:1312
    v_mfma_f32_16x16x32_bf16 v[112:115], v[64:67], v[24:27], v[112:115]
    ds_read_b64_tr_b16 v[52:53], v121 offset:64
    v_mfma_f32_16x16x32_bf16 v[116:119], v[64:67], v[28:31], v[116:119]
    ds_read_b64_tr_b16 v[54:55], v121 offset:1344
    s_waitcnt lgkmcnt(8)
    v_mfma_f32_16x16x32_bf16 v[96:99], v[32:35], v[8:11], v[96:99]
    ds_read_b128 v[24:27], v120 offset:4096
    ds_read_b128 v[28:31], v120 offset:4352
    v_mfma_f32_16x16x32_bf16 v[100:103], v[32:35], v[12:15], v[100:103]
    ds_read_b64_tr_b16 v[56:57], v121 offset:5120
    ds_read_b64_tr_b16 v[58:59], v121 offset:6400
    v_mfma_f32_16x16x32_bf16 v[104:107], v[36:39], v[8:11], v[104:107]
    ds_read_b64_tr_b16 v[60:61], v121 offset:5152
    v_mfma_f32_16x16x32_bf16 v[108:111], v[36:39], v[12:15], v[108:111]
    ds_read_b64_tr_b16 v[62:63], v121 offset:6432
    v_mfma_f32_16x16x32_bf16 v[112:115], v[40:43], v[8:11], v[112:115]
    ds_read_b64_tr_b16 v[64:65], v121 offset:5184
    v_mfma_f32_16x16x32_bf16 v[116:119], v[40:43], v[12:15], v[116:119]
    ds_read_b64_tr_b16 v[66:67], v121 offset:6464
    s_waitcnt lgkmcnt(8)
    v_mfma_f32_16x16x32_bf16 v[96:99], v[44:47], v[16:19], v[96:99]
    ds_read_b128 v[8:11], v120 offset:8192
    ds_read_b128 v[12:15], v120 offset:8448
    v_mfma_f32_16x16x32_bf16 v[100:103], v[44:47], v[20:23], v[100:103]
    ds_read_b64_tr_b16 v[32:33], v121 offset:10240
    ds_read_b64_tr_b16 v[34:35], v121 offset:11520
    v_mfma_f32_16x16x32_bf16 v[104:107], v[48:51], v[16:19], v[104:107]
    ds_read_b64_tr_b16 v[36:37], v121 offset:10272
    v_mfma_f32_16x16x32_bf16 v[108:111], v[48:51], v[20:23], v[108:111]
    ds_read_b64_tr_b16 v[38:39], v121 offset:11552
    v_mfma_f32_16x16x32_bf16 v[112:115], v[52:55], v[16:19], v[112:115]
    ds_read_b64_tr_b16 v[40:41], v121 offset:10304
    v_mfma_f32_16x16x32_bf16 v[116:119], v[52:55], v[20:23], v[116:119]
    ds_read_b64_tr_b16 v[42:43], v121 offset:11584
    s_waitcnt lgkmcnt(8)
    v_mfma_f32_16x16x32_bf16 v[96:99], v[56:59], v[24:27], v[96:99]
    ds_read_b128 v[16:19], v120 offset:12288
    ds_read_b128 v[20:23], v120 offset:12544
    v_mfma_f32_16x16x32_bf16 v[100:103], v[56:59], v[28:31], v[100:103]
    ds_read_b64_tr_b16 v[44:45], v121 offset:15360
    ds_read_b64_tr_b16 v[46:47], v121 offset:16640
    v_mfma_f32_16x16x32_bf16 v[104:107], v[60:63], v[24:27], v[104:107]
    ds_read_b64_tr_b16 v[48:49], v121 offset:15392
    v_mfma_f32_16x16x32_bf16 v[108:111], v[60:63], v[28:31], v[108:111]
    ds_read_b64_tr_b16 v[50:51], v121 offset:16672
    v_mfma_f32_16x16x32_bf16 v[112:115], v[64:67], v[24:27], v[112:115]
    ds_read_b64_tr_b16 v[52:53], v121 offset:15424
    v_mfma_f32_16x16x32_bf16 v[116:119], v[64:67], v[28:31], v[116:119]
    ds_read_b64_tr_b16 v[54:55], v121 offset:16704
    s_waitcnt lgkmcnt(8)
    v_mfma_f32_16x16x32_bf16 v[96:99], v[32:35], v[8:11], v[96:99]
    s_barrier
    v_add_u32 v6, 73728, v4
    v_add_u32 v7, 73728, v5
    ds_read_b128 v[24:27], v6 offset:0
    ds_read_b128 v[28:31], v6 offset:256
    v_mfma_f32_16x16x32_bf16 v[100:103], v[32:35], v[12:15], v[100:103]
    ds_read_b64_tr_b16 v[56:57], v7 offset:0
    ds_read_b64_tr_b16 v[58:59], v7 offset:1280
    v_mfma_f32_16x16x32_bf16 v[104:107], v[36:39], v[8:11], v[104:107]
    ds_read_b64_tr_b16 v[60:61], v7 offset:32
    v_mfma_f32_16x16x32_bf16 v[108:111], v[36:39], v[12:15], v[108:111]
    ds_read_b64_tr_b16 v[62:63], v7 offset:1312
    v_mfma_f32_16x16x32_bf16 v[112:115], v[40:43], v[8:11], v[112:115]
    ds_read_b64_tr_b16 v[64:65], v7 offset:64
    v_mfma_f32_16x16x32_bf16 v[116:119], v[40:43], v[12:15], v[116:119]
    ds_read_b64_tr_b16 v[66:67], v7 offset:1344
    s_waitcnt lgkmcnt(8)
    v_mfma_f32_16x16x32_bf16 v[96:99], v[44:47], v[16:19], v[96:99]
    ds_read_b128 v[8:11], v6 offset:4096
    ds_read_b128 v[12:15], v6 offset:4352
    v_mfma_f32_16x16x32_bf16 v[100:103], v[44:47], v[20:23], v[100:103]
    ds_read_b64_tr_b16 v[32:33], v7 offset:5120
    ds_read_b64_tr_b16 v[34:35], v7 offset:6400
    v_mfma_f32_16x16x32_bf16 v[104:107], v[48:51], v[16:19], v[104:107]
    ds_read_b64_tr_b16 v[36:37], v7 offset:5152
    v_mfma_f32_16x16x32_bf16 v[108:111], v[48:51], v[20:23], v[108:111]
    ds_read_b64_tr_b16 v[38:39], v7 offset:6432
    v_mfma_f32_16x16x32_bf16 v[112:115], v[52:55], v[16:19], v[112:115]
    ds_read_b64_tr_b16 v[40:41], v7 offset:5184
    v_mfma_f32_16x16x32_bf16 v[116:119], v[52:55], v[20:23], v[116:119]
    ds_read_b64_tr_b16 v[42:43], v7 offset:6464
    s_waitcnt lgkmcnt(8)
    v_mfma_f32_16x16x32_bf16 v[96:99], v[56:59], v[24:27], v[96:99]
    ds_read_b128 v[16:19], v6 offset:8192
    ds_read_b128 v[20:23], v6 offset:8448
    v_mfma_f32_16x16x32_bf16 v[100:103], v[56:59], v[28:31], v[100:103]
    ds_read_b64_tr_b16 v[44:45], v7 offset:10240
    ds_read_b64_tr_b16 v[46:47], v7 offset:11520
    v_mfma_f32_16x16x32_bf16 v[104:107], v[60:63], v[24:27], v[104:107]
    ds_read_b64_tr_b16 v[48:49], v7 offset:10272
    v_mfma_f32_16x16x32_bf16 v[108:111], v[60:63], v[28:31], v[108:111]
    ds_read_b64_tr_b16 v[50:51], v7 offset:11552
    v_mfma_f32_16x16x32_bf16 v[112:115], v[64:67], v[24:27], v[112:115]
    ds_read_b64_tr_b16 v[52:53], v7 offset:10304
    v_mfma_f32_16x16x32_bf16 v[116:119], v[64:67], v[28:31], v[116:119]
    ds_read_b64_tr_b16 v[54:55], v7 offset:11584
    s_waitcnt lgkmcnt(8)
    v_mfma_f32_16x16x32_bf16 v[96:99], v[32:35], v[8:11], v[96:99]
    ds_read_b128 v[24:27], v6 offset:12288
    ds_read_b128 v[28:31], v6 offset:12544
    v_mfma_f32_16x16x32_bf16 v[100:103], v[32:35], v[12:15], v[100:103]
    ds_read_b64_tr_b16 v[56:57], v7 offset:15360
    ds_read_b64_tr_b16 v[58:59], v7 offset:16640
    v_mfma_f32_16x16x32_bf16 v[104:107], v[36:39], v[8:11], v[104:107]
    ds_read_b64_tr_b16 v[60:61], v7 offset:15392
    v_mfma_f32_16x16x32_bf16 v[108:111], v[36:39], v[12:15], v[108:111]
    ds_read_b64_tr_b16 v[62:63], v7 offset:16672
    v_mfma_f32_16x16x32_bf16 v[112:115], v[40:43], v[8:11], v[112:115]
    ds_read_b64_tr_b16 v[64:65], v7 offset:15424
    v_mfma_f32_16x16x32_bf16 v[116:119], v[40:43], v[12:15], v[116:119]
    ds_read_b64_tr_b16 v[66:67], v7 offset:16704
    s_waitcnt lgkmcnt(8)
    v_mfma_f32_16x16x32_bf16 v[96:99], v[44:47], v[16:19], v[96:99]
    s_barrier
    v_add_u32 v120, 110592, v4
    v_add_u32 v121, 110592, v5
    ds_read_b128 v[8:11], v120 offset:0
    ds_read_b128 v[12:15], v120 offset:256
    v_mfma_f32_16x16x32_bf16 v[100:103], v[44:47], v[20:23], v[100:103]
    ds_read_b64_tr_b16 v[32:33], v121 offset:0
    ds_read_b64_tr_b16 v[34:35], v121 offset:1280
    v_mfma_f32_16x16x32_bf16 v[104:107], v[48:51], v[16:19], v[104:107]
    ds_read_b64_tr_b16 v[36:37], v121 offset:32
    v_mfma_f32_16x16x32_bf16 v[108:111], v[48:51], v[20:23], v[108:111]
    ds_read_b64_tr_b16 v[38:39], v121 offset:1312
    v_mfma_f32_16x16x32_bf16 v[112:115], v[52:55], v[16:19], v[112:115]
    ds_read_b64_tr_b16 v[40:41], v121 offset:64
    v_mfma_f32_16x16x32_bf16 v[116:119], v[52:55], v[20:23], v[116:119]
    ds_read_b64_tr_b16 v[42:43], v121 offset:1344
    s_waitcnt lgkmcnt(8)
    v_mfma_f32_16x16x32_bf16 v[96:99], v[56:59], v[24:27], v[96:99]
    ds_read_b128 v[16:19], v120 offset:4096
    ds_read_b128 v[20:23], v120 offset:4352
    v_mfma_f32_16x16x32_bf16 v[100:103], v[56:59], v[28:31], v[100:103]
    ds_read_b64_tr_b16 v[44:45], v121 offset:5120
    ds_read_b64_tr_b16 v[46:47], v121 offset:6400
    v_mfma_f32_16x16x32_bf16 v[104:107], v[60:63], v[24:27], v[104:107]
    ds_read_b64_tr_b16 v[48:49], v121 offset:5152
    v_mfma_f32_16x16x32_bf16 v[108:111], v[60:63], v[28:31], v[108:111]
    ds_read_b64_tr_b16 v[50:51], v121 offset:6432
    v_mfma_f32_16x16x32_bf16 v[112:115], v[64:67], v[24:27], v[112:115]
    ds_read_b64_tr_b16 v[52:53], v121 offset:5184
    v_mfma_f32_16x16x32_bf16 v[116:119], v[64:67], v[28:31], v[116:119]
    ds_read_b64_tr_b16 v[54:55], v121 offset:6464
    s_waitcnt lgkmcnt(8)
    v_mfma_f32_16x16x32_bf16 v[96:99], v[32:35], v[8:11], v[96:99]
    ds_read_b128 v[24:27], v120 offset:8192
    ds_read_b128 v[28:31], v120 offset:8448
    v_mfma_f32_16x16x32_bf16 v[100:103], v[32:35], v[12:15], v[100:103]
    ds_read_b64_tr_b16 v[56:57], v121 offset:10240
    ds_read_b64_tr_b16 v[58:59], v121 offset:11520
    v_mfma_f32_16x16x32_bf16 v[104:107], v[36:39], v[8:11], v[104:107]
    ds_read_b64_tr_b16 v[60:61], v121 offset:10272
    v_mfma_f32_16x16x32_bf16 v[108:111], v[36:39], v[12:15], v[108:111]
    ds_read_b64_tr_b16 v[62:63], v121 offset:11552
    v_mfma_f32_16x16x32_bf16 v[112:115], v[40:43], v[8:11], v[112:115]
    ds_read_b64_tr_b16 v[64:65], v121 offset:10304
    v_mfma_f32_16x16x32_bf16 v[116:119], v[40:43], v[12:15], v[116:119]
    ds_read_b64_tr_b16 v[66:67], v121 offset:11584
    s_waitcnt lgkmcnt(8)
    v_mfma_f32_16x16x32_bf16 v[96:99], v[44:47], v[16:19], v[96:99]
    ds_read_b128 v[8:11], v120 offset:12288
    ds_read_b128 v[12:15], v120 offset:12544
    v_mfma_f32_16x16x32_bf16 v[100:103], v[44:47], v[20:23], v[100:103]
    ds_read_b64_tr_b16 v[32:33], v121 offset:15360
    ds_read_b64_tr_b16 v[34:35], v121 offset:16640
    v_mfma_f32_16x16x32_bf16 v[104:107], v[48:51], v[16:19], v[104:107]
    ds_read_b64_tr_b16 v[36:37], v121 offset:15392
    v_mfma_f32_16x16x32_bf16 v[108:111], v[48:51], v[20:23], v[108:111]
    ds_read_b64_tr_b16 v[38:39], v121 offset:16672
    v_mfma_f32_16x16x32_bf16 v[112:115], v[52:55], v[16:19], v[112:115]
    ds_read_b64_tr_b16 v[40:41], v121 offset:15424
    v_mfma_f32_16x16x32_bf16 v[116:119], v[52:55], v[20:23], v[116:119]
    ds_read_b64_tr_b16 v[42:43], v121 offset:16704
    s_waitcnt lgkmcnt(8)
    v_mfma_f32_16x16x32_bf16 v[96:99], v[56:59], v[24:27], v[96:99]
    s_barrier
    v_add_u32 v6, 0, v4
    v_add_u32 v7, 0, v5
    ds_read_b128 v[16:19], v6 offset:0
    ds_read_b128 v[20:23], v6 offset:256
    v_mfma_f32_16x16x32_bf16 v[100:103], v[56:59], v[28:31], v[100:103]
    ds_read_b64_tr_b16 v[44:45], v7 offset:0
    ds_read_b64_tr_b16 v[46:47], v7 offset:1280
    v_mfma_f32_16x16x32_bf16 v[104:107], v[60:63], v[24:27], v[104:107]
    ds_read_b64_tr_b16 v[48:49], v7 offset:32
    v_mfma_f32_16x16x32_bf16 v[108:111], v[60:63], v[28:31], v[108:111]
    ds_read_b64_tr_b16 v[50:51], v7 offset:1312
    v_mfma_f32_16x16x32_bf16 v[112:115], v[64:67], v[24:27], v[112:115]
    ds_read_b64_tr_b16 v[52:53], v7 offset:64
    v_mfma_f32_16x16x32_bf16 v[116:119], v[64:67], v[28:31], v[116:119]
    ds_read_b64_tr_b16 v[54:55], v7 offset:1344
    s_waitcnt lgkmcnt(8)
    v_mfma_f32_16x16x32_bf16 v[96:99], v[32:35], v[8:11], v[96:99]
    ds_read_b128 v[24:27], v6 offset:4096
    ds_read_b128 v[28:31], v6 offset:4352
    v_mfma_f32_16x16x32_bf16 v[100:103], v[32:35], v[12:15], v[100:103]
    ds_read_b64_tr_b16 v[56:57], v7 offset:5120
    ds_read_b64_tr_b16 v[58:59], v7 offset:6400
    v_mfma_f32_16x16x32_bf16 v[104:107], v[36:39], v[8:11], v[104:107]
    ds_read_b64_tr_b16 v[60:61], v7 offset:5152
    v_mfma_f32_16x16x32_bf16 v[108:111], v[36:39], v[12:15], v[108:111]
    ds_read_b64_tr_b16 v[62:63], v7 offset:6432
    v_mfma_f32_16x16x32_bf16 v[112:115], v[40:43], v[8:11], v[112:115]
    ds_read_b64_tr_b16 v[64:65], v7 offset:5184
    v_mfma_f32_16x16x32_bf16 v[116:119], v[40:43], v[12:15], v[116:119]
    ds_read_b64_tr_b16 v[66:67], v7 offset:6464
    s_waitcnt lgkmcnt(8)
    v_mfma_f32_16x16x32_bf16 v[96:99], v[44:47], v[16:19], v[96:99]
    ds_read_b128 v[8:11], v6 offset:8192
    ds_read_b128 v[12:15], v6 offset:8448
    v_mfma_f32_16x16x32_bf16 v[100:103], v[44:47], v[20:23], v[100:103]
    ds_read_b64_tr_b16 v[32:33], v7 offset:10240
    ds_read_b64_tr_b16 v[34:35], v7 offset:11520
    v_mfma_f32_16x16x32_bf16 v[104:107], v[48:51], v[16:19], v[104:107]
    ds_read_b64_tr_b16 v[36:37], v7 offset:10272
    v_mfma_f32_16x16x32_bf16 v[108:111], v[48:51], v[20:23], v[108:111]
    ds_read_b64_tr_b16 v[38:39], v7 offset:11552
    v_mfma_f32_16x16x32_bf16 v[112:115], v[52:55], v[16:19], v[112:115]
    ds_read_b64_tr_b16 v[40:41], v7 offset:10304
    v_mfma_f32_16x16x32_bf16 v[116:119], v[52:55], v[20:23], v[116:119]
    ds_read_b64_tr_b16 v[42:43], v7 offset:11584
    s_waitcnt lgkmcnt(8)
    v_mfma_f32_16x16x32_bf16 v[96:99], v[56:59], v[24:27], v[96:99]
    ds_read_b128 v[16:19], v6 offset:12288
    ds_read_b128 v[20:23], v6 offset:12544
    v_mfma_f32_16x16x32_bf16 v[100:103], v[56:59], v[28:31], v[100:103]
    ds_read_b64_tr_b16 v[44:45], v7 offset:15360
    ds_read_b64_tr_b16 v[46:47], v7 offset:16640
    v_mfma_f32_16x16x32_bf16 v[104:107], v[60:63], v[24:27], v[104:107]
    ds_read_b64_tr_b16 v[48:49], v7 offset:15392
    v_mfma_f32_16x16x32_bf16 v[108:111], v[60:63], v[28:31], v[108:111]
    ds_read_b64_tr_b16 v[50:51], v7 offset:16672
    v_mfma_f32_16x16x32_bf16 v[112:115], v[64:67], v[24:27], v[112:115]
    ds_read_b64_tr_b16 v[52:53], v7 offset:15424
    v_mfma_f32_16x16x32_bf16 v[116:119], v[64:67], v[28:31], v[116:119]
    ds_read_b64_tr_b16 v[54:55], v7 offset:16704
    s_waitcnt lgkmcnt(8)
    v_mfma_f32_16x16x32_bf16 v[96:99], v[32:35], v[8:11], v[96:99]
    v_mfma_f32_16x16x32_bf16 v[100:103], v[32:35], v[12:15], v[100:103]
    v_mfma_f32_16x16x32_bf16 v[104:107], v[36:39], v[8:11], v[104:107]
    v_mfma_f32_16x16x32_bf16 v[108:111], v[36:39], v[12:15], v[108:111]
    v_mfma_f32_16x16x32_bf16 v[112:115], v[40:43], v[8:11], v[112:115]
    v_mfma_f32_16x16x32_bf16 v[116:119], v[40:43], v[12:15], v[116:119]
    s_waitcnt lgkmcnt(0)
    v_mfma_f32_16x16x32_bf16 v[96:99], v[44:47], v[16:19], v[96:99]
    v_mfma_f32_16x16x32_bf16 v[100:103], v[44:47], v[20:23], v[100:103]
    v_mfma_f32_16x16x32_bf16 v[104:107], v[48:51], v[16:19], v[104:107]
    v_mfma_f32_16x16x32_bf16 v[108:111], v[48:51], v[20:23], v[108:111]
    v_mfma_f32_16x16x32_bf16 v[112:115], v[52:55], v[16:19], v[112:115]
    v_mfma_f32_16x16x32_bf16 v[116:119], v[52:55], v[20:23], v[116:119]
    s_nop 7
    s_barrier
    s_waitcnt vmcnt(0)
    v_lshlrev_b32 v24, 16, v70
    v_and_b32 v25, 0xffff0000, v70
    v_lshlrev_b32 v26, 16, v71
    v_and_b32 v27, 0xffff0000, v71
    v_add_f32 v96, v96, v24
    v_add_f32 v97, v97, v25
    v_add_f32 v98, v98, v26
    v_add_f32 v99, v99, v27
    v_cvt_pk_bf16_f32 v8, v96, v97
    v_cvt_pk_bf16_f32 v9, v98, v99
    s_mov_b32 s23, 0
    s_cmp_eq_u32 s74, 0
    s_cbranch_scc1 L_slow_93
    buffer_store_dwordx2 v[8:9], v86, s[16:19], s23 offen
    s_branch L_dd_94
L_slow_93:
    buffer_store_dwordx2 v[8:9], v86, s[16:19], s23 offen sc1
L_dd_94:
    v_lshlrev_b32 v24, 16, v72
    v_and_b32 v25, 0xffff0000, v72
    v_lshlrev_b32 v26, 16, v73
    v_and_b32 v27, 0xffff0000, v73
    v_add_f32 v100, v100, v24
    v_add_f32 v101, v101, v25
    v_add_f32 v102, v102, v26
    v_add_f32 v103, v103, v27
    v_cvt_pk_bf16_f32 v10, v100, v101
    v_cvt_pk_bf16_f32 v11, v102, v103
    s_mov_b32 s23, 256
    s_cmp_eq_u32 s74, 0
    s_cbranch_scc1 L_slow_95
    buffer_store_dwordx2 v[10:11], v86, s[16:19], s23 offen
    s_branch L_dd_96
L_slow_95:
    buffer_store_dwordx2 v[10:11], v86, s[16:19], s23 offen sc1
L_dd_96:
    v_lshlrev_b32 v24, 16, v74
    v_and_b32 v25, 0xffff0000, v74
    v_lshlrev_b32 v26, 16, v75
    v_and_b32 v27, 0xffff0000, v75
    v_add_f32 v104, v104, v24
    v_add_f32 v105, v105, v25
    v_add_f32 v106, v106, v26
    v_add_f32 v107, v107, v27
    v_cvt_pk_bf16_f32 v12, v104, v105
    v_cvt_pk_bf16_f32 v13, v106, v107
    s_mov_b32 s23, 65536
    s_cmp_eq_u32 s74, 0
    s_cbranch_scc1 L_slow_97
    buffer_store_dwordx2 v[12:13], v86, s[16:19], s23 offen
    s_branch L_dd_98
L_slow_97:
    buffer_store_dwordx2 v[12:13], v86, s[16:19], s23 offen sc1
L_dd_98:
    v_lshlrev_b32 v24, 16, v76
    v_and_b32 v25, 0xffff0000, v76
    v_lshlrev_b32 v26, 16, v77
    v_and_b32 v27, 0xffff0000, v77
    v_add_f32 v108, v108, v24
    v_add_f32 v109, v109, v25
    v_add_f32 v110, v110, v26
    v_add_f32 v111, v111, v27
    v_cvt_pk_bf16_f32 v14, v108, v109
    v_cvt_pk_bf16_f32 v15, v110, v111
    s_mov_b32 s23, 65792
    s_cmp_eq_u32 s74, 0
    s_cbranch_scc1 L_slow_99
    buffer_store_dwordx2 v[14:15], v86, s[16:19], s23 offen
    s_branch L_dd_100
L_slow_99:
    buffer_store_dwordx2 v[14:15], v86, s[16:19], s23 offen sc1
L_dd_100:
    v_lshlrev_b32 v24, 16, v78
    v_and_b32 v25, 0xffff0000, v78
    v_lshlrev_b32 v26, 16, v79
    v_and_b32 v27, 0xffff0000, v79
    v_add_f32 v112, v112, v24
    v_add_f32 v113, v113, v25
    v_add_f32 v114, v114, v26
    v_add_f32 v115, v115, v27
    v_cvt_pk_bf16_f32 v16, v112, v113
    v_cvt_pk_bf16_f32 v17, v114, v115
    s_add_u32 s23, s44, 131072
    s_cmp_eq_u32 s74, 0
    s_cbranch_scc1 L_slow_101
    buffer_store_dwordx2 v[16:17], v86, s[16:19], s23 offen
    s_branch L_dd_102
L_slow_101:
    buffer_store_dwordx2 v[16:17], v86, s[16:19], s23 offen sc1
L_dd_102:
    v_lshlrev_b32 v24, 16, v80
    v_and_b32 v25, 0xffff0000, v80
    v_lshlrev_b32 v26, 16, v81
    v_and_b32 v27, 0xffff0000, v81
    v_add_f32 v116, v116, v24
    v_add_f32 v117, v117, v25
    v_add_f32 v118, v118, v26
    v_add_f32 v119, v119, v27
    v_cvt_pk_bf16_f32 v18, v116, v117
    v_cvt_pk_bf16_f32 v19, v118, v119
    s_add_u32 s23, s44, 131328
    s_cmp_eq_u32 s74, 0
    s_cbranch_scc1 L_slow_103
    buffer_store_dwordx2 v[18:19], v86, s[16:19], s23 offen
    s_branch L_dd_104
L_slow_103:
    buffer_store_dwordx2 v[18:19], v86, s[16:19], s23 offen sc1
L_dd_104:
    v_lshlrev_b32 v24, 16, v8
    v_and_b32 v25, 0xffff0000, v8
    v_add_f32 v28, v24, v25
    v_mul_f32 v29, v24, v24
    v_fmac_f32 v29, v25, v25
    v_lshlrev_b32 v24, 16, v9
    v_and_b32 v25, 0xffff0000, v9
    v_add_f32 v28, v28, v24
    v_add_f32 v28, v28, v25
    v_fmac_f32 v29, v24, v24
    v_fmac_f32 v29, v25, v25
    v_lshlrev_b32 v24, 16, v12
    v_and_b32 v25, 0xffff0000, v12
    v_add_f32 v28, v28, v24
    v_add_f32 v28, v28, v25
    v_fmac_f32 v29, v24, v24
    v_fmac_f32 v29, v25, v25
    v_lshlrev_b32 v24, 16, v13
    v_and_b32 v25, 0xffff0000, v13
    v_add_f32 v28, v28, v24
    v_add_f32 v28, v28, v25
    v_fmac_f32 v29, v24, v24
    v_fmac_f32 v29, v25, v25
    v_lshlrev_b32 v24, 16, v16
    v_and_b32 v25, 0xffff0000, v16
    v_cndmask_b32 v24, v24, 0, s[46:47]
    v_cndmask_b32 v25, v25, 0, s[46:47]
    v_add_f32 v28, v28, v24
    v_add_f32 v28, v28, v25
    v_fmac_f32 v29, v24, v24
    v_fmac_f32 v29, v25, v25
    v_lshlrev_b32 v24, 16, v17
    v_and_b32 v25, 0xffff0000, v17
    v_cndmask_b32 v24, v24, 0, s[46:47]
    v_cndmask_b32 v25, v25, 0, s[46:47]
    v_add_f32 v28, v28, v24
    v_add_f32 v28, v28, v25
    v_fmac_f32 v29, v24, v24
    v_fmac_f32 v29, v25, v25
    v_lshlrev_b32 v24, 16, v10
    v_and_b32 v25, 0xffff0000, v10
    v_add_f32 v30, v24, v25
    v_mul_f32 v31, v24, v24
    v_fmac_f32 v31, v25, v25
    v_lshlrev_b32 v24, 16, v11
    v_and_b32 v25, 0xffff0000, v11
    v_add_f32 v30, v30, v24
    v_add_f32 v30, v30, v25
    v_fmac_f32 v31, v24, v24
    v_fmac_f32 v31, v25, v25
    v_lshlrev_b32 v24, 16, v14
    v_and_b32 v25, 0xffff0000, v14
    v_add_f32 v30, v30, v24
    v_add_f32 v30, v30, v25
    v_fmac_f32 v31, v24, v24
    v_fmac_f32 v31, v25, v25
    v_lshlrev_b32 v24, 16, v15
    v_and_b32 v25, 0xffff0000, v15
    v_add_f32 v30, v30, v24
    v_add_f32 v30, v30, v25
    v_fmac_f32 v31, v24, v24
    v_fmac_f32 v31, v25, v25
    v_lshlrev_b32 v24, 16, v18
    v_and_b32 v25, 0xffff0000, v18
    v_cndmask_b32 v24, v24, 0, s[46:47]
    v_cndmask_b32 v25, v25, 0, s[46:47]
    v_add_f32 v30, v30, v24
    v_add_f32 v30, v30, v25
    v_fmac_f32 v31, v24, v24
    v_fmac_f32 v31, v25, v25
    v_lshlrev_b32 v24, 16, v19
    v_and_b32 v25, 0xffff0000, v19
    v_cndmask_b32 v24, v24, 0, s[46:47]
    v_cndmask_b32 v25, v25, 0, s[46:47]
    v_add_f32 v30, v30, v24
    v_add_f32 v30, v30, v25
    v_fmac_f32 v31, v24, v24
    v_fmac_f32 v31, v25, v25
    v_mov_b32 v32, v28
    v_mov_b32 v33, v29
    v_mov_b32 v34, v30
    v_mov_b32 v35, v31
    s_nop 1
    v_permlane32_swap_b32 v28, v32
    v_permlane32_swap_b32 v29, v33
    v_permlane32_swap_b32 v30, v34
    v_permlane32_swap_b32 v31, v35
    s_nop 1
    v_add_f32 v28, v28, v32
    v_add_f32 v29, v29, v33
    v_add_f32 v30, v30, v34
    v_add_f32 v31, v31, v35
    s_nop 0
    v_mov_b32 v32, v28
    v_mov_b32 v33, v29
    v_mov_b32 v34, v30
    v_mov_b32 v35, v31
    s_nop 1
    v_permlane16_swap_b32 v28, v32
    v_permlane16_swap_b32 v29, v33
    v_permlane16_swap_b32 v30, v34
    v_permlane16_swap_b32 v31, v35
    s_nop 1
    v_add_f32 v28, v28, v32
    v_add_f32 v29, v29, v33
    v_add_f32 v30, v30, v34
    v_add_f32 v31, v31, v35
    s_lshl_b32 s23, s26, 1
    s_add_u32 s23, s23, s30
    s_lshl_b32 s23, s23, 14
    s_add_u32 s23, s23, 20439040
    v_lshlrev_b32 v32, 3, v84
    s_mov_b64 exec, 0xffff
    s_cmp_eq_u32 s74, 0
    s_cbranch_scc1 L_slow_105
    buffer_store_dwordx2 v[28:29], v32, s[80:83], s23 offen
    buffer_store_dwordx2 v[30:31], v32, s[80:83], s23 offen offset:128
    s_branch L_dd_106
L_slow_105:
    buffer_store_dwordx2 v[28:29], v32, s[80:83], s23 offen sc1
    buffer_store_dwordx2 v[30:31], v32, s[80:83], s23 offen offset:128 sc1
L_dd_106:
    s_mov_b64 exec, -1
    s_waitcnt vmcnt(0)
    s_barrier
    s_cmp_eq_u32 s100, 0
    s_cbranch_scc0 L_oa2_107
    s_lshr_b32 s40, s21, 7
    s_add_u32 s40, s40, 32
    s_lshr_b32 s41, s21, 6
    s_and_b32 s41, s41, 1
    s_lshl_b32 s41, s41, 3
    s_add_u32 s41, s41, s26
    s_lshl_b32 s101, s40, 7
    s_add_u32 s101, s101, 23814144
    s_lshl_b32 s75, s41, 2
    s_add_u32 s101, s101, s75
    v_mov_b32 v4, s101
    v_mov_b32 v5, 1
    s_mov_b64 exec, 1
    s_cmp_eq_u32 s74, 0
    s_cbranch_scc1 L_slow_108
    buffer_store_dword v5, v4, s[80:83], 0 offen
    s_branch L_dd_109
L_slow_108:
    buffer_store_dword v5, v4, s[80:83], 0 offen sc1
L_dd_109:
    s_mov_b64 exec, -1
L_oa2_107:
    v_mbcnt_lo_u32_b32 v1, -1, 0
    v_mbcnt_hi_u32_b32 v1, -1, v1
    s_and_b32 s26, s73, 1
    s_lshl_b32 s21, s72, 1
    s_add_u32 s21, s21, s26
    s_lshl_b32 s21, s21, 7
    s_lshr_b32 s34, s73, 1
    s_cmp_ge_u32 s34, 14
    s_cbranch_scc1 L_f2_compute0
    s_lshl_b32 s22, s34, 7
    s_mul_i32 s35, s34, 3
    s_mul_i32 s23, s26, 5
    s_add_u32 s35, s35, s23
    s_mul_i32 s23, s35, 0xcccd
    s_lshr_b32 s23, s23, 19
    s_mul_i32 s23, s23, 10
    s_sub_u32 s35, s35, s23
    s_branch L_f1_compute
L_f1_loader:
    s_cmp_eq_u32 s100, 4
    s_cbranch_scc0 L_fw_110
    s_lshr_b32 s40, s21, 7
    s_add_u32 s40, s40, 32
    s_lshl_b32 s101, s40, 7
    s_add_u32 s101, s101, 23814144
    v_lshlrev_b32 v9, 2, v1
    v_add_u32 v9, s101, v9
    v_mov_b32 v10, 1
    s_mov_b64 exec, 0xffff
    s_mov_b32 s101, 0
L_poll_111:
    buffer_load_dword v8, v9, s[80:83], 0 offen sc1
    s_waitcnt vmcnt(0)
    v_cmp_gt_u32 vcc, v10, v8
    s_nop 4
    s_cmp_eq_u64 vcc, 0
    s_cbranch_scc1 L_pollok_112
    s_add_u32 s101, s101, 1
    s_cmp_gt_u32 s101, 262144
    s_cbranch_scc1 L_pollok_112
    s_sleep 1
    s_branch L_poll_111
L_pollok_112:
    s_mov_b64 exec, -1
L_fw_110:
    s_barrier
    s_add_u32 m0, s31, 0
    s_mov_b32 s23, s29
    buffer_load_dwordx4 v4, s[8:11], s23 offen  lds
    s_add_u32 m0, m0, 1024
    s_nop 0
    buffer_load_dwordx4 v5, s[8:11], s23 offen  lds
    s_add_u32 m0, m0, 1024
    s_add_u32 s23, s23, 32768
    buffer_load_dwordx4 v4, s[8:11], s23 offen  lds
    s_add_u32 m0, m0, 1024
    s_nop 0
    buffer_load_dwordx4 v5, s[8:11], s23 offen  lds
    s_add_u32 s35, s35, 1
    s_cmp_eq_u32 s35, 10
    s_cselect_b32 s23, 2621440, 0
    s_cselect_b32 s35, 0, s35
    s_add_u32 s29, s29, 262144
    s_sub_u32 s29, s29, s23
    s_add_u32 m0, s31, 32768
    s_mov_b32 s23, s29
    buffer_load_dwordx4 v4, s[8:11], s23 offen  lds
    s_add_u32 m0, m0, 1024
    s_nop 0
    buffer_load_dwordx4 v5, s[8:11], s23 offen  lds
    s_add_u32 m0, m0, 1024
    s_add_u32 s23, s23, 32768
    buffer_load_dwordx4 v4, s[8:11], s23 offen  lds
    s_add_u32 m0, m0, 1024
    s_nop 0
    buffer_load_dwordx4 v5, s[8:11], s23 offen  lds
    s_add_u32 s35, s35, 1
    s_cmp_eq_u32 s35, 10
    s_cselect_b32 s23, 2621440, 0
    s_cselect_b32 s35, 0, s35
    s_add_u32 s29, s29, 262144
    s_sub_u32 s29, s29, s23
    s_waitcnt vmcnt(4) lgkmcnt(0)
    s_barrier
    s_add_u32 m0, s31, 65536
    s_mov_b32 s23, s29
    buffer_load_dwordx4 v4, s[8:11], s23 offen  lds
    s_add_u32 m0, m0, 1024
    s_nop 0
    buffer_load_dwordx4 v5, s[8:11], s23 offen  lds
    s_add_u32 m0, m0, 1024
    s_add_u32 s23, s23, 32768
    buffer_load_dwordx4 v4, s[8:11], s23 offen  lds
    s_add_u32 m0, m0, 1024
    s_nop 0
    buffer_load_dwordx4 v5, s[8:11], s23 offen  lds
    s_add_u32 s35, s35, 1
    s_cmp_eq_u32 s35, 10
    s_cselect_b32 s23, 2621440, 0
    s_cselect_b32 s35, 0, s35
    s_add_u32 s29, s29, 262144
    s_sub_u32 s29, s29, s23
    s_add_u32 m0, s31, 81920
    s_mov_b32 s23, s30
    buffer_load_dwordx4 v6, s[12:15], s23 offen  lds
    s_add_u32 m0, m0, 1024
    s_add_u32 s23, s23, 13824
    buffer_load_dwordx4 v6, s[12:15], s23 offen  lds
    s_add_u32 m0, m0, 1024
    s_add_u32 s23, s23, 13824
    buffer_load_dwordx4 v6, s[12:15], s23 offen  lds
    s_add_u32 m0, m0, 1024
    s_add_u32 s23, s23, 13824
    buffer_load_dwordx4 v6, s[12:15], s23 offen  lds
    s_add_u32 s36, s36, 1
    s_cmp_eq_u32 s36, 10
    s_cselect_b32 s23, 2211840, 0
    s_cselect_b32 s36, 0, s36
    s_add_u32 s30, s30, 221184
    s_sub_u32 s30, s30, s23
    s_waitcnt vmcnt(8) lgkmcnt(0)
    s_barrier
    s_add_u32 m0, s31, 98304
    s_mov_b32 s23, s29
    buffer_load_dwordx4 v4, s[8:11], s23 offen  lds
    s_add_u32 m0, m0, 1024
    s_nop 0
    buffer_load_dwordx4 v5, s[8:11], s23 offen  lds
    s_add_u32 m0, m0, 1024
    s_add_u32 s23, s23, 32768
    buffer_load_dwordx4 v4, s[8:11], s23 offen  lds
    s_add_u32 m0, m0, 1024
    s_nop 0
    buffer_load_dwordx4 v5, s[8:11], s23 offen  lds
    s_add_u32 s35, s35, 1
    s_cmp_eq_u32 s35, 10
    s_cselect_b32 s23, 2621440, 0
    s_cselect_b32 s35, 0, s35
    s_add_u32 s29, s29, 262144
    s_sub_u32 s29, s29, s23
    s_add_u32 m0, s31, 114688
    s_mov_b32 s23, s30
    buffer_load_dwordx4 v6, s[12:15], s23 offen  lds
    s_add_u32 m0, m0, 1024
    s_add_u32 s23, s23, 13824
    buffer_load_dwordx4 v6, s[12:15], s23 offen  lds
    s_add_u32 m0, m0, 1024
    s_add_u32 s23, s23, 13824
    buffer_load_dwordx4 v6, s[12:15], s23 offen  lds
    s_add_u32 m0, m0, 1024
    s_add_u32 s23, s23, 13824
    buffer_load_dwordx4 v6, s[12:15], s23 offen  lds
    s_add_u32 s36, s36, 1
    s_cmp_eq_u32 s36, 10
    s_cselect_b32 s23, 2211840, 0
    s_cselect_b32 s36, 0, s36
    s_add_u32 s30, s30, 221184
    s_sub_u32 s30, s30, s23
    s_waitcnt vmcnt(8) lgkmcnt(0)
    s_barrier
    s_add_u32 m0, s31, 0
    s_mov_b32 s23, s29
    buffer_load_dwordx4 v4, s[8:11], s23 offen  lds
    s_add_u32 m0, m0, 1024
    s_nop 0
    buffer_load_dwordx4 v5, s[8:11], s23 offen  lds
    s_add_u32 m0, m0, 1024
    s_add_u32 s23, s23, 32768
    buffer_load_dwordx4 v4, s[8:11], s23 offen  lds
    s_add_u32 m0, m0, 1024
    s_nop 0
    buffer_load_dwordx4 v5, s[8:11], s23 offen  lds
    s_add_u32 s35, s35, 1
    s_cmp_eq_u32 s35, 10
    s_cselect_b32 s23, 2621440, 0
    s_cselect_b32 s35, 0, s35
    s_add_u32 s29, s29, 262144
    s_sub_u32 s29, s29, s23
    s_add_u32 m0, s31, 16384
    s_mov_b32 s23, s30
    buffer_load_dwordx4 v6, s[12:15], s23 offen  lds
    s_add_u32 m0, m0, 1024
    s_add_u32 s23, s23, 13824
    buffer_load_dwordx4 v6, s[12:15], s23 offen  lds
    s_add_u32 m0, m0, 1024
    s_add_u32 s23, s23, 13824
    buffer_load_dwordx4 v6, s[12:15], s23 offen  lds
    s_add_u32 m0, m0, 1024
    s_add_u32 s23, s23, 13824
    buffer_load_dwordx4 v6, s[12:15], s23 offen  lds
    s_add_u32 s36, s36, 1
    s_cmp_eq_u32 s36, 10
    s_cselect_b32 s23, 2211840, 0
    s_cselect_b32 s36, 0, s36
    s_add_u32 s30, s30, 221184
    s_sub_u32 s30, s30, s23
    s_waitcnt vmcnt(8) lgkmcnt(0)
    s_barrier
    s_add_u32 m0, s31, 32768
    s_mov_b32 s23, s29
    buffer_load_dwordx4 v4, s[8:11], s23 offen  lds
    s_add_u32 m0, m0, 1024
    s_nop 0
    buffer_load_dwordx4 v5, s[8:11], s23 offen  lds
    s_add_u32 m0, m0, 1024
    s_add_u32 s23, s23, 32768
    buffer_load_dwordx4 v4, s[8:11], s23 offen  lds
    s_add_u32 m0, m0, 1024
    s_nop 0
    buffer_load_dwordx4 v5, s[8:11], s23 offen  lds
    s_add_u32 s35, s35, 1
    s_cmp_eq_u32 s35, 10
    s_cselect_b32 s23, 2621440, 0
    s_cselect_b32 s35, 0, s35
    s_add_u32 s29, s29, 262144
    s_sub_u32 s29, s29, s23
    s_add_u32 m0, s31, 49152
    s_mov_b32 s23, s30
    buffer_load_dwordx4 v6, s[12:15], s23 offen  lds
    s_add_u32 m0, m0, 1024
    s_add_u32 s23, s23, 13824
    buffer_load_dwordx4 v6, s[12:15], s23 offen  lds
    s_add_u32 m0, m0, 1024
    s_add_u32 s23, s23, 13824
    buffer_load_dwordx4 v6, s[12:15], s23 offen  lds
    s_add_u32 m0, m0, 1024
    s_add_u32 s23, s23, 13824
    buffer_load_dwordx4 v6, s[12:15], s23 offen  lds
    s_add_u32 s36, s36, 1
    s_cmp_eq_u32 s36, 10
    s_cselect_b32 s23, 2211840, 0
    s_cselect_b32 s36, 0, s36
    s_add_u32 s30, s30, 221184
    s_sub_u32 s30, s30, s23
    s_waitcnt vmcnt(8) lgkmcnt(0)
    s_barrier
    s_add_u32 m0, s31, 65536
    s_mov_b32 s23, s29
    buffer_load_dwordx4 v4, s[8:11], s23 offen  lds
    s_add_u32 m0, m0, 1024
    s_nop 0
    buffer_load_dwordx4 v5, s[8:11], s23 offen  lds
    s_add_u32 m0, m0, 1024
    s_add_u32 s23, s23, 32768
    buffer_load_dwordx4 v4, s[8:11], s23 offen  lds
    s_add_u32 m0, m0, 1024
    s_nop 0
    buffer_load_dwordx4 v5, s[8:11], s23 offen  lds
    s_add_u32 s35, s35, 1
    s_cmp_eq_u32 s35, 10
    s_cselect_b32 s23, 2621440, 0
    s_cselect_b32 s35, 0, s35
    s_add_u32 s29, s29, 262144
    s_sub_u32 s29, s29, s23
    s_add_u32 m0, s31, 81920
    s_mov_b32 s23, s30
    buffer_load_dwordx4 v6, s[12:15], s23 offen  lds
    s_add_u32 m0, m0, 1024
    s_add_u32 s23, s23, 13824
    buffer_load_dwordx4 v6, s[12:15], s23 offen  lds
    s_add_u32 m0, m0, 1024
    s_add_u32 s23, s23, 13824
    buffer_load_dwordx4 v6, s[12:15], s23 offen  lds
    s_add_u32 m0, m0, 1024
    s_add_u32 s23, s23, 13824
    buffer_load_dwordx4 v6, s[12:15], s23 offen  lds
    s_add_u32 s36, s36, 1
    s_cmp_eq_u32 s36, 10
    s_cselect_b32 s23, 2211840, 0
    s_cselect_b32 s36, 0, s36
    s_add_u32 s30, s30, 221184
    s_sub_u32 s30, s30, s23
    s_waitcnt vmcnt(8) lgkmcnt(0)
    s_barrier
    s_add_u32 m0, s31, 98304
    s_mov_b32 s23, s29
    buffer_load_dwordx4 v4, s[8:11], s23 offen  lds
    s_add_u32 m0, m0, 1024
    s_nop 0
    buffer_load_dwordx4 v5, s[8:11], s23 offen  lds
    s_add_u32 m0, m0, 1024
    s_add_u32 s23, s23, 32768
    buffer_load_dwordx4 v4, s[8:11], s23 offen  lds
    s_add_u32 m0, m0, 1024
    s_nop 0
    buffer_load_dwordx4 v5, s[8:11], s23 offen  lds
    s_add_u32 s35, s35, 1
    s_cmp_eq_u32 s35, 10
    s_cselect_b32 s23, 2621440, 0
    s_cselect_b32 s35, 0, s35
    s_add_u32 s29, s29, 262144
    s_sub_u32 s29, s29, s23
    s_add_u32 m0, s31, 114688
    s_mov_b32 s23, s30
    buffer_load_dwordx4 v6, s[12:15], s23 offen  lds
    s_add_u32 m0, m0, 1024
    s_add_u32 s23, s23, 13824
    buffer_load_dwordx4 v6, s[12:15], s23 offen  lds
    s_add_u32 m0, m0, 1024
    s_add_u32 s23, s23, 13824
    buffer_load_dwordx4 v6, s[12:15], s23 offen  lds
    s_add_u32 m0, m0, 1024
    s_add_u32 s23, s23, 13824
    buffer_load_dwordx4 v6, s[12:15], s23 offen  lds
    s_add_u32 s36, s36, 1
    s_cmp_eq_u32 s36, 10
    s_cselect_b32 s23, 2211840, 0
    s_cselect_b32 s36, 0, s36
    s_add_u32 s30, s30, 221184
    s_sub_u32 s30, s30, s23
    s_waitcnt vmcnt(8) lgkmcnt(0)
    s_barrier
    s_add_u32 m0, s31, 0
    s_mov_b32 s23, s29
    buffer_load_dwordx4 v4, s[8:11], s23 offen  lds
    s_add_u32 m0, m0, 1024
    s_nop 0
    buffer_load_dwordx4 v5, s[8:11], s23 offen  lds
    s_add_u32 m0, m0, 1024
    s_add_u32 s23, s23, 32768
    buffer_load_dwordx4 v4, s[8:11], s23 offen  lds
    s_add_u32 m0, m0, 1024
    s_nop 0
    buffer_load_dwordx4 v5, s[8:11], s23 offen  lds
    s_add_u32 s35, s35, 1
    s_cmp_eq_u32 s35, 10
    s_cselect_b32 s23, 2621440, 0
    s_cselect_b32 s35, 0, s35
    s_add_u32 s29, s29, 262144
    s_sub_u32 s29, s29, s23
    s_add_u32 m0, s31, 16384
    s_mov_b32 s23, s30
    buffer_load_dwordx4 v6, s[12:15], s23 offen  lds
    s_add_u32 m0, m0, 1024
    s_add_u32 s23, s23, 13824
    buffer_load_dwordx4 v6, s[12:15], s23 offen  lds
    s_add_u32 m0, m0, 1024
    s_add_u32 s23, s23, 13824
    buffer_load_dwordx4 v6, s[12:15], s23 offen  lds
    s_add_u32 m0, m0, 1024
    s_add_u32 s23, s23, 13824
    buffer_load_dwordx4 v6, s[12:15], s23 offen  lds
    s_add_u32 s36, s36, 1
    s_cmp_eq_u32 s36, 10
    s_cselect_b32 s23, 2211840, 0
    s_cselect_b32 s36, 0, s36
    s_add_u32 s30, s30, 221184
    s_sub_u32 s30, s30, s23
    s_waitcnt vmcnt(8) lgkmcnt(0)
    s_barrier
    s_add_u32 m0, s31, 32768
    s_mov_b32 s23, s29
    buffer_load_dwordx4 v4, s[8:11], s23 offen  lds
    s_add_u32 m0, m0, 1024
    s_nop 0
    buffer_load_dwordx4 v5, s[8:11], s23 offen  lds
    s_add_u32 m0, m0, 1024
    s_add_u32 s23, s23, 32768
    buffer_load_dwordx4 v4, s[8:11], s23 offen  lds
    s_add_u32 m0, m0, 1024
    s_nop 0
    buffer_load_dwordx4 v5, s[8:11], s23 offen  lds
    s_add_u32 s35, s35, 1
    s_cmp_eq_u32 s35, 10
    s_cselect_b32 s23, 2621440, 0
    s_cselect_b32 s35, 0, s35
    s_add_u32 s29, s29, 262144
    s_sub_u32 s29, s29, s23
    s_add_u32 m0, s31, 49152
    s_mov_b32 s23, s30
    buffer_load_dwordx4 v6, s[12:15], s23 offen  lds
    s_add_u32 m0, m0, 1024
    s_add_u32 s23, s23, 13824
    buffer_load_dwordx4 v6, s[12:15], s23 offen  lds
    s_add_u32 m0, m0, 1024
    s_add_u32 s23, s23, 13824
    buffer_load_dwordx4 v6, s[12:15], s23 offen  lds
    s_add_u32 m0, m0, 1024
    s_add_u32 s23, s23, 13824
    buffer_load_dwordx4 v6, s[12:15], s23 offen  lds
    s_add_u32 s36, s36, 1
    s_cmp_eq_u32 s36, 10
    s_cselect_b32 s23, 2211840, 0
    s_cselect_b32 s36, 0, s36
    s_add_u32 s30, s30, 221184
    s_sub_u32 s30, s30, s23
    v_and_b32 v20, 31, v1
    v_lshlrev_b32 v21, 2, v20
    v_lshlrev_b32 v20, 3, v20
    s_lshl_b32 s23, s20, 5
    s_add_u32 s24, s23, s21
    s_lshl_b32 s24, s24, 3
    s_add_u32 s24, s24, 20439040
    s_mov_b32 exec_hi, 0
    buffer_load_dwordx2 v[24:25], v20, s[80:83], s24 offen
    s_add_u32 s24, s24, 16384
    buffer_load_dwordx2 v[26:27], v20, s[80:83], s24 offen
    s_add_u32 s24, s24, 16384
    buffer_load_dwordx2 v[28:29], v20, s[80:83], s24 offen
    s_add_u32 s24, s24, 16384
    buffer_load_dwordx2 v[30:31], v20, s[80:83], s24 offen
    s_add_u32 s24, s24, 16384
    buffer_load_dwordx2 v[32:33], v20, s[80:83], s24 offen
    s_add_u32 s24, s24, 16384
    buffer_load_dwordx2 v[34:35], v20, s[80:83], s24 offen
    s_add_u32 s24, s24, 16384
    buffer_load_dwordx2 v[36:37], v20, s[80:83], s24 offen
    s_add_u32 s24, s24, 16384
    buffer_load_dwordx2 v[38:39], v20, s[80:83], s24 offen
    s_add_u32 s24, s24, 16384
    buffer_load_dwordx2 v[40:41], v20, s[80:83], s24 offen
    s_add_u32 s24, s24, 16384
    buffer_load_dwordx2 v[42:43], v20, s[80:83], s24 offen
    s_add_u32 s24, s24, 16384
    buffer_load_dwordx2 v[44:45], v20, s[80:83], s24 offen
    s_add_u32 s24, s24, 16384
    buffer_load_dwordx2 v[46:47], v20, s[80:83], s24 offen
    s_add_u32 s24, s24, 16384
    buffer_load_dwordx2 v[48:49], v20, s[80:83], s24 offen
    s_add_u32 s24, s24, 16384
    buffer_load_dwordx2 v[50:51], v20, s[80:83], s24 offen
    s_add_u32 s24, s24, 16384
    buffer_load_dwordx2 v[52:53], v20, s[80:83], s24 offen
    s_add_u32 s24, s24, 16384
    buffer_load_dwordx2 v[54:55], v20, s[80:83], s24 offen
    s_mov_b32 exec_hi, -1
    s_waitcnt vmcnt(24) lgkmcnt(0)
    s_barrier
    s_and_b32 s75, s73, 3
    s_mul_i32 s75, s75, 3
    s_lshr_b32 s76, s73, 2
    s_lshl_b32 s77, s76, 1
    s_add_u32 s75, s75, s77
    s_cmp_ge_u32 s75, 14
    s_cselect_b32 s77, 14, 0
    s_sub_u32 s75, s75, s77
    s_cmp_ge_u32 s75, 14
    s_cselect_b32 s77, 14, 0
    s_sub_u32 s75, s75, s77
    s_mul_i32 s76, s76, 286720
    s_add_u32 s76, s76, 21520384
    s_mul_i32 s77, s20, 5120
    s_add_u32 s76, s76, s77
    s_mul_i32 s77, s75, 20480
    s_add_u32 s77, s77, s76
    v_lshlrev_b32 v61, 7, v1
    s_mov_b32 exec_lo, -1
    s_mov_b32 exec_hi, 0xff
    buffer_load_dword v60, v61, s[80:83], s77 offen sc1
    s_add_u32 s75, s75, 1
    s_cmp_eq_u32 s75, 14
    s_cselect_b32 s75, 0, s75
    s_mul_i32 s77, s75, 20480
    s_add_u32 s77, s77, s76
    buffer_load_dword v60, v61, s[80:83], s77 offen sc1
    s_mov_b64 exec, -1
    s_cmp_eq_u32 s100, 7
    s_cbranch_scc0 L_wo_113
    v_lshlrev_b32 v61, 21, v1
    s_mov_b64 exec, 3
    s_mov_b32 s44, s96
    s_mov_b32 s45, s97
    s_and_b32 s45, s45, 0xffff
    s_mov_b32 s46, 0x280000
    s_mov_b32 s47, 0x20000
    buffer_load_dword v60, v61, s[44:47], 0 offen sc1
    s_mov_b64 exec, 0xfff
    buffer_load_dword v60, v61, s[80:83], 0 offen sc1
    s_mov_b64 exec, -1
L_wo_113:
    s_waitcnt vmcnt(16) lgkmcnt(0)
    s_barrier
    s_waitcnt vmcnt(0)
    v_add_f32 v24, v24, v26
    v_add_f32 v25, v25, v27
    v_add_f32 v24, v24, v28
    v_add_f32 v25, v25, v29
    v_add_f32 v24, v24, v30
    v_add_f32 v25, v25, v31
    v_add_f32 v24, v24, v32
    v_add_f32 v25, v25, v33
    v_add_f32 v24, v24, v34
    v_add_f32 v25, v25, v35
    v_add_f32 v24, v24, v36
    v_add_f32 v25, v25, v37
    v_add_f32 v24, v24, v38
    v_add_f32 v25, v25, v39
    v_add_f32 v24, v24, v40
    v_add_f32 v25, v25, v41
    v_add_f32 v24, v24, v42
    v_add_f32 v25, v25, v43
    v_add_f32 v24, v24, v44
    v_add_f32 v25, v25, v45
    v_add_f32 v24, v24, v46
    v_add_f32 v25, v25, v47
    v_add_f32 v24, v24, v48
    v_add_f32 v25, v25, v49
    v_add_f32 v24, v24, v50
    v_add_f32 v25, v25, v51
    v_add_f32 v24, v24, v52
    v_add_f32 v25, v25, v53
    v_add_f32 v24, v24, v54
    v_add_f32 v25, v25, v55
    v_mul_f32 v24, 0x3acccccd, v24
    v_mul_f32 v25, 0x3acccccd, v25
    v_fma_f32 v25, -v24, v24, v25
    v_max_f32 v25, 0, v25
    v_add_f32 v25, 0x3727c5ac, v25
    v_rsq_f32 v25, v25
    s_lshl_b32 s23, s20, 7
    s_add_u32 s23, s23, 145408
    v_add_u32 v21, s23, v21
    s_mov_b32 exec_hi, 0
    ds_write_b32 v21, v24
    ds_write_b32 v21, v25 offset:512
    s_mov_b32 exec_hi, -1
    s_waitcnt lgkmcnt(0)
    s_barrier
    s_and_b32 s23, s73, 3
    s_lshl_b32 s21, s72, 2
    s_add_u32 s21, s21, s23
    s_lshl_b32 s21, s21, 6
    s_lshr_b32 s26, s73, 2
    s_mul_i32 s22, s26, 80
    s_mul_i32 s33, s23, 3
    s_mul_i32 s24, s26, 2
    s_add_u32 s33, s33, s24
    s_cmp_ge_u32 s33, 14
    s_cselect_b32 s24, 14, 0
    s_sub_u32 s33, s33, s24
    s_cmp_ge_u32 s33, 14
    s_cselect_b32 s24, 14, 0
    s_sub_u32 s33, s33, s24
    s_add_u32 s8, s78, 0xc80000
    s_addc_u32 s9, s79, 0
    s_and_b32 s9, s9, 0xffff
    s_mov_b32 s10, 0x6c0000
    s_mov_b32 s11, 0x20000
    s_sub_u32 s20, s100, 4
    v_lshlrev_b32 v4, 4, v1
    s_lshl_b32 s23, s20, 17
    s_lshl_b32 s24, s21, 4
    s_add_u32 s29, s23, s24
    s_mul_i32 s23, s20, 5120
    s_mul_i32 s24, s26, 286720
    s_add_u32 s30, s23, s24
    s_add_u32 s30, s30, 21520384
    s_lshl_b32 s31, s20, 12
    s_add_u32 s32, s23, 16384
    s_mul_i32 s23, s33, 524288
    s_add_u32 s29, s29, s23
    s_mul_i32 s23, s33, 20480
    s_add_u32 s30, s30, s23
    s_mov_b32 s34, s33
    s_barrier
    s_add_u32 m0, s32, 0
    s_add_u32 s23, s30, 4096
    buffer_load_dwordx4 v4, s[80:83], s30 offen offset:0 lds
    buffer_load_dwordx4 v4, s[80:83], s30 offen offset:1024 lds
    buffer_load_dwordx4 v4, s[80:83], s30 offen offset:2048 lds
    buffer_load_dwordx4 v4, s[80:83], s30 offen offset:3072 lds
    s_add_u32 m0, m0, 4096
    s_add_u32 s34, s34, 1
    buffer_load_dwordx4 v4, s[80:83], s23 offen lds
    s_cmp_eq_u32 s34, 14
    s_cselect_b32 s23, 286720, 0
    s_cselect_b32 s34, 0, s34
    s_add_u32 s30, s30, 20480
    s_sub_u32 s30, s30, s23
    s_add_u32 m0, s32, 36864
    s_add_u32 s23, s30, 4096
    buffer_load_dwordx4 v4, s[80:83], s30 offen offset:0 lds
    buffer_load_dwordx4 v4, s[80:83], s30 offen offset:1024 lds
    buffer_load_dwordx4 v4, s[80:83], s30 offen offset:2048 lds
    buffer_load_dwordx4 v4, s[80:83], s30 offen offset:3072 lds
    s_add_u32 m0, m0, 4096
    s_add_u32 s34, s34, 1
    buffer_load_dwordx4 v4, s[80:83], s23 offen lds
    s_cmp_eq_u32 s34, 14
    s_cselect_b32 s23, 286720, 0
    s_cselect_b32 s34, 0, s34
    s_add_u32 s30, s30, 20480
    s_sub_u32 s30, s30, s23
    s_branch L_f2_loader
L_f2_loader0:
    s_and_b32 s23, s73, 3
    s_lshl_b32 s21, s72, 2
    s_add_u32 s21, s21, s23
    s_lshl_b32 s21, s21, 6
    s_lshr_b32 s26, s73, 2
    s_mul_i32 s22, s26, 80
    s_mul_i32 s33, s23, 3
    s_mul_i32 s24, s26, 2
    s_add_u32 s33, s33, s24
    s_cmp_ge_u32 s33, 14
    s_cselect_b32 s24, 14, 0
    s_sub_u32 s33, s33, s24
    s_cmp_ge_u32 s33, 14
    s_cselect_b32 s24, 14, 0
    s_sub_u32 s33, s33, s24
    s_add_u32 s8, s78, 0xc80000
    s_addc_u32 s9, s79, 0
    s_and_b32 s9, s9, 0xffff
    s_mov_b32 s10, 0x6c0000
    s_mov_b32 s11, 0x20000
    s_sub_u32 s20, s100, 4
    v_lshlrev_b32 v4, 4, v1
    s_lshl_b32 s23, s20, 17
    s_lshl_b32 s24, s21, 4
    s_add_u32 s29, s23, s24
    s_mul_i32 s23, s20, 5120
    s_mul_i32 s24, s26, 286720
    s_add_u32 s30, s23, s24
    s_add_u32 s30, s30, 21520384
    s_lshl_b32 s31, s20, 12
    s_add_u32 s32, s23, 16384
    s_mul_i32 s23, s33, 524288
    s_add_u32 s29, s29, s23
    s_mul_i32 s23, s33, 20480
    s_add_u32 s30, s30, s23
    s_mov_b32 s34, s33
    s_add_u32 m0, s32, 0
    s_add_u32 s23, s30, 4096
    buffer_load_dwordx4 v4, s[80:83], s30 offen offset:0 lds
    buffer_load_dwordx4 v4, s[80:83], s30 offen offset:1024 lds
    buffer_load_dwordx4 v4, s[80:83], s30 offen offset:2048 lds
    buffer_load_dwordx4 v4, s[80:83], s30 offen offset:3072 lds
    s_add_u32 m0, m0, 4096
    s_add_u32 s34, s34, 1
    buffer_load_dwordx4 v4, s[80:83], s23 offen lds
    s_cmp_eq_u32 s34, 14
    s_cselect_b32 s23, 286720, 0
    s_cselect_b32 s34, 0, s34
    s_add_u32 s30, s30, 20480
    s_sub_u32 s30, s30, s23
    s_add_u32 m0, s32, 36864
    s_add_u32 s23, s30, 4096
    buffer_load_dwordx4 v4, s[80:83], s30 offen offset:0 lds
    buffer_load_dwordx4 v4, s[80:83], s30 offen offset:1024 lds
    buffer_load_dwordx4 v4, s[80:83], s30 offen offset:2048 lds
    buffer_load_dwordx4 v4, s[80:83], s30 offen offset:3072 lds
    s_add_u32 m0, m0, 4096
    s_add_u32 s34, s34, 1
    buffer_load_dwordx4 v4, s[80:83], s23 offen lds
    s_cmp_eq_u32 s34, 14
    s_cselect_b32 s23, 286720, 0
    s_cselect_b32 s34, 0, s34
    s_add_u32 s30, s30, 20480
    s_sub_u32 s30, s30, s23
L_f2_loader:
    s_cmp_eq_u32 s100, 4
    s_cbranch_scc0 L_gw_114
    s_lshr_b32 s40, s21, 7
    s_add_u32 s40, s40, 48
    s_lshl_b32 s101, s40, 7
    s_add_u32 s101, s101, 23814144
    v_lshlrev_b32 v9, 2, v1
    v_add_u32 v9, s101, v9
    v_mov_b32 v10, 1
    s_mov_b64 exec, 0x3fff
    s_mov_b32 s101, 0
L_poll_115:
    buffer_load_dword v8, v9, s[80:83], 0 offen sc1
    s_waitcnt vmcnt(0)
    v_cmp_gt_u32 vcc, v10, v8
    s_nop 4
    s_cmp_eq_u64 vcc, 0
    s_cbranch_scc1 L_pollok_116
    s_add_u32 s101, s101, 1
    s_cmp_gt_u32 s101, 262144
    s_cbranch_scc1 L_pollok_116
    s_sleep 1
    s_branch L_poll_115
L_pollok_116:
    s_mov_b64 exec, -1
L_gw_114:
    s_barrier
    s_add_u32 m0, s31, 0
    s_mov_b32 s23, s29
    buffer_load_dwordx4 v4, s[8:11], s23 offen lds
    s_add_u32 m0, m0, 1024
    s_add_u32 s23, s23, 32768
    buffer_load_dwordx4 v4, s[8:11], s23 offen lds
    s_add_u32 m0, m0, 1024
    s_add_u32 s23, s23, 32768
    buffer_load_dwordx4 v4, s[8:11], s23 offen lds
    s_add_u32 m0, m0, 1024
    s_add_u32 s23, s23, 32768
    buffer_load_dwordx4 v4, s[8:11], s23 offen lds
    s_add_u32 s33, s33, 1
    s_cmp_eq_u32 s33, 14
    s_cselect_b32 s23, 7340032, 0
    s_cselect_b32 s33, 0, s33
    s_add_u32 s29, s29, 524288
    s_sub_u32 s29, s29, s23
    s_add_u32 m0, s31, 36864
    s_mov_b32 s23, s29
    buffer_load_dwordx4 v4, s[8:11], s23 offen lds
    s_add_u32 m0, m0, 1024
    s_add_u32 s23, s23, 32768
    buffer_load_dwordx4 v4, s[8:11], s23 offen lds
    s_add_u32 m0, m0, 1024
    s_add_u32 s23, s23, 32768
    buffer_load_dwordx4 v4, s[8:11], s23 offen lds
    s_add_u32 m0, m0, 1024
    s_add_u32 s23, s23, 32768
    buffer_load_dwordx4 v4, s[8:11], s23 offen lds
    s_add_u32 s33, s33, 1
    s_cmp_eq_u32 s33, 14
    s_cselect_b32 s23, 7340032, 0
    s_cselect_b32 s33, 0, s33
    s_add_u32 s29, s29, 524288
    s_sub_u32 s29, s29, s23
    s_waitcnt vmcnt(4)
    s_barrier
    s_add_u32 m0, s31, 73728
    s_mov_b32 s23, s29
    buffer_load_dwordx4 v4, s[8:11], s23 offen lds
    s_add_u32 m0, m0, 1024
    s_add_u32 s23, s23, 32768
    buffer_load_dwordx4 v4, s[8:11], s23 offen lds
    s_add_u32 m0, m0, 1024
    s_add_u32 s23, s23, 32768
    buffer_load_dwordx4 v4, s[8:11], s23 offen lds
    s_add_u32 m0, m0, 1024
    s_add_u32 s23, s23, 32768
    buffer_load_dwordx4 v4, s[8:11], s23 offen lds
    s_add_u32 s33, s33, 1
    s_cmp_eq_u32 s33, 14
    s_cselect_b32 s23, 7340032, 0
    s_cselect_b32 s33, 0, s33
    s_add_u32 s29, s29, 524288
    s_sub_u32 s29, s29, s23
    s_add_u32 m0, s32, 73728
    s_add_u32 s23, s30, 4096
    buffer_load_dwordx4 v4, s[80:83], s30 offen offset:0 lds
    buffer_load_dwordx4 v4, s[80:83], s30 offen offset:1024 lds
    buffer_load_dwordx4 v4, s[80:83], s30 offen offset:2048 lds
    buffer_load_dwordx4 v4, s[80:83], s30 offen offset:3072 lds
    s_add_u32 m0, m0, 4096
    s_add_u32 s34, s34, 1
    buffer_load_dwordx4 v4, s[80:83], s23 offen lds
    s_cmp_eq_u32 s34, 14
    s_cselect_b32 s23, 286720, 0
    s_cselect_b32 s34, 0, s34
    s_add_u32 s30, s30, 20480
    s_sub_u32 s30, s30, s23
    s_waitcnt vmcnt(9)
    s_barrier
    s_add_u32 m0, s31, 110592
    s_mov_b32 s23, s29
    buffer_load_dwordx4 v4, s[8:11], s23 offen lds
    s_add_u32 m0, m0, 1024
    s_add_u32 s23, s23, 32768
    buffer_load_dwordx4 v4, s[8:11], s23 offen lds
    s_add_u32 m0, m0, 1024
    s_add_u32 s23, s23, 32768
    buffer_load_dwordx4 v4, s[8:11], s23 offen lds
    s_add_u32 m0, m0, 1024
    s_add_u32 s23, s23, 32768
    buffer_load_dwordx4 v4, s[8:11], s23 offen lds
    s_add_u32 s33, s33, 1
    s_cmp_eq_u32 s33, 14
    s_cselect_b32 s23, 7340032, 0
    s_cselect_b32 s33, 0, s33
    s_add_u32 s29, s29, 524288
    s_sub_u32 s29, s29, s23
    s_add_u32 m0, s32, 110592
    s_add_u32 s23, s30, 4096
    buffer_load_dwordx4 v4, s[80:83], s30 offen offset:0 lds
    buffer_load_dwordx4 v4, s[80:83], s30 offen offset:1024 lds
    buffer_load_dwordx4 v4, s[80:83], s30 offen offset:2048 lds
    buffer_load_dwordx4 v4, s[80:83], s30 offen offset:3072 lds
    s_add_u32 m0, m0, 4096
    s_add_u32 s34, s34, 1
    buffer_load_dwordx4 v4, s[80:83], s23 offen lds
    s_cmp_eq_u32 s34, 14
    s_cselect_b32 s23, 286720, 0
    s_cselect_b32 s34, 0, s34
    s_add_u32 s30, s30, 20480
    s_sub_u32 s30, s30, s23
    s_waitcnt vmcnt(9)
    s_barrier
    s_add_u32 m0, s31, 0
    s_mov_b32 s23, s29
    buffer_load_dwordx4 v4, s[8:11], s23 offen lds
    s_add_u32 m0, m0, 1024
    s_add_u32 s23, s23, 32768
    buffer_load_dwordx4 v4, s[8:11], s23 offen lds
    s_add_u32 m0, m0, 1024
    s_add_u32 s23, s23, 32768
    buffer_load_dwordx4 v4, s[8:11], s23 offen lds
    s_add_u32 m0, m0, 1024
    s_add_u32 s23, s23, 32768
    buffer_load_dwordx4 v4, s[8:11], s23 offen lds
    s_add_u32 s33, s33, 1
    s_cmp_eq_u32 s33, 14
    s_cselect_b32 s23, 7340032, 0
    s_cselect_b32 s33, 0, s33
    s_add_u32 s29, s29, 524288
    s_sub_u32 s29, s29, s23
    s_add_u32 m0, s32, 0
    s_add_u32 s23, s30, 4096
    buffer_load_dwordx4 v4, s[80:83], s30 offen offset:0 lds
    buffer_load_dwordx4 v4, s[80:83], s30 offen offset:1024 lds
    buffer_load_dwordx4 v4, s[80:83], s30 offen offset:2048 lds
    buffer_load_dwordx4 v4, s[80:83], s30 offen offset:3072 lds
    s_add_u32 m0, m0, 4096
    s_add_u32 s34, s34, 1
    buffer_load_dwordx4 v4, s[80:83], s23 offen lds
    s_cmp_eq_u32 s34, 14
    s_cselect_b32 s23, 286720, 0
    s_cselect_b32 s34, 0, s34
    s_add_u32 s30, s30, 20480
    s_sub_u32 s30, s30, s23
    s_waitcnt vmcnt(9)
    s_barrier
    s_add_u32 m0, s31, 36864
    s_mov_b32 s23, s29
    buffer_load_dwordx4 v4, s[8:11], s23 offen lds
    s_add_u32 m0, m0, 1024
    s_add_u32 s23, s23, 32768
    buffer_load_dwordx4 v4, s[8:11], s23 offen lds
    s_add_u32 m0, m0, 1024
    s_add_u32 s23, s23, 32768
    buffer_load_dwordx4 v4, s[8:11], s23 offen lds
    s_add_u32 m0, m0, 1024
    s_add_u32 s23, s23, 32768
    buffer_load_dwordx4 v4, s[8:11], s23 offen lds
    s_add_u32 s33, s33, 1
    s_cmp_eq_u32 s33, 14
    s_cselect_b32 s23, 7340032, 0
    s_cselect_b32 s33, 0, s33
    s_add_u32 s29, s29, 524288
    s_sub_u32 s29, s29, s23
    s_add_u32 m0, s32, 36864
    s_add_u32 s23, s30, 4096
    buffer_load_dwordx4 v4, s[80:83], s30 offen offset:0 lds
    buffer_load_dwordx4 v4, s[80:83], s30 offen offset:1024 lds
    buffer_load_dwordx4 v4, s[80:83], s30 offen offset:2048 lds
    buffer_load_dwordx4 v4, s[80:83], s30 offen offset:3072 lds
    s_add_u32 m0, m0, 4096
    s_add_u32 s34, s34, 1
    buffer_load_dwordx4 v4, s[80:83], s23 offen lds
    s_cmp_eq_u32 s34, 14
    s_cselect_b32 s23, 286720, 0
    s_cselect_b32 s34, 0, s34
    s_add_u32 s30, s30, 20480
    s_sub_u32 s30, s30, s23
    s_waitcnt vmcnt(9)
    s_barrier
    s_add_u32 m0, s31, 73728
    s_mov_b32 s23, s29
    buffer_load_dwordx4 v4, s[8:11], s23 offen lds
    s_add_u32 m0, m0, 1024
    s_add_u32 s23, s23, 32768
    buffer_load_dwordx4 v4, s[8:11], s23 offen lds
    s_add_u32 m0, m0, 1024
    s_add_u32 s23, s23, 32768
    buffer_load_dwordx4 v4, s[8:11], s23 offen lds
    s_add_u32 m0, m0, 1024
    s_add_u32 s23, s23, 32768
    buffer_load_dwordx4 v4, s[8:11], s23 offen lds
    s_add_u32 s33, s33, 1
    s_cmp_eq_u32 s33, 14
    s_cselect_b32 s23, 7340032, 0
    s_cselect_b32 s33, 0, s33
    s_add_u32 s29, s29, 524288
    s_sub_u32 s29, s29, s23
    s_add_u32 m0, s32, 73728
    s_add_u32 s23, s30, 4096
    buffer_load_dwordx4 v4, s[80:83], s30 offen offset:0 lds
    buffer_load_dwordx4 v4, s[80:83], s30 offen offset:1024 lds
    buffer_load_dwordx4 v4, s[80:83], s30 offen offset:2048 lds
    buffer_load_dwordx4 v4, s[80:83], s30 offen offset:3072 lds
    s_add_u32 m0, m0, 4096
    s_add_u32 s34, s34, 1
    buffer_load_dwordx4 v4, s[80:83], s23 offen lds
    s_cmp_eq_u32 s34, 14
    s_cselect_b32 s23, 286720, 0
    s_cselect_b32 s34, 0, s34
    s_add_u32 s30, s30, 20480
    s_sub_u32 s30, s30, s23
    s_waitcnt vmcnt(9)
    s_barrier
    s_add_u32 m0, s31, 110592
    s_mov_b32 s23, s29
    buffer_load_dwordx4 v4, s[8:11], s23 offen lds
    s_add_u32 m0, m0, 1024
    s_add_u32 s23, s23, 32768
    buffer_load_dwordx4 v4, s[8:11], s23 offen lds
    s_add_u32 m0, m0, 1024
    s_add_u32 s23, s23, 32768
    buffer_load_dwordx4 v4, s[8:11], s23 offen lds
    s_add_u32 m0, m0, 1024
    s_add_u32 s23, s23, 32768
    buffer_load_dwordx4 v4, s[8:11], s23 offen lds
    s_add_u32 s33, s33, 1
    s_cmp_eq_u32 s33, 14
    s_cselect_b32 s23, 7340032, 0
    s_cselect_b32 s33, 0, s33
    s_add_u32 s29, s29, 524288
    s_sub_u32 s29, s29, s23
    s_add_u32 m0, s32, 110592
    s_add_u32 s23, s30, 4096
    buffer_load_dwordx4 v4, s[80:83], s30 offen offset:0 lds
    buffer_load_dwordx4 v4, s[80:83], s30 offen offset:1024 lds
    buffer_load_dwordx4 v4, s[80:83], s30 offen offset:2048 lds
    buffer_load_dwordx4 v4, s[80:83], s30 offen offset:3072 lds
    s_add_u32 m0, m0, 4096
    s_add_u32 s34, s34, 1
    buffer_load_dwordx4 v4, s[80:83], s23 offen lds
    s_cmp_eq_u32 s34, 14
    s_cselect_b32 s23, 286720, 0
    s_cselect_b32 s34, 0, s34
    s_add_u32 s30, s30, 20480
    s_sub_u32 s30, s30, s23
    s_waitcnt vmcnt(9)
    s_barrier
    s_add_u32 m0, s31, 0
    s_mov_b32 s23, s29
    buffer_load_dwordx4 v4, s[8:11], s23 offen lds
    s_add_u32 m0, m0, 1024
    s_add_u32 s23, s23, 32768
    buffer_load_dwordx4 v4, s[8:11], s23 offen lds
    s_add_u32 m0, m0, 1024
    s_add_u32 s23, s23, 32768
    buffer_load_dwordx4 v4, s[8:11], s23 offen lds
    s_add_u32 m0, m0, 1024
    s_add_u32 s23, s23, 32768
    buffer_load_dwordx4 v4, s[8:11], s23 offen lds
    s_add_u32 s33, s33, 1
    s_cmp_eq_u32 s33, 14
    s_cselect_b32 s23, 7340032, 0
    s_cselect_b32 s33, 0, s33
    s_add_u32 s29, s29, 524288
    s_sub_u32 s29, s29, s23
    s_add_u32 m0, s32, 0
    s_add_u32 s23, s30, 4096
    buffer_load_dwordx4 v4, s[80:83], s30 offen offset:0 lds
    buffer_load_dwordx4 v4, s[80:83], s30 offen offset:1024 lds
    buffer_load_dwordx4 v4, s[80:83], s30 offen offset:2048 lds
    buffer_load_dwordx4 v4, s[80:83], s30 offen offset:3072 lds
    s_add_u32 m0, m0, 4096
    s_add_u32 s34, s34, 1
    buffer_load_dwordx4 v4, s[80:83], s23 offen lds
    s_cmp_eq_u32 s34, 14
    s_cselect_b32 s23, 286720, 0
    s_cselect_b32 s34, 0, s34
    s_add_u32 s30, s30, 20480
    s_sub_u32 s30, s30, s23
    s_waitcnt vmcnt(9)
    s_barrier
    s_add_u32 m0, s31, 36864
    s_mov_b32 s23, s29
    buffer_load_dwordx4 v4, s[8:11], s23 offen lds
    s_add_u32 m0, m0, 1024
    s_add_u32 s23, s23, 32768
    buffer_load_dwordx4 v4, s[8:11], s23 offen lds
    s_add_u32 m0, m0, 1024
    s_add_u32 s23, s23, 32768
    buffer_load_dwordx4 v4, s[8:11], s23 offen lds
    s_add_u32 m0, m0, 1024
    s_add_u32 s23, s23, 32768
    buffer_load_dwordx4 v4, s[8:11], s23 offen lds
    s_add_u32 s33, s33, 1
    s_cmp_eq_u32 s33, 14
    s_cselect_b32 s23, 7340032, 0
    s_cselect_b32 s33, 0, s33
    s_add_u32 s29, s29, 524288
    s_sub_u32 s29, s29, s23
    s_add_u32 m0, s32, 36864
    s_add_u32 s23, s30, 4096
    buffer_load_dwordx4 v4, s[80:83], s30 offen offset:0 lds
    buffer_load_dwordx4 v4, s[80:83], s30 offen offset:1024 lds
    buffer_load_dwordx4 v4, s[80:83], s30 offen offset:2048 lds
    buffer_load_dwordx4 v4, s[80:83], s30 offen offset:3072 lds
    s_add_u32 m0, m0, 4096
    s_add_u32 s34, s34, 1
    buffer_load_dwordx4 v4, s[80:83], s23 offen lds
    s_cmp_eq_u32 s34, 14
    s_cselect_b32 s23, 286720, 0
    s_cselect_b32 s34, 0, s34
    s_add_u32 s30, s30, 20480
    s_sub_u32 s30, s30, s23
    s_waitcnt vmcnt(9)
    s_barrier
    s_add_u32 m0, s31, 73728
    s_mov_b32 s23, s29
    buffer_load_dwordx4 v4, s[8:11], s23 offen lds
    s_add_u32 m0, m0, 1024
    s_add_u32 s23, s23, 32768
    buffer_load_dwordx4 v4, s[8:11], s23 offen lds
    s_add_u32 m0, m0, 1024
    s_add_u32 s23, s23, 32768
    buffer_load_dwordx4 v4, s[8:11], s23 offen lds
    s_add_u32 m0, m0, 1024
    s_add_u32 s23, s23, 32768
    buffer_load_dwordx4 v4, s[8:11], s23 offen lds
    s_add_u32 s33, s33, 1
    s_cmp_eq_u32 s33, 14
    s_cselect_b32 s23, 7340032, 0
    s_cselect_b32 s33, 0, s33
    s_add_u32 s29, s29, 524288
    s_sub_u32 s29, s29, s23
    s_add_u32 m0, s32, 73728
    s_add_u32 s23, s30, 4096
    buffer_load_dwordx4 v4, s[80:83], s30 offen offset:0 lds
    buffer_load_dwordx4 v4, s[80:83], s30 offen offset:1024 lds
    buffer_load_dwordx4 v4, s[80:83], s30 offen offset:2048 lds
    buffer_load_dwordx4 v4, s[80:83], s30 offen offset:3072 lds
    s_add_u32 m0, m0, 4096
    s_add_u32 s34, s34, 1
    buffer_load_dwordx4 v4, s[80:83], s23 offen lds
    s_cmp_eq_u32 s34, 14
    s_cselect_b32 s23, 286720, 0
    s_cselect_b32 s34, 0, s34
    s_add_u32 s30, s30, 20480
    s_sub_u32 s30, s30, s23
    s_waitcnt vmcnt(9)
    s_barrier
    s_add_u32 m0, s31, 110592
    s_mov_b32 s23, s29
    buffer_load_dwordx4 v4, s[8:11], s23 offen lds
    s_add_u32 m0, m0, 1024
    s_add_u32 s23, s23, 32768
    buffer_load_dwordx4 v4, s[8:11], s23 offen lds
    s_add_u32 m0, m0, 1024
    s_add_u32 s23, s23, 32768
    buffer_load_dwordx4 v4, s[8:11], s23 offen lds
    s_add_u32 m0, m0, 1024
    s_add_u32 s23, s23, 32768
    buffer_load_dwordx4 v4, s[8:11], s23 offen lds
    s_add_u32 s33, s33, 1
    s_cmp_eq_u32 s33, 14
    s_cselect_b32 s23, 7340032, 0
    s_cselect_b32 s33, 0, s33
    s_add_u32 s29, s29, 524288
    s_sub_u32 s29, s29, s23
    s_add_u32 m0, s32, 110592
    s_add_u32 s23, s30, 4096
    buffer_load_dwordx4 v4, s[80:83], s30 offen offset:0 lds
    buffer_load_dwordx4 v4, s[80:83], s30 offen offset:1024 lds
    buffer_load_dwordx4 v4, s[80:83], s30 offen offset:2048 lds
    buffer_load_dwordx4 v4, s[80:83], s30 offen offset:3072 lds
    s_add_u32 m0, m0, 4096
    s_add_u32 s34, s34, 1
    buffer_load_dwordx4 v4, s[80:83], s23 offen lds
    s_cmp_eq_u32 s34, 14
    s_cselect_b32 s23, 286720, 0
    s_cselect_b32 s34, 0, s34
    s_add_u32 s30, s30, 20480
    s_sub_u32 s30, s30, s23
    s_waitcnt vmcnt(9)
    s_barrier
    s_add_u32 m0, s31, 0
    s_mov_b32 s23, s29
    buffer_load_dwordx4 v4, s[8:11], s23 offen lds
    s_add_u32 m0, m0, 1024
    s_add_u32 s23, s23, 32768
    buffer_load_dwordx4 v4, s[8:11], s23 offen lds
    s_add_u32 m0, m0, 1024
    s_add_u32 s23, s23, 32768
    buffer_load_dwordx4 v4, s[8:11], s23 offen lds
    s_add_u32 m0, m0, 1024
    s_add_u32 s23, s23, 32768
    buffer_load_dwordx4 v4, s[8:11], s23 offen lds
    s_add_u32 s33, s33, 1
    s_cmp_eq_u32 s33, 14
    s_cselect_b32 s23, 7340032, 0
    s_cselect_b32 s33, 0, s33
    s_add_u32 s29, s29, 524288
    s_sub_u32 s29, s29, s23
    s_add_u32 m0, s32, 0
    s_add_u32 s23, s30, 4096
    buffer_load_dwordx4 v4, s[80:83], s30 offen offset:0 lds
    buffer_load_dwordx4 v4, s[80:83], s30 offen offset:1024 lds
    buffer_load_dwordx4 v4, s[80:83], s30 offen offset:2048 lds
    buffer_load_dwordx4 v4, s[80:83], s30 offen offset:3072 lds
    s_add_u32 m0, m0, 4096
    s_add_u32 s34, s34, 1
    buffer_load_dwordx4 v4, s[80:83], s23 offen lds
    s_cmp_eq_u32 s34, 14
    s_cselect_b32 s23, 286720, 0
    s_cselect_b32 s34, 0, s34
    s_add_u32 s30, s30, 20480
    s_sub_u32 s30, s30, s23
    s_waitcnt vmcnt(9)
    s_barrier
    s_add_u32 m0, s31, 36864
    s_mov_b32 s23, s29
    buffer_load_dwordx4 v4, s[8:11], s23 offen lds
    s_add_u32 m0, m0, 1024
    s_add_u32 s23, s23, 32768
    buffer_load_dwordx4 v4, s[8:11], s23 offen lds
    s_add_u32 m0, m0, 1024
    s_add_u32 s23, s23, 32768
    buffer_load_dwordx4 v4, s[8:11], s23 offen lds
    s_add_u32 m0, m0, 1024
    s_add_u32 s23, s23, 32768
    buffer_load_dwordx4 v4, s[8:11], s23 offen lds
    s_add_u32 s33, s33, 1
    s_cmp_eq_u32 s33, 14
    s_cselect_b32 s23, 7340032, 0
    s_cselect_b32 s33, 0, s33
    s_add_u32 s29, s29, 524288
    s_sub_u32 s29, s29, s23
    s_add_u32 m0, s32, 36864
    s_add_u32 s23, s30, 4096
    buffer_load_dwordx4 v4, s[80:83], s30 offen offset:0 lds
    buffer_load_dwordx4 v4, s[80:83], s30 offen offset:1024 lds
    buffer_load_dwordx4 v4, s[80:83], s30 offen offset:2048 lds
    buffer_load_dwordx4 v4, s[80:83], s30 offen offset:3072 lds
    s_add_u32 m0, m0, 4096
    s_add_u32 s34, s34, 1
    buffer_load_dwordx4 v4, s[80:83], s23 offen lds
    s_cmp_eq_u32 s34, 14
    s_cselect_b32 s23, 286720, 0
    s_cselect_b32 s34, 0, s34
    s_add_u32 s30, s30, 20480
    s_sub_u32 s30, s30, s23
    s_waitcnt vmcnt(9)
    s_barrier
    s_waitcnt vmcnt(0)
    s_barrier
    s_endpgm
L_f1_compute:
    s_lshr_b32 s32, s100, 1
    s_and_b32 s33, s100, 1
    v_and_b32 v2, 31, v1
    v_lshrrev_b32 v3, 5, v1
    v_lshlrev_b32 v128, 11, v3
    v_lshlrev_b32 v129, 4, v2
    v_add_u32 v128, v128, v129
    s_lshl_b32 s23, s32, 10
    v_add_u32 v4, s23, v128
    v_add_u32 v5, 512, v4
    v_add_u32 v6, 65536, v4
    v_add_u32 v7, 65536, v5
    v_lshrrev_b32 v128, 2, v1
    v_and_b32 v128, 3, v128
    v_lshlrev_b32 v129, 3, v3
    v_add_u32 v129, v129, v128
    v_lshlrev_b32 v129, 8, v129
    v_lshlrev_b32 v128, 6, v128
    v_add_u32 v129, v129, v128
    v_lshrrev_b32 v128, 4, v1
    v_and_b32 v128, 1, v128
    v_lshlrev_b32 v128, 5, v128
    v_add_u32 v129, v129, v128
    v_lshrrev_b32 v128, 1, v1
    v_and_b32 v128, 1, v128
    v_lshlrev_b32 v128, 4, v128
    v_add_u32 v129, v129, v128
    v_and_b32 v128, 1, v1
    v_lshlrev_b32 v128, 3, v128
    v_add_u32 v129, v129, v128
    v_add_u32 v129, 16384, v129
    s_lshl_b32 s23, s33, 7
    s_lshl_b32 s24, s32, 6
    s_add_u32 s23, s23, s24
    v_xor_b32 v8, s23, v129
    v_xor_b32 v9, 64, v8
    v_add_u32 v10, 65536, v8
    v_add_u32 v11, 65536, v9
    s_lshl_b32 s24, s33, 6
    s_add_u32 s25, s22, s24
    s_lshr_b32 s25, s25, 3
    v_add_u32 v128, s25, v3
    v_lshlrev_b32 v128, 15, v128
    v_lshlrev_b32 v129, 4, v2
    v_add_u32 v128, v128, v129
    s_xor_b32 s26, s32, 0
    s_lshl_b32 s26, s26, 2
    s_add_u32 s26, s26, 0
    s_lshl_b32 s26, s26, 15
    v_add_u32 v24, s26, v128
    s_xor_b32 s26, s32, 0
    s_lshl_b32 s26, s26, 2
    s_add_u32 s26, s26, 2
    s_lshl_b32 s26, s26, 15
    v_add_u32 v25, s26, v128
    s_xor_b32 s26, s32, 1
    s_lshl_b32 s26, s26, 2
    s_add_u32 s26, s26, 0
    s_lshl_b32 s26, s26, 15
    v_add_u32 v26, s26, v128
    s_xor_b32 s26, s32, 1
    s_lshl_b32 s26, s26, 2
    s_add_u32 s26, s26, 2
    s_lshl_b32 s26, s26, 15
    v_add_u32 v27, s26, v128
    s_lshl_b32 s24, s32, 6
    s_add_u32 s23, s21, s24
    s_lshl_b32 s40, s23, 4
    s_add_u32 s41, s40, 512
    s_add_u32 s16, s78, 0xc80000
    s_addc_u32 s17, s79, 0
    s_and_b32 s17, s17, 0xffff
    s_mov_b32 s18, 0x6c0000
    s_mov_b32 s19, 0x20000
    s_barrier
    v_mov_b32 v144, 0
    v_mov_b32 v145, 0
    s_barrier
    ds_read_b128 a[4:7], v4 offset:0
    ds_read_b128 a[8:11], v5 offset:0
    ds_read_b64_tr_b16 v[32:33], v8 offset:0
    ds_read_b64_tr_b16 v[34:35], v8 offset:1024
    ds_read_b64_tr_b16 v[36:37], v9 offset:0
    ds_read_b64_tr_b16 v[38:39], v9 offset:1024
    ds_read_b128 a[12:15], v4 offset:4096
    ds_read_b128 a[16:19], v5 offset:4096
    ds_read_b64_tr_b16 v[40:41], v8 offset:4096
    ds_read_b64_tr_b16 v[42:43], v8 offset:5120
    ds_read_b64_tr_b16 v[44:45], v9 offset:4096
    ds_read_b64_tr_b16 v[46:47], v9 offset:5120
    s_waitcnt lgkmcnt(6)
    v_mfma_f32_32x32x16_bf16 v[64:79], v[32:35], a[4:7], 0
    ds_read_b128 a[20:23], v4 offset:8192
    ds_read_b128 a[24:27], v5 offset:8192
    v_lshlrev_b32 v128, 16, v32
    v_and_b32 v129, 0xffff0000, v32
    v_add_f32 v144, v144, v128
    v_mfma_f32_32x32x16_bf16 v[80:95], v[32:35], a[8:11], 0
    ds_read_b64_tr_b16 v[48:49], v8 offset:8192
    ds_read_b64_tr_b16 v[50:51], v8 offset:9216
    v_add_f32 v145, v145, v129
    v_lshlrev_b32 v130, 16, v33
    v_and_b32 v131, 0xffff0000, v33
    v_mfma_f32_32x32x16_bf16 v[96:111], v[36:39], a[4:7], 0
    ds_read_b64_tr_b16 v[52:53], v9 offset:8192
    ds_read_b64_tr_b16 v[54:55], v9 offset:9216
    v_add_f32 v144, v144, v130
    v_add_f32 v145, v145, v131
    v_lshlrev_b32 v128, 16, v34
    v_and_b32 v129, 0xffff0000, v34
    v_mfma_f32_32x32x16_bf16 v[112:127], v[36:39], a[8:11], 0
    v_add_f32 v144, v144, v128
    v_add_f32 v145, v145, v129
    v_lshlrev_b32 v130, 16, v35
    v_and_b32 v131, 0xffff0000, v35
    v_add_f32 v144, v144, v130
    v_add_f32 v145, v145, v131
    s_waitcnt lgkmcnt(6)
    v_mfma_f32_32x32x16_bf16 v[64:79], v[40:43], a[12:15], v[64:79]
    ds_read_b128 a[4:7], v4 offset:12288
    ds_read_b128 a[8:11], v5 offset:12288
    v_lshlrev_b32 v128, 16, v40
    v_and_b32 v129, 0xffff0000, v40
    v_add_f32 v144, v144, v128
    v_mfma_f32_32x32x16_bf16 v[80:95], v[40:43], a[16:19], v[80:95]
    ds_read_b64_tr_b16 v[32:33], v8 offset:12288
    ds_read_b64_tr_b16 v[34:35], v8 offset:13312
    v_add_f32 v145, v145, v129
    v_lshlrev_b32 v130, 16, v41
    v_and_b32 v131, 0xffff0000, v41
    v_mfma_f32_32x32x16_bf16 v[96:111], v[44:47], a[12:15], v[96:111]
    ds_read_b64_tr_b16 v[36:37], v9 offset:12288
    ds_read_b64_tr_b16 v[38:39], v9 offset:13312
    v_add_f32 v144, v144, v130
    v_add_f32 v145, v145, v131
    v_lshlrev_b32 v128, 16, v42
    v_and_b32 v129, 0xffff0000, v42
    v_mfma_f32_32x32x16_bf16 v[112:127], v[44:47], a[16:19], v[112:127]
    v_add_f32 v144, v144, v128
    v_add_f32 v145, v145, v129
    v_lshlrev_b32 v130, 16, v43
    v_and_b32 v131, 0xffff0000, v43
    v_add_f32 v144, v144, v130
    v_add_f32 v145, v145, v131
    s_waitcnt lgkmcnt(6)
    v_mfma_f32_32x32x16_bf16 v[64:79], v[48:51], a[20:23], v[64:79]
    s_barrier
    ds_read_b128 a[12:15], v4 offset:32768
    ds_read_b128 a[16:19], v5 offset:32768
    v_lshlrev_b32 v128, 16, v48
    v_and_b32 v129, 0xffff0000, v48
    v_add_f32 v144, v144, v128
    v_mfma_f32_32x32x16_bf16 v[80:95], v[48:51], a[24:27], v[80:95]
    ds_read_b64_tr_b16 v[40:41], v8 offset:32768
    ds_read_b64_tr_b16 v[42:43], v8 offset:33792
    v_add_f32 v145, v145, v129
    v_lshlrev_b32 v130, 16, v49
    v_and_b32 v131, 0xffff0000, v49
    v_mfma_f32_32x32x16_bf16 v[96:111], v[52:55], a[20:23], v[96:111]
    ds_read_b64_tr_b16 v[44:45], v9 offset:32768
    ds_read_b64_tr_b16 v[46:47], v9 offset:33792
    v_add_f32 v144, v144, v130
    v_add_f32 v145, v145, v131
    v_lshlrev_b32 v128, 16, v50
    v_and_b32 v129, 0xffff0000, v50
    v_mfma_f32_32x32x16_bf16 v[112:127], v[52:55], a[24:27], v[112:127]
    v_add_f32 v144, v144, v128
    v_add_f32 v145, v145, v129
    v_lshlrev_b32 v130, 16, v51
    v_and_b32 v131, 0xffff0000, v51
    v_add_f32 v144, v144, v130
    v_add_f32 v145, v145, v131
    s_waitcnt lgkmcnt(6)
    v_mfma_f32_32x32x16_bf16 v[64:79], v[32:35], a[4:7], v[64:79]
    ds_read_b128 a[20:23], v4 offset:36864
    ds_read_b128 a[24:27], v5 offset:36864
    v_lshlrev_b32 v128, 16, v32
    v_and_b32 v129, 0xffff0000, v32
    v_add_f32 v144, v144, v128
    v_mfma_f32_32x32x16_bf16 v[80:95], v[32:35], a[8:11], v[80:95]
    ds_read_b64_tr_b16 v[48:49], v8 offset:36864
    ds_read_b64_tr_b16 v[50:51], v8 offset:37888
    v_add_f32 v145, v145, v129
    v_lshlrev_b32 v130, 16, v33
    v_and_b32 v131, 0xffff0000, v33
    v_mfma_f32_32x32x16_bf16 v[96:111], v[36:39], a[4:7], v[96:111]
    ds_read_b64_tr_b16 v[52:53], v9 offset:36864
    ds_read_b64_tr_b16 v[54:55], v9 offset:37888
    v_add_f32 v144, v144, v130
    v_add_f32 v145, v145, v131
    v_lshlrev_b32 v128, 16, v34
    v_and_b32 v129, 0xffff0000, v34
    v_mfma_f32_32x32x16_bf16 v[112:127], v[36:39], a[8:11], v[112:127]
    v_add_f32 v144, v144, v128
    v_add_f32 v145, v145, v129
    v_lshlrev_b32 v130, 16, v35
    v_and_b32 v131, 0xffff0000, v35
    v_add_f32 v144, v144, v130
    v_add_f32 v145, v145, v131
    s_waitcnt lgkmcnt(6)
    v_mfma_f32_32x32x16_bf16 v[64:79], v[40:43], a[12:15], v[64:79]
    ds_read_b128 a[4:7], v4 offset:40960
    ds_read_b128 a[8:11], v5 offset:40960
    v_lshlrev_b32 v128, 16, v40
    v_and_b32 v129, 0xffff0000, v40
    v_add_f32 v144, v144, v128
    v_mfma_f32_32x32x16_bf16 v[80:95], v[40:43], a[16:19], v[80:95]
    ds_read_b64_tr_b16 v[32:33], v8 offset:40960
    ds_read_b64_tr_b16 v[34:35], v8 offset:41984
    v_add_f32 v145, v145, v129
    v_lshlrev_b32 v130, 16, v41
    v_and_b32 v131, 0xffff0000, v41
    v_mfma_f32_32x32x16_bf16 v[96:111], v[44:47], a[12:15], v[96:111]
    ds_read_b64_tr_b16 v[36:37], v9 offset:40960
    ds_read_b64_tr_b16 v[38:39], v9 offset:41984
    v_add_f32 v144, v144, v130
    v_add_f32 v145, v145, v131
    v_lshlrev_b32 v128, 16, v42
    v_and_b32 v129, 0xffff0000, v42
    v_mfma_f32_32x32x16_bf16 v[112:127], v[44:47], a[16:19], v[112:127]
    v_add_f32 v144, v144, v128
    v_add_f32 v145, v145, v129
    v_lshlrev_b32 v130, 16, v43
    v_and_b32 v131, 0xffff0000, v43
    v_add_f32 v144, v144, v130
    v_add_f32 v145, v145, v131
    s_waitcnt lgkmcnt(6)
    v_mfma_f32_32x32x16_bf16 v[64:79], v[48:51], a[20:23], v[64:79]
    ds_read_b128 a[12:15], v4 offset:45056
    ds_read_b128 a[16:19], v5 offset:45056
    v_lshlrev_b32 v128, 16, v48
    v_and_b32 v129, 0xffff0000, v48
    v_add_f32 v144, v144, v128
    v_mfma_f32_32x32x16_bf16 v[80:95], v[48:51], a[24:27], v[80:95]
    ds_read_b64_tr_b16 v[40:41], v8 offset:45056
    ds_read_b64_tr_b16 v[42:43], v8 offset:46080
    v_add_f32 v145, v145, v129
    v_lshlrev_b32 v130, 16, v49
    v_and_b32 v131, 0xffff0000, v49
    v_mfma_f32_32x32x16_bf16 v[96:111], v[52:55], a[20:23], v[96:111]
    ds_read_b64_tr_b16 v[44:45], v9 offset:45056
    ds_read_b64_tr_b16 v[46:47], v9 offset:46080
    v_add_f32 v144, v144, v130
    v_add_f32 v145, v145, v131
    v_lshlrev_b32 v128, 16, v50
    v_and_b32 v129, 0xffff0000, v50
    v_mfma_f32_32x32x16_bf16 v[112:127], v[52:55], a[24:27], v[112:127]
    v_add_f32 v144, v144, v128
    v_add_f32 v145, v145, v129
    v_lshlrev_b32 v130, 16, v51
    v_and_b32 v131, 0xffff0000, v51
    v_add_f32 v144, v144, v130
    v_add_f32 v145, v145, v131
    s_waitcnt lgkmcnt(6)
    v_mfma_f32_32x32x16_bf16 v[64:79], v[32:35], a[4:7], v[64:79]
    s_barrier
    ds_read_b128 a[20:23], v6 offset:0
    ds_read_b128 a[24:27], v7 offset:0
    v_lshlrev_b32 v128, 16, v32
    v_and_b32 v129, 0xffff0000, v32
    v_add_f32 v144, v144, v128
    v_mfma_f32_32x32x16_bf16 v[80:95], v[32:35], a[8:11], v[80:95]
    ds_read_b64_tr_b16 v[48:49], v10 offset:0
    ds_read_b64_tr_b16 v[50:51], v10 offset:1024
    v_add_f32 v145, v145, v129
    v_lshlrev_b32 v130, 16, v33
    v_and_b32 v131, 0xffff0000, v33
    v_mfma_f32_32x32x16_bf16 v[96:111], v[36:39], a[4:7], v[96:111]
    ds_read_b64_tr_b16 v[52:53], v11 offset:0
    ds_read_b64_tr_b16 v[54:55], v11 offset:1024
    v_add_f32 v144, v144, v130
    v_add_f32 v145, v145, v131
    v_lshlrev_b32 v128, 16, v34
    v_and_b32 v129, 0xffff0000, v34
    v_mfma_f32_32x32x16_bf16 v[112:127], v[36:39], a[8:11], v[112:127]
    v_add_f32 v144, v144, v128
    v_add_f32 v145, v145, v129
    v_lshlrev_b32 v130, 16, v35
    v_and_b32 v131, 0xffff0000, v35
    v_add_f32 v144, v144, v130
    v_add_f32 v145, v145, v131
    s_waitcnt lgkmcnt(6)
    v_mfma_f32_32x32x16_bf16 v[64:79], v[40:43], a[12:15], v[64:79]
    ds_read_b128 a[4:7], v6 offset:4096
    ds_read_b128 a[8:11], v7 offset:4096
    v_lshlrev_b32 v128, 16, v40
    v_and_b32 v129, 0xffff0000, v40
    v_add_f32 v144, v144, v128
    v_mfma_f32_32x32x16_bf16 v[80:95], v[40:43], a[16:19], v[80:95]
    ds_read_b64_tr_b16 v[32:33], v10 offset:4096
    ds_read_b64_tr_b16 v[34:35], v10 offset:5120
    v_add_f32 v145, v145, v129
    v_lshlrev_b32 v130, 16, v41
    v_and_b32 v131, 0xffff0000, v41
    v_mfma_f32_32x32x16_bf16 v[96:111], v[44:47], a[12:15], v[96:111]
    ds_read_b64_tr_b16 v[36:37], v11 offset:4096
    ds_read_b64_tr_b16 v[38:39], v11 offset:5120
    v_add_f32 v144, v144, v130
    v_add_f32 v145, v145, v131
    v_lshlrev_b32 v128, 16, v42
    v_and_b32 v129, 0xffff0000, v42
    v_mfma_f32_32x32x16_bf16 v[112:127], v[44:47], a[16:19], v[112:127]
    v_add_f32 v144, v144, v128
    v_add_f32 v145, v145, v129
    v_lshlrev_b32 v130, 16, v43
    v_and_b32 v131, 0xffff0000, v43
    v_add_f32 v144, v144, v130
    v_add_f32 v145, v145, v131
    s_waitcnt lgkmcnt(6)
    v_mfma_f32_32x32x16_bf16 v[64:79], v[48:51], a[20:23], v[64:79]
    ds_read_b128 a[12:15], v6 offset:8192
    ds_read_b128 a[16:19], v7 offset:8192
    v_lshlrev_b32 v128, 16, v48
    v_and_b32 v129, 0xffff0000, v48
    v_add_f32 v144, v144, v128
    v_mfma_f32_32x32x16_bf16 v[80:95], v[48:51], a[24:27], v[80:95]
    ds_read_b64_tr_b16 v[40:41], v10 offset:8192
    ds_read_b64_tr_b16 v[42:43], v10 offset:9216
    v_add_f32 v145, v145, v129
    v_lshlrev_b32 v130, 16, v49
    v_and_b32 v131, 0xffff0000, v49
    v_mfma_f32_32x32x16_bf16 v[96:111], v[52:55], a[20:23], v[96:111]
    ds_read_b64_tr_b16 v[44:45], v11 offset:8192
    ds_read_b64_tr_b16 v[46:47], v11 offset:9216
    v_add_f32 v144, v144, v130
    v_add_f32 v145, v145, v131
    v_lshlrev_b32 v128, 16, v50
    v_and_b32 v129, 0xffff0000, v50
    v_mfma_f32_32x32x16_bf16 v[112:127], v[52:55], a[24:27], v[112:127]
    v_add_f32 v144, v144, v128
    v_add_f32 v145, v145, v129
    v_lshlrev_b32 v130, 16, v51
    v_and_b32 v131, 0xffff0000, v51
    v_add_f32 v144, v144, v130
    v_add_f32 v145, v145, v131
    s_waitcnt lgkmcnt(6)
    v_mfma_f32_32x32x16_bf16 v[64:79], v[32:35], a[4:7], v[64:79]
    ds_read_b128 a[20:23], v6 offset:12288
    ds_read_b128 a[24:27], v7 offset:12288
    v_lshlrev_b32 v128, 16, v32
    v_and_b32 v129, 0xffff0000, v32
    v_add_f32 v144, v144, v128
    v_mfma_f32_32x32x16_bf16 v[80:95], v[32:35], a[8:11], v[80:95]
    ds_read_b64_tr_b16 v[48:49], v10 offset:12288
    ds_read_b64_tr_b16 v[50:51], v10 offset:13312
    v_add_f32 v145, v145, v129
    v_lshlrev_b32 v130, 16, v33
    v_and_b32 v131, 0xffff0000, v33
    v_mfma_f32_32x32x16_bf16 v[96:111], v[36:39], a[4:7], v[96:111]
    ds_read_b64_tr_b16 v[52:53], v11 offset:12288
    ds_read_b64_tr_b16 v[54:55], v11 offset:13312
    v_add_f32 v144, v144, v130
    v_add_f32 v145, v145, v131
    v_lshlrev_b32 v128, 16, v34
    v_and_b32 v129, 0xffff0000, v34
    v_mfma_f32_32x32x16_bf16 v[112:127], v[36:39], a[8:11], v[112:127]
    v_add_f32 v144, v144, v128
    v_add_f32 v145, v145, v129
    v_lshlrev_b32 v130, 16, v35
    v_and_b32 v131, 0xffff0000, v35
    v_add_f32 v144, v144, v130
    v_add_f32 v145, v145, v131
    s_waitcnt lgkmcnt(6)
    v_mfma_f32_32x32x16_bf16 v[64:79], v[40:43], a[12:15], v[64:79]
    s_barrier
    ds_read_b128 a[4:7], v6 offset:32768
    ds_read_b128 a[8:11], v7 offset:32768
    v_lshlrev_b32 v128, 16, v40
    v_and_b32 v129, 0xffff0000, v40
    v_add_f32 v144, v144, v128
    v_mfma_f32_32x32x16_bf16 v[80:95], v[40:43], a[16:19], v[80:95]
    ds_read_b64_tr_b16 v[32:33], v10 offset:32768
    ds_read_b64_tr_b16 v[34:35], v10 offset:33792
    v_add_f32 v145, v145, v129
    v_lshlrev_b32 v130, 16, v41
    v_and_b32 v131, 0xffff0000, v41
    v_mfma_f32_32x32x16_bf16 v[96:111], v[44:47], a[12:15], v[96:111]
    ds_read_b64_tr_b16 v[36:37], v11 offset:32768
    ds_read_b64_tr_b16 v[38:39], v11 offset:33792
    v_add_f32 v144, v144, v130
    v_add_f32 v145, v145, v131
    v_lshlrev_b32 v128, 16, v42
    v_and_b32 v129, 0xffff0000, v42
    v_mfma_f32_32x32x16_bf16 v[112:127], v[44:47], a[16:19], v[112:127]
    v_add_f32 v144, v144, v128
    v_add_f32 v145, v145, v129
    v_lshlrev_b32 v130, 16, v43
    v_and_b32 v131, 0xffff0000, v43
    v_add_f32 v144, v144, v130
    v_add_f32 v145, v145, v131
    s_waitcnt lgkmcnt(6)
    v_mfma_f32_32x32x16_bf16 v[64:79], v[48:51], a[20:23], v[64:79]
    ds_read_b128 a[12:15], v6 offset:36864
    ds_read_b128 a[16:19], v7 offset:36864
    v_lshlrev_b32 v128, 16, v48
    v_and_b32 v129, 0xffff0000, v48
    v_add_f32 v144, v144, v128
    v_mfma_f32_32x32x16_bf16 v[80:95], v[48:51], a[24:27], v[80:95]
    ds_read_b64_tr_b16 v[40:41], v10 offset:36864
    ds_read_b64_tr_b16 v[42:43], v10 offset:37888
    v_add_f32 v145, v145, v129
    v_lshlrev_b32 v130, 16, v49
    v_and_b32 v131, 0xffff0000, v49
    v_mfma_f32_32x32x16_bf16 v[96:111], v[52:55], a[20:23], v[96:111]
    ds_read_b64_tr_b16 v[44:45], v11 offset:36864
    ds_read_b64_tr_b16 v[46:47], v11 offset:37888
    v_add_f32 v144, v144, v130
    v_add_f32 v145, v145, v131
    v_lshlrev_b32 v128, 16, v50
    v_and_b32 v129, 0xffff0000, v50
    v_mfma_f32_32x32x16_bf16 v[112:127], v[52:55], a[24:27], v[112:127]
    v_add_f32 v144, v144, v128
    v_add_f32 v145, v145, v129
    v_lshlrev_b32 v130, 16, v51
    v_and_b32 v131, 0xffff0000, v51
    v_add_f32 v144, v144, v130
    v_add_f32 v145, v145, v131
    s_waitcnt lgkmcnt(6)
    v_mfma_f32_32x32x16_bf16 v[64:79], v[32:35], a[4:7], v[64:79]
    ds_read_b128 a[20:23], v6 offset:40960
    ds_read_b128 a[24:27], v7 offset:40960
    v_lshlrev_b32 v128, 16, v32
    v_and_b32 v129, 0xffff0000, v32
    v_add_f32 v144, v144, v128
    v_mfma_f32_32x32x16_bf16 v[80:95], v[32:35], a[8:11], v[80:95]
    ds_read_b64_tr_b16 v[48:49], v10 offset:40960
    ds_read_b64_tr_b16 v[50:51], v10 offset:41984
    v_add_f32 v145, v145, v129
    v_lshlrev_b32 v130, 16, v33
    v_and_b32 v131, 0xffff0000, v33
    v_mfma_f32_32x32x16_bf16 v[96:111], v[36:39], a[4:7], v[96:111]
    ds_read_b64_tr_b16 v[52:53], v11 offset:40960
    ds_read_b64_tr_b16 v[54:55], v11 offset:41984
    v_add_f32 v144, v144, v130
    v_add_f32 v145, v145, v131
    v_lshlrev_b32 v128, 16, v34
    v_and_b32 v129, 0xffff0000, v34
    v_mfma_f32_32x32x16_bf16 v[112:127], v[36:39], a[8:11], v[112:127]
    v_add_f32 v144, v144, v128
    v_add_f32 v145, v145, v129
    v_lshlrev_b32 v130, 16, v35
    v_and_b32 v131, 0xffff0000, v35
    v_add_f32 v144, v144, v130
    v_add_f32 v145, v145, v131
    s_waitcnt lgkmcnt(6)
    v_mfma_f32_32x32x16_bf16 v[64:79], v[40:43], a[12:15], v[64:79]
    ds_read_b128 a[4:7], v6 offset:45056
    ds_read_b128 a[8:11], v7 offset:45056
    v_lshlrev_b32 v128, 16, v40
    v_and_b32 v129, 0xffff0000, v40
    v_add_f32 v144, v144, v128
    v_mfma_f32_32x32x16_bf16 v[80:95], v[40:43], a[16:19], v[80:95]
    ds_read_b64_tr_b16 v[32:33], v10 offset:45056
    ds_read_b64_tr_b16 v[34:35], v10 offset:46080
    v_add_f32 v145, v145, v129
    v_lshlrev_b32 v130, 16, v41
    v_and_b32 v131, 0xffff0000, v41
    v_mfma_f32_32x32x16_bf16 v[96:111], v[44:47], a[12:15], v[96:111]
    ds_read_b64_tr_b16 v[36:37], v11 offset:45056
    ds_read_b64_tr_b16 v[38:39], v11 offset:46080
    v_add_f32 v144, v144, v130
    v_add_f32 v145, v145, v131
    v_lshlrev_b32 v128, 16, v42
    v_and_b32 v129, 0xffff0000, v42
    v_mfma_f32_32x32x16_bf16 v[112:127], v[44:47], a[16:19], v[112:127]
    v_add_f32 v144, v144, v128
    v_add_f32 v145, v145, v129
    v_lshlrev_b32 v130, 16, v43
    v_and_b32 v131, 0xffff0000, v43
    v_add_f32 v144, v144, v130
    v_add_f32 v145, v145, v131
    s_waitcnt lgkmcnt(6)
    v_mfma_f32_32x32x16_bf16 v[64:79], v[48:51], a[20:23], v[64:79]
    s_barrier
    ds_read_b128 a[12:15], v4 offset:0
    ds_read_b128 a[16:19], v5 offset:0
    v_lshlrev_b32 v128, 16, v48
    v_and_b32 v129, 0xffff0000, v48
    v_add_f32 v144, v144, v128
    v_mfma_f32_32x32x16_bf16 v[80:95], v[48:51], a[24:27], v[80:95]
    ds_read_b64_tr_b16 v[40:41], v8 offset:0
    ds_read_b64_tr_b16 v[42:43], v8 offset:1024
    v_add_f32 v145, v145, v129
    v_lshlrev_b32 v130, 16, v49
    v_and_b32 v131, 0xffff0000, v49
    v_mfma_f32_32x32x16_bf16 v[96:111], v[52:55], a[20:23], v[96:111]
    ds_read_b64_tr_b16 v[44:45], v9 offset:0
    ds_read_b64_tr_b16 v[46:47], v9 offset:1024
    v_add_f32 v144, v144, v130
    v_add_f32 v145, v145, v131
    v_lshlrev_b32 v128, 16, v50
    v_and_b32 v129, 0xffff0000, v50
    v_mfma_f32_32x32x16_bf16 v[112:127], v[52:55], a[24:27], v[112:127]
    v_add_f32 v144, v144, v128
    v_add_f32 v145, v145, v129
    v_lshlrev_b32 v130, 16, v51
    v_and_b32 v131, 0xffff0000, v51
    v_add_f32 v144, v144, v130
    v_add_f32 v145, v145, v131
    s_waitcnt lgkmcnt(6)
    v_mfma_f32_32x32x16_bf16 v[64:79], v[32:35], a[4:7], v[64:79]
    ds_read_b128 a[20:23], v4 offset:4096
    ds_read_b128 a[24:27], v5 offset:4096
    v_lshlrev_b32 v128, 16, v32
    v_and_b32 v129, 0xffff0000, v32
    v_add_f32 v144, v144, v128
    v_mfma_f32_32x32x16_bf16 v[80:95], v[32:35], a[8:11], v[80:95]
    ds_read_b64_tr_b16 v[48:49], v8 offset:4096
    ds_read_b64_tr_b16 v[50:51], v8 offset:5120
    v_add_f32 v145, v145, v129
    v_lshlrev_b32 v130, 16, v33
    v_and_b32 v131, 0xffff0000, v33
    v_mfma_f32_32x32x16_bf16 v[96:111], v[36:39], a[4:7], v[96:111]
    ds_read_b64_tr_b16 v[52:53], v9 offset:4096
    ds_read_b64_tr_b16 v[54:55], v9 offset:5120
    v_add_f32 v144, v144, v130
    v_add_f32 v145, v145, v131
    v_lshlrev_b32 v128, 16, v34
    v_and_b32 v129, 0xffff0000, v34
    v_mfma_f32_32x32x16_bf16 v[112:127], v[36:39], a[8:11], v[112:127]
    v_add_f32 v144, v144, v128
    v_add_f32 v145, v145, v129
    v_lshlrev_b32 v130, 16, v35
    v_and_b32 v131, 0xffff0000, v35
    v_add_f32 v144, v144, v130
    v_add_f32 v145, v145, v131
    s_waitcnt lgkmcnt(6)
    v_mfma_f32_32x32x16_bf16 v[64:79], v[40:43], a[12:15], v[64:79]
    ds_read_b128 a[4:7], v4 offset:8192
    ds_read_b128 a[8:11], v5 offset:8192
    v_lshlrev_b32 v128, 16, v40
    v_and_b32 v129, 0xffff0000, v40
    v_add_f32 v144, v144, v128
    v_mfma_f32_32x32x16_bf16 v[80:95], v[40:43], a[16:19], v[80:95]
    ds_read_b64_tr_b16 v[32:33], v8 offset:8192
    ds_read_b64_tr_b16 v[34:35], v8 offset:9216
    v_add_f32 v145, v145, v129
    v_lshlrev_b32 v130, 16, v41
    v_and_b32 v131, 0xffff0000, v41
    v_mfma_f32_32x32x16_bf16 v[96:111], v[44:47], a[12:15], v[96:111]
    ds_read_b64_tr_b16 v[36:37], v9 offset:8192
    ds_read_b64_tr_b16 v[38:39], v9 offset:9216
    v_add_f32 v144, v144, v130
    v_add_f32 v145, v145, v131
    v_lshlrev_b32 v128, 16, v42
    v_and_b32 v129, 0xffff0000, v42
    v_mfma_f32_32x32x16_bf16 v[112:127], v[44:47], a[16:19], v[112:127]
    v_add_f32 v144, v144, v128
    v_add_f32 v145, v145, v129
    v_lshlrev_b32 v130, 16, v43
    v_and_b32 v131, 0xffff0000, v43
    v_add_f32 v144, v144, v130
    v_add_f32 v145, v145, v131
    s_waitcnt lgkmcnt(6)
    v_mfma_f32_32x32x16_bf16 v[64:79], v[48:51], a[20:23], v[64:79]
    ds_read_b128 a[12:15], v4 offset:12288
    ds_read_b128 a[16:19], v5 offset:12288
    v_lshlrev_b32 v128, 16, v48
    v_and_b32 v129, 0xffff0000, v48
    v_add_f32 v144, v144, v128
    v_mfma_f32_32x32x16_bf16 v[80:95], v[48:51], a[24:27], v[80:95]
    ds_read_b64_tr_b16 v[40:41], v8 offset:12288
    ds_read_b64_tr_b16 v[42:43], v8 offset:13312
    v_add_f32 v145, v145, v129
    v_lshlrev_b32 v130, 16, v49
    v_and_b32 v131, 0xffff0000, v49
    v_mfma_f32_32x32x16_bf16 v[96:111], v[52:55], a[20:23], v[96:111]
    ds_read_b64_tr_b16 v[44:45], v9 offset:12288
    ds_read_b64_tr_b16 v[46:47], v9 offset:13312
    v_add_f32 v144, v144, v130
    v_add_f32 v145, v145, v131
    v_lshlrev_b32 v128, 16, v50
    v_and_b32 v129, 0xffff0000, v50
    v_mfma_f32_32x32x16_bf16 v[112:127], v[52:55], a[24:27], v[112:127]
    v_add_f32 v144, v144, v128
    v_add_f32 v145, v145, v129
    v_lshlrev_b32 v130, 16, v51
    v_and_b32 v131, 0xffff0000, v51
    v_add_f32 v144, v144, v130
    v_add_f32 v145, v145, v131
    s_waitcnt lgkmcnt(6)
    v_mfma_f32_32x32x16_bf16 v[64:79], v[32:35], a[4:7], v[64:79]
    s_barrier
    ds_read_b128 a[20:23], v4 offset:32768
    ds_read_b128 a[24:27], v5 offset:32768
    v_lshlrev_b32 v128, 16, v32
    v_and_b32 v129, 0xffff0000, v32
    v_add_f32 v144, v144, v128
    v_mfma_f32_32x32x16_bf16 v[80:95], v[32:35], a[8:11], v[80:95]
    ds_read_b64_tr_b16 v[48:49], v8 offset:32768
    ds_read_b64_tr_b16 v[50:51], v8 offset:33792
    v_add_f32 v145, v145, v129
    v_lshlrev_b32 v130, 16, v33
    v_and_b32 v131, 0xffff0000, v33
    v_mfma_f32_32x32x16_bf16 v[96:111], v[36:39], a[4:7], v[96:111]
    ds_read_b64_tr_b16 v[52:53], v9 offset:32768
    ds_read_b64_tr_b16 v[54:55], v9 offset:33792
    v_add_f32 v144, v144, v130
    v_add_f32 v145, v145, v131
    v_lshlrev_b32 v128, 16, v34
    v_and_b32 v129, 0xffff0000, v34
    v_mfma_f32_32x32x16_bf16 v[112:127], v[36:39], a[8:11], v[112:127]
    v_add_f32 v144, v144, v128
    v_add_f32 v145, v145, v129
    v_lshlrev_b32 v130, 16, v35
    v_and_b32 v131, 0xffff0000, v35
    v_add_f32 v144, v144, v130
    v_add_f32 v145, v145, v131
    s_waitcnt lgkmcnt(6)
    v_mfma_f32_32x32x16_bf16 v[64:79], v[40:43], a[12:15], v[64:79]
    ds_read_b128 a[4:7], v4 offset:36864
    ds_read_b128 a[8:11], v5 offset:36864
    v_lshlrev_b32 v128, 16, v40
    v_and_b32 v129, 0xffff0000, v40
    v_add_f32 v144, v144, v128
    v_mfma_f32_32x32x16_bf16 v[80:95], v[40:43], a[16:19], v[80:95]
    ds_read_b64_tr_b16 v[32:33], v8 offset:36864
    ds_read_b64_tr_b16 v[34:35], v8 offset:37888
    v_add_f32 v145, v145, v129
    v_lshlrev_b32 v130, 16, v41
    v_and_b32 v131, 0xffff0000, v41
    v_mfma_f32_32x32x16_bf16 v[96:111], v[44:47], a[12:15], v[96:111]
    ds_read_b64_tr_b16 v[36:37], v9 offset:36864
    ds_read_b64_tr_b16 v[38:39], v9 offset:37888
    v_add_f32 v144, v144, v130
    v_add_f32 v145, v145, v131
    v_lshlrev_b32 v128, 16, v42
    v_and_b32 v129, 0xffff0000, v42
    v_mfma_f32_32x32x16_bf16 v[112:127], v[44:47], a[16:19], v[112:127]
    v_add_f32 v144, v144, v128
    v_add_f32 v145, v145, v129
    v_lshlrev_b32 v130, 16, v43
    v_and_b32 v131, 0xffff0000, v43
    v_add_f32 v144, v144, v130
    v_add_f32 v145, v145, v131
    s_waitcnt lgkmcnt(6)
    v_mfma_f32_32x32x16_bf16 v[64:79], v[48:51], a[20:23], v[64:79]
    ds_read_b128 a[12:15], v4 offset:40960
    ds_read_b128 a[16:19], v5 offset:40960
    v_lshlrev_b32 v128, 16, v48
    v_and_b32 v129, 0xffff0000, v48
    v_add_f32 v144, v144, v128
    v_mfma_f32_32x32x16_bf16 v[80:95], v[48:51], a[24:27], v[80:95]
    ds_read_b64_tr_b16 v[40:41], v8 offset:40960
    ds_read_b64_tr_b16 v[42:43], v8 offset:41984
    v_add_f32 v145, v145, v129
    v_lshlrev_b32 v130, 16, v49
    v_and_b32 v131, 0xffff0000, v49
    v_mfma_f32_32x32x16_bf16 v[96:111], v[52:55], a[20:23], v[96:111]
    ds_read_b64_tr_b16 v[44:45], v9 offset:40960
    ds_read_b64_tr_b16 v[46:47], v9 offset:41984
    v_add_f32 v144, v144, v130
    v_add_f32 v145, v145, v131
    v_lshlrev_b32 v128, 16, v50
    v_and_b32 v129, 0xffff0000, v50
    v_mfma_f32_32x32x16_bf16 v[112:127], v[52:55], a[24:27], v[112:127]
    v_add_f32 v144, v144, v128
    v_add_f32 v145, v145, v129
    v_lshlrev_b32 v130, 16, v51
    v_and_b32 v131, 0xffff0000, v51
    v_add_f32 v144, v144, v130
    v_add_f32 v145, v145, v131
    s_waitcnt lgkmcnt(6)
    v_mfma_f32_32x32x16_bf16 v[64:79], v[32:35], a[4:7], v[64:79]
    ds_read_b128 a[20:23], v4 offset:45056
    ds_read_b128 a[24:27], v5 offset:45056
    v_lshlrev_b32 v128, 16, v32
    v_and_b32 v129, 0xffff0000, v32
    v_add_f32 v144, v144, v128
    v_mfma_f32_32x32x16_bf16 v[80:95], v[32:35], a[8:11], v[80:95]
    ds_read_b64_tr_b16 v[48:49], v8 offset:45056
    ds_read_b64_tr_b16 v[50:51], v8 offset:46080
    v_add_f32 v145, v145, v129
    v_lshlrev_b32 v130, 16, v33
    v_and_b32 v131, 0xffff0000, v33
    v_mfma_f32_32x32x16_bf16 v[96:111], v[36:39], a[4:7], v[96:111]
    ds_read_b64_tr_b16 v[52:53], v9 offset:45056
    ds_read_b64_tr_b16 v[54:55], v9 offset:46080
    v_add_f32 v144, v144, v130
    v_add_f32 v145, v145, v131
    v_lshlrev_b32 v128, 16, v34
    v_and_b32 v129, 0xffff0000, v34
    v_mfma_f32_32x32x16_bf16 v[112:127], v[36:39], a[8:11], v[112:127]
    v_add_f32 v144, v144, v128
    v_add_f32 v145, v145, v129
    v_lshlrev_b32 v130, 16, v35
    v_and_b32 v131, 0xffff0000, v35
    v_add_f32 v144, v144, v130
    v_add_f32 v145, v145, v131
    s_waitcnt lgkmcnt(6)
    v_mfma_f32_32x32x16_bf16 v[64:79], v[40:43], a[12:15], v[64:79]
    s_barrier
    ds_read_b128 a[4:7], v6 offset:0
    ds_read_b128 a[8:11], v7 offset:0
    v_lshlrev_b32 v128, 16, v40
    v_and_b32 v129, 0xffff0000, v40
    v_add_f32 v144, v144, v128
    v_mfma_f32_32x32x16_bf16 v[80:95], v[40:43], a[16:19], v[80:95]
    ds_read_b64_tr_b16 v[32:33], v10 offset:0
    ds_read_b64_tr_b16 v[34:35], v10 offset:1024
    v_add_f32 v145, v145, v129
    v_lshlrev_b32 v130, 16, v41
    v_and_b32 v131, 0xffff0000, v41
    v_mfma_f32_32x32x16_bf16 v[96:111], v[44:47], a[12:15], v[96:111]
    ds_read_b64_tr_b16 v[36:37], v11 offset:0
    ds_read_b64_tr_b16 v[38:39], v11 offset:1024
    v_add_f32 v144, v144, v130
    v_add_f32 v145, v145, v131
    v_lshlrev_b32 v128, 16, v42
    v_and_b32 v129, 0xffff0000, v42
    v_mfma_f32_32x32x16_bf16 v[112:127], v[44:47], a[16:19], v[112:127]
    v_add_f32 v144, v144, v128
    v_add_f32 v145, v145, v129
    v_lshlrev_b32 v130, 16, v43
    v_and_b32 v131, 0xffff0000, v43
    v_add_f32 v144, v144, v130
    v_add_f32 v145, v145, v131
    s_waitcnt lgkmcnt(6)
    v_mfma_f32_32x32x16_bf16 v[64:79], v[48:51], a[20:23], v[64:79]
    ds_read_b128 a[12:15], v6 offset:4096
    ds_read_b128 a[16:19], v7 offset:4096
    v_lshlrev_b32 v128, 16, v48
    v_and_b32 v129, 0xffff0000, v48
    v_add_f32 v144, v144, v128
    v_mfma_f32_32x32x16_bf16 v[80:95], v[48:51], a[24:27], v[80:95]
    ds_read_b64_tr_b16 v[40:41], v10 offset:4096
    ds_read_b64_tr_b16 v[42:43], v10 offset:5120
    v_add_f32 v145, v145, v129
    v_lshlrev_b32 v130, 16, v49
    v_and_b32 v131, 0xffff0000, v49
    v_mfma_f32_32x32x16_bf16 v[96:111], v[52:55], a[20:23], v[96:111]
    ds_read_b64_tr_b16 v[44:45], v11 offset:4096
    ds_read_b64_tr_b16 v[46:47], v11 offset:5120
    v_add_f32 v144, v144, v130
    v_add_f32 v145, v145, v131
    v_lshlrev_b32 v128, 16, v50
    v_and_b32 v129, 0xffff0000, v50
    v_mfma_f32_32x32x16_bf16 v[112:127], v[52:55], a[24:27], v[112:127]
    v_add_f32 v144, v144, v128
    v_add_f32 v145, v145, v129
    v_lshlrev_b32 v130, 16, v51
    v_and_b32 v131, 0xffff0000, v51
    v_add_f32 v144, v144, v130
    v_add_f32 v145, v145, v131
    s_waitcnt lgkmcnt(6)
    v_mfma_f32_32x32x16_bf16 v[64:79], v[32:35], a[4:7], v[64:79]
    ds_read_b128 a[20:23], v6 offset:8192
    ds_read_b128 a[24:27], v7 offset:8192
    v_lshlrev_b32 v128, 16, v32
    v_and_b32 v129, 0xffff0000, v32
    v_add_f32 v144, v144, v128
    v_mfma_f32_32x32x16_bf16 v[80:95], v[32:35], a[8:11], v[80:95]
    ds_read_b64_tr_b16 v[48:49], v10 offset:8192
    ds_read_b64_tr_b16 v[50:51], v10 offset:9216
    v_add_f32 v145, v145, v129
    v_lshlrev_b32 v130, 16, v33
    v_and_b32 v131, 0xffff0000, v33
    v_mfma_f32_32x32x16_bf16 v[96:111], v[36:39], a[4:7], v[96:111]
    ds_read_b64_tr_b16 v[52:53], v11 offset:8192
    ds_read_b64_tr_b16 v[54:55], v11 offset:9216
    v_add_f32 v144, v144, v130
    v_add_f32 v145, v145, v131
    v_lshlrev_b32 v128, 16, v34
    v_and_b32 v129, 0xffff0000, v34
    v_mfma_f32_32x32x16_bf16 v[112:127], v[36:39], a[8:11], v[112:127]
    v_add_f32 v144, v144, v128
    v_add_f32 v145, v145, v129
    v_lshlrev_b32 v130, 16, v35
    v_and_b32 v131, 0xffff0000, v35
    v_add_f32 v144, v144, v130
    v_add_f32 v145, v145, v131
    s_waitcnt lgkmcnt(6)
    v_mfma_f32_32x32x16_bf16 v[64:79], v[40:43], a[12:15], v[64:79]
    ds_read_b128 a[4:7], v6 offset:12288
    ds_read_b128 a[8:11], v7 offset:12288
    v_lshlrev_b32 v128, 16, v40
    v_and_b32 v129, 0xffff0000, v40
    v_add_f32 v144, v144, v128
    v_mfma_f32_32x32x16_bf16 v[80:95], v[40:43], a[16:19], v[80:95]
    ds_read_b64_tr_b16 v[32:33], v10 offset:12288
    ds_read_b64_tr_b16 v[34:35], v10 offset:13312
    v_add_f32 v145, v145, v129
    v_lshlrev_b32 v130, 16, v41
    v_and_b32 v131, 0xffff0000, v41
    v_mfma_f32_32x32x16_bf16 v[96:111], v[44:47], a[12:15], v[96:111]
    ds_read_b64_tr_b16 v[36:37], v11 offset:12288
    ds_read_b64_tr_b16 v[38:39], v11 offset:13312
    v_add_f32 v144, v144, v130
    v_add_f32 v145, v145, v131
    v_lshlrev_b32 v128, 16, v42
    v_and_b32 v129, 0xffff0000, v42
    v_mfma_f32_32x32x16_bf16 v[112:127], v[44:47], a[16:19], v[112:127]
    v_add_f32 v144, v144, v128
    v_add_f32 v145, v145, v129
    v_lshlrev_b32 v130, 16, v43
    v_and_b32 v131, 0xffff0000, v43
    v_add_f32 v144, v144, v130
    v_add_f32 v145, v145, v131
    s_waitcnt lgkmcnt(6)
    v_mfma_f32_32x32x16_bf16 v[64:79], v[48:51], a[20:23], v[64:79]
    s_barrier
    ds_read_b128 a[12:15], v6 offset:32768
    ds_read_b128 a[16:19], v7 offset:32768
    v_lshlrev_b32 v128, 16, v48
    v_and_b32 v129, 0xffff0000, v48
    v_add_f32 v144, v144, v128
    v_mfma_f32_32x32x16_bf16 v[80:95], v[48:51], a[24:27], v[80:95]
    ds_read_b64_tr_b16 v[40:41], v10 offset:32768
    ds_read_b64_tr_b16 v[42:43], v10 offset:33792
    v_add_f32 v145, v145, v129
    v_lshlrev_b32 v130, 16, v49
    v_and_b32 v131, 0xffff0000, v49
    v_mfma_f32_32x32x16_bf16 v[96:111], v[52:55], a[20:23], v[96:111]
    ds_read_b64_tr_b16 v[44:45], v11 offset:32768
    ds_read_b64_tr_b16 v[46:47], v11 offset:33792
    v_add_f32 v144, v144, v130
    v_add_f32 v145, v145, v131
    v_lshlrev_b32 v128, 16, v50
    v_and_b32 v129, 0xffff0000, v50
    v_mfma_f32_32x32x16_bf16 v[112:127], v[52:55], a[24:27], v[112:127]
    v_add_f32 v144, v144, v128
    v_add_f32 v145, v145, v129
    v_lshlrev_b32 v130, 16, v51
    v_and_b32 v131, 0xffff0000, v51
    v_add_f32 v144, v144, v130
    v_add_f32 v145, v145, v131
    s_waitcnt lgkmcnt(6)
    v_mfma_f32_32x32x16_bf16 v[64:79], v[32:35], a[4:7], v[64:79]
    ds_read_b128 a[20:23], v6 offset:36864
    ds_read_b128 a[24:27], v7 offset:36864
    v_lshlrev_b32 v128, 16, v32
    v_and_b32 v129, 0xffff0000, v32
    v_add_f32 v144, v144, v128
    v_mfma_f32_32x32x16_bf16 v[80:95], v[32:35], a[8:11], v[80:95]
    ds_read_b64_tr_b16 v[48:49], v10 offset:36864
    ds_read_b64_tr_b16 v[50:51], v10 offset:37888
    v_add_f32 v145, v145, v129
    v_lshlrev_b32 v130, 16, v33
    v_and_b32 v131, 0xffff0000, v33
    v_mfma_f32_32x32x16_bf16 v[96:111], v[36:39], a[4:7], v[96:111]
    ds_read_b64_tr_b16 v[52:53], v11 offset:36864
    ds_read_b64_tr_b16 v[54:55], v11 offset:37888
    v_add_f32 v144, v144, v130
    v_add_f32 v145, v145, v131
    v_lshlrev_b32 v128, 16, v34
    v_and_b32 v129, 0xffff0000, v34
    v_mfma_f32_32x32x16_bf16 v[112:127], v[36:39], a[8:11], v[112:127]
    v_add_f32 v144, v144, v128
    v_add_f32 v145, v145, v129
    v_lshlrev_b32 v130, 16, v35
    v_and_b32 v131, 0xffff0000, v35
    v_add_f32 v144, v144, v130
    v_add_f32 v145, v145, v131
    s_waitcnt lgkmcnt(6)
    v_mfma_f32_32x32x16_bf16 v[64:79], v[40:43], a[12:15], v[64:79]
    ds_read_b128 a[4:7], v6 offset:40960
    ds_read_b128 a[8:11], v7 offset:40960
    v_lshlrev_b32 v128, 16, v40
    v_and_b32 v129, 0xffff0000, v40
    v_add_f32 v144, v144, v128
    v_mfma_f32_32x32x16_bf16 v[80:95], v[40:43], a[16:19], v[80:95]
    ds_read_b64_tr_b16 v[32:33], v10 offset:40960
    ds_read_b64_tr_b16 v[34:35], v10 offset:41984
    v_add_f32 v145, v145, v129
    v_lshlrev_b32 v130, 16, v41
    v_and_b32 v131, 0xffff0000, v41
    v_mfma_f32_32x32x16_bf16 v[96:111], v[44:47], a[12:15], v[96:111]
    ds_read_b64_tr_b16 v[36:37], v11 offset:40960
    ds_read_b64_tr_b16 v[38:39], v11 offset:41984
    v_add_f32 v144, v144, v130
    v_add_f32 v145, v145, v131
    v_lshlrev_b32 v128, 16, v42
    v_and_b32 v129, 0xffff0000, v42
    v_mfma_f32_32x32x16_bf16 v[112:127], v[44:47], a[16:19], v[112:127]
    v_add_f32 v144, v144, v128
    v_add_f32 v145, v145, v129
    v_lshlrev_b32 v130, 16, v43
    v_and_b32 v131, 0xffff0000, v43
    v_add_f32 v144, v144, v130
    v_add_f32 v145, v145, v131
    s_waitcnt lgkmcnt(6)
    v_mfma_f32_32x32x16_bf16 v[64:79], v[48:51], a[20:23], v[64:79]
    ds_read_b128 a[12:15], v6 offset:45056
    ds_read_b128 a[16:19], v7 offset:45056
    v_lshlrev_b32 v128, 16, v48
    v_and_b32 v129, 0xffff0000, v48
    v_add_f32 v144, v144, v128
    v_mfma_f32_32x32x16_bf16 v[80:95], v[48:51], a[24:27], v[80:95]
    ds_read_b64_tr_b16 v[40:41], v10 offset:45056
    ds_read_b64_tr_b16 v[42:43], v10 offset:46080
    v_add_f32 v145, v145, v129
    v_lshlrev_b32 v130, 16, v49
    v_and_b32 v131, 0xffff0000, v49
    v_mfma_f32_32x32x16_bf16 v[96:111], v[52:55], a[20:23], v[96:111]
    ds_read_b64_tr_b16 v[44:45], v11 offset:45056
    ds_read_b64_tr_b16 v[46:47], v11 offset:46080
    v_add_f32 v144, v144, v130
    v_add_f32 v145, v145, v131
    v_lshlrev_b32 v128, 16, v50
    v_and_b32 v129, 0xffff0000, v50
    v_mfma_f32_32x32x16_bf16 v[112:127], v[52:55], a[24:27], v[112:127]
    v_add_f32 v144, v144, v128
    v_add_f32 v145, v145, v129
    v_lshlrev_b32 v130, 16, v51
    v_and_b32 v131, 0xffff0000, v51
    v_add_f32 v144, v144, v130
    v_add_f32 v145, v145, v131
    s_waitcnt lgkmcnt(6)
    v_mfma_f32_32x32x16_bf16 v[64:79], v[32:35], a[4:7], v[64:79]
    s_barrier
    ds_read_b128 a[20:23], v4 offset:0
    ds_read_b128 a[24:27], v5 offset:0
    v_lshlrev_b32 v128, 16, v32
    v_and_b32 v129, 0xffff0000, v32
    v_add_f32 v144, v144, v128
    v_mfma_f32_32x32x16_bf16 v[80:95], v[32:35], a[8:11], v[80:95]
    ds_read_b64_tr_b16 v[48:49], v8 offset:0
    ds_read_b64_tr_b16 v[50:51], v8 offset:1024
    v_add_f32 v145, v145, v129
    v_lshlrev_b32 v130, 16, v33
    v_and_b32 v131, 0xffff0000, v33
    v_mfma_f32_32x32x16_bf16 v[96:111], v[36:39], a[4:7], v[96:111]
    ds_read_b64_tr_b16 v[52:53], v9 offset:0
    ds_read_b64_tr_b16 v[54:55], v9 offset:1024
    v_add_f32 v144, v144, v130
    v_add_f32 v145, v145, v131
    v_lshlrev_b32 v128, 16, v34
    v_and_b32 v129, 0xffff0000, v34
    v_mfma_f32_32x32x16_bf16 v[112:127], v[36:39], a[8:11], v[112:127]
    v_add_f32 v144, v144, v128
    v_add_f32 v145, v145, v129
    v_lshlrev_b32 v130, 16, v35
    v_and_b32 v131, 0xffff0000, v35
    v_add_f32 v144, v144, v130
    v_add_f32 v145, v145, v131
    s_waitcnt lgkmcnt(6)
    v_mfma_f32_32x32x16_bf16 v[64:79], v[40:43], a[12:15], v[64:79]
    ds_read_b128 a[4:7], v4 offset:4096
    ds_read_b128 a[8:11], v5 offset:4096
    v_lshlrev_b32 v128, 16, v40
    v_and_b32 v129, 0xffff0000, v40
    v_add_f32 v144, v144, v128
    v_mfma_f32_32x32x16_bf16 v[80:95], v[40:43], a[16:19], v[80:95]
    ds_read_b64_tr_b16 v[32:33], v8 offset:4096
    ds_read_b64_tr_b16 v[34:35], v8 offset:5120
    v_add_f32 v145, v145, v129
    v_lshlrev_b32 v130, 16, v41
    v_and_b32 v131, 0xffff0000, v41
    v_mfma_f32_32x32x16_bf16 v[96:111], v[44:47], a[12:15], v[96:111]
    ds_read_b64_tr_b16 v[36:37], v9 offset:4096
    ds_read_b64_tr_b16 v[38:39], v9 offset:5120
    v_add_f32 v144, v144, v130
    v_add_f32 v145, v145, v131
    v_lshlrev_b32 v128, 16, v42
    v_and_b32 v129, 0xffff0000, v42
    v_mfma_f32_32x32x16_bf16 v[112:127], v[44:47], a[16:19], v[112:127]
    v_add_f32 v144, v144, v128
    v_add_f32 v145, v145, v129
    v_lshlrev_b32 v130, 16, v43
    v_and_b32 v131, 0xffff0000, v43
    v_add_f32 v144, v144, v130
    v_add_f32 v145, v145, v131
    s_waitcnt lgkmcnt(6)
    v_mfma_f32_32x32x16_bf16 v[64:79], v[48:51], a[20:23], v[64:79]
    ds_read_b128 a[12:15], v4 offset:8192
    ds_read_b128 a[16:19], v5 offset:8192
    v_lshlrev_b32 v128, 16, v48
    v_and_b32 v129, 0xffff0000, v48
    v_add_f32 v144, v144, v128
    v_mfma_f32_32x32x16_bf16 v[80:95], v[48:51], a[24:27], v[80:95]
    ds_read_b64_tr_b16 v[40:41], v8 offset:8192
    ds_read_b64_tr_b16 v[42:43], v8 offset:9216
    v_add_f32 v145, v145, v129
    v_lshlrev_b32 v130, 16, v49
    v_and_b32 v131, 0xffff0000, v49
    v_mfma_f32_32x32x16_bf16 v[96:111], v[52:55], a[20:23], v[96:111]
    ds_read_b64_tr_b16 v[44:45], v9 offset:8192
    ds_read_b64_tr_b16 v[46:47], v9 offset:9216
    v_add_f32 v144, v144, v130
    v_add_f32 v145, v145, v131
    v_lshlrev_b32 v128, 16, v50
    v_and_b32 v129, 0xffff0000, v50
    v_mfma_f32_32x32x16_bf16 v[112:127], v[52:55], a[24:27], v[112:127]
    v_add_f32 v144, v144, v128
    v_add_f32 v145, v145, v129
    v_lshlrev_b32 v130, 16, v51
    v_and_b32 v131, 0xffff0000, v51
    v_add_f32 v144, v144, v130
    v_add_f32 v145, v145, v131
    s_waitcnt lgkmcnt(6)
    v_mfma_f32_32x32x16_bf16 v[64:79], v[32:35], a[4:7], v[64:79]
    ds_read_b128 a[20:23], v4 offset:12288
    ds_read_b128 a[24:27], v5 offset:12288
    v_lshlrev_b32 v128, 16, v32
    v_and_b32 v129, 0xffff0000, v32
    v_add_f32 v144, v144, v128
    v_mfma_f32_32x32x16_bf16 v[80:95], v[32:35], a[8:11], v[80:95]
    ds_read_b64_tr_b16 v[48:49], v8 offset:12288
    ds_read_b64_tr_b16 v[50:51], v8 offset:13312
    v_add_f32 v145, v145, v129
    v_lshlrev_b32 v130, 16, v33
    v_and_b32 v131, 0xffff0000, v33
    v_mfma_f32_32x32x16_bf16 v[96:111], v[36:39], a[4:7], v[96:111]
    ds_read_b64_tr_b16 v[52:53], v9 offset:12288
    ds_read_b64_tr_b16 v[54:55], v9 offset:13312
    v_add_f32 v144, v144, v130
    v_add_f32 v145, v145, v131
    v_lshlrev_b32 v128, 16, v34
    v_and_b32 v129, 0xffff0000, v34
    v_mfma_f32_32x32x16_bf16 v[112:127], v[36:39], a[8:11], v[112:127]
    v_add_f32 v144, v144, v128
    v_add_f32 v145, v145, v129
    v_lshlrev_b32 v130, 16, v35
    v_and_b32 v131, 0xffff0000, v35
    v_add_f32 v144, v144, v130
    v_add_f32 v145, v145, v131
    s_waitcnt lgkmcnt(6)
    v_mfma_f32_32x32x16_bf16 v[64:79], v[40:43], a[12:15], v[64:79]
    s_barrier
    ds_read_b128 a[4:7], v4 offset:32768
    ds_read_b128 a[8:11], v5 offset:32768
    v_lshlrev_b32 v128, 16, v40
    v_and_b32 v129, 0xffff0000, v40
    v_add_f32 v144, v144, v128
    v_mfma_f32_32x32x16_bf16 v[80:95], v[40:43], a[16:19], v[80:95]
    ds_read_b64_tr_b16 v[32:33], v8 offset:32768
    ds_read_b64_tr_b16 v[34:35], v8 offset:33792
    v_add_f32 v145, v145, v129
    v_lshlrev_b32 v130, 16, v41
    v_and_b32 v131, 0xffff0000, v41
    v_mfma_f32_32x32x16_bf16 v[96:111], v[44:47], a[12:15], v[96:111]
    ds_read_b64_tr_b16 v[36:37], v9 offset:32768
    ds_read_b64_tr_b16 v[38:39], v9 offset:33792
    v_add_f32 v144, v144, v130
    v_add_f32 v145, v145, v131
    v_lshlrev_b32 v128, 16, v42
    v_and_b32 v129, 0xffff0000, v42
    v_mfma_f32_32x32x16_bf16 v[112:127], v[44:47], a[16:19], v[112:127]
    v_add_f32 v144, v144, v128
    v_add_f32 v145, v145, v129
    v_lshlrev_b32 v130, 16, v43
    v_and_b32 v131, 0xffff0000, v43
    v_add_f32 v144, v144, v130
    v_add_f32 v145, v145, v131
    s_waitcnt lgkmcnt(6)
    v_mfma_f32_32x32x16_bf16 v[64:79], v[48:51], a[20:23], v[64:79]
    ds_read_b128 a[12:15], v4 offset:36864
    ds_read_b128 a[16:19], v5 offset:36864
    v_lshlrev_b32 v128, 16, v48
    v_and_b32 v129, 0xffff0000, v48
    v_add_f32 v144, v144, v128
    v_mfma_f32_32x32x16_bf16 v[80:95], v[48:51], a[24:27], v[80:95]
    ds_read_b64_tr_b16 v[40:41], v8 offset:36864
    ds_read_b64_tr_b16 v[42:43], v8 offset:37888
    v_add_f32 v145, v145, v129
    v_lshlrev_b32 v130, 16, v49
    v_and_b32 v131, 0xffff0000, v49
    v_mfma_f32_32x32x16_bf16 v[96:111], v[52:55], a[20:23], v[96:111]
    ds_read_b64_tr_b16 v[44:45], v9 offset:36864
    ds_read_b64_tr_b16 v[46:47], v9 offset:37888
    v_add_f32 v144, v144, v130
    v_add_f32 v145, v145, v131
    v_lshlrev_b32 v128, 16, v50
    v_and_b32 v129, 0xffff0000, v50
    v_mfma_f32_32x32x16_bf16 v[112:127], v[52:55], a[24:27], v[112:127]
    v_add_f32 v144, v144, v128
    v_add_f32 v145, v145, v129
    v_lshlrev_b32 v130, 16, v51
    v_and_b32 v131, 0xffff0000, v51
    v_add_f32 v144, v144, v130
    v_add_f32 v145, v145, v131
    s_waitcnt lgkmcnt(6)
    v_mfma_f32_32x32x16_bf16 v[64:79], v[32:35], a[4:7], v[64:79]
    ds_read_b128 a[20:23], v4 offset:40960
    ds_read_b128 a[24:27], v5 offset:40960
    v_lshlrev_b32 v128, 16, v32
    v_and_b32 v129, 0xffff0000, v32
    v_add_f32 v144, v144, v128
    v_mfma_f32_32x32x16_bf16 v[80:95], v[32:35], a[8:11], v[80:95]
    ds_read_b64_tr_b16 v[48:49], v8 offset:40960
    ds_read_b64_tr_b16 v[50:51], v8 offset:41984
    v_add_f32 v145, v145, v129
    v_lshlrev_b32 v130, 16, v33
    v_and_b32 v131, 0xffff0000, v33
    v_mfma_f32_32x32x16_bf16 v[96:111], v[36:39], a[4:7], v[96:111]
    ds_read_b64_tr_b16 v[52:53], v9 offset:40960
    ds_read_b64_tr_b16 v[54:55], v9 offset:41984
    v_add_f32 v144, v144, v130
    v_add_f32 v145, v145, v131
    v_lshlrev_b32 v128, 16, v34
    v_and_b32 v129, 0xffff0000, v34
    v_mfma_f32_32x32x16_bf16 v[112:127], v[36:39], a[8:11], v[112:127]
    v_add_f32 v144, v144, v128
    v_add_f32 v145, v145, v129
    v_lshlrev_b32 v130, 16, v35
    v_and_b32 v131, 0xffff0000, v35
    v_add_f32 v144, v144, v130
    v_add_f32 v145, v145, v131
    s_waitcnt lgkmcnt(6)
    v_mfma_f32_32x32x16_bf16 v[64:79], v[40:43], a[12:15], v[64:79]
    ds_read_b128 a[4:7], v4 offset:45056
    ds_read_b128 a[8:11], v5 offset:45056
    v_lshlrev_b32 v128, 16, v40
    v_and_b32 v129, 0xffff0000, v40
    v_add_f32 v144, v144, v128
    v_mfma_f32_32x32x16_bf16 v[80:95], v[40:43], a[16:19], v[80:95]
    ds_read_b64_tr_b16 v[32:33], v8 offset:45056
    ds_read_b64_tr_b16 v[34:35], v8 offset:46080
    v_add_f32 v145, v145, v129
    v_lshlrev_b32 v130, 16, v41
    v_and_b32 v131, 0xffff0000, v41
    v_mfma_f32_32x32x16_bf16 v[96:111], v[44:47], a[12:15], v[96:111]
    ds_read_b64_tr_b16 v[36:37], v9 offset:45056
    ds_read_b64_tr_b16 v[38:39], v9 offset:46080
    v_add_f32 v144, v144, v130
    v_add_f32 v145, v145, v131
    v_lshlrev_b32 v128, 16, v42
    v_and_b32 v129, 0xffff0000, v42
    v_mfma_f32_32x32x16_bf16 v[112:127], v[44:47], a[16:19], v[112:127]
    v_add_f32 v144, v144, v128
    v_add_f32 v145, v145, v129
    v_lshlrev_b32 v130, 16, v43
    v_and_b32 v131, 0xffff0000, v43
    v_add_f32 v144, v144, v130
    v_add_f32 v145, v145, v131
    s_waitcnt lgkmcnt(6)
    v_mfma_f32_32x32x16_bf16 v[64:79], v[48:51], a[20:23], v[64:79]
    v_lshlrev_b32 v128, 16, v48
    v_and_b32 v129, 0xffff0000, v48
    v_add_f32 v144, v144, v128
    v_mfma_f32_32x32x16_bf16 v[80:95], v[48:51], a[24:27], v[80:95]
    v_add_f32 v145, v145, v129
    v_lshlrev_b32 v130, 16, v49
    v_and_b32 v131, 0xffff0000, v49
    v_mfma_f32_32x32x16_bf16 v[96:111], v[52:55], a[20:23], v[96:111]
    v_add_f32 v144, v144, v130
    v_add_f32 v145, v145, v131
    v_lshlrev_b32 v128, 16, v50
    v_and_b32 v129, 0xffff0000, v50
    v_mfma_f32_32x32x16_bf16 v[112:127], v[52:55], a[24:27], v[112:127]
    v_add_f32 v144, v144, v128
    v_add_f32 v145, v145, v129
    v_lshlrev_b32 v130, 16, v51
    v_and_b32 v131, 0xffff0000, v51
    v_add_f32 v144, v144, v130
    v_add_f32 v145, v145, v131
    s_waitcnt lgkmcnt(0)
    v_mfma_f32_32x32x16_bf16 v[64:79], v[32:35], a[4:7], v[64:79]
    v_lshlrev_b32 v128, 16, v32
    v_and_b32 v129, 0xffff0000, v32
    v_add_f32 v144, v144, v128
    v_mfma_f32_32x32x16_bf16 v[80:95], v[32:35], a[8:11], v[80:95]
    v_add_f32 v145, v145, v129
    v_lshlrev_b32 v130, 16, v33
    v_and_b32 v131, 0xffff0000, v33
    v_mfma_f32_32x32x16_bf16 v[96:111], v[36:39], a[4:7], v[96:111]
    v_add_f32 v144, v144, v130
    v_add_f32 v145, v145, v131
    v_lshlrev_b32 v128, 16, v34
    v_and_b32 v129, 0xffff0000, v34
    v_mfma_f32_32x32x16_bf16 v[112:127], v[36:39], a[8:11], v[112:127]
    v_add_f32 v144, v144, v128
    v_add_f32 v145, v145, v129
    v_lshlrev_b32 v130, 16, v35
    v_and_b32 v131, 0xffff0000, v35
    v_add_f32 v144, v144, v130
    v_add_f32 v145, v145, v131
    v_add_f32 v144, v144, v145
    s_nop 0
    v_mov_b32 v145, v144
    s_nop 1
    v_permlane32_swap_b32 v144, v145
    s_nop 1
    v_add_f32 v144, v144, v145
    s_lshl_b32 s23, s33, 8
    s_lshl_b32 s24, s32, 7
    s_add_u32 s23, s23, s24
    s_add_u32 s23, s23, 146432
    v_lshlrev_b32 v158, 2, v2
    v_add_u32 v159, s23, v158
    ds_write_b32 v159, v144
    s_waitcnt lgkmcnt(0)
    s_barrier
    s_lshl_b32 s24, s32, 8
    s_add_u32 s23, s24, 145408
    s_xor_b32 s24, s33, 0
    s_lshl_b32 s24, s24, 31
    s_add_u32 s23, s23, 0
    v_lshlrev_b32 v132, 2, v2
    v_add_u32 v132, s23, v132
    ds_read_b32 v128, v132
    ds_read_b32 v130, v132 offset:512
    s_lshl_b32 s24, s32, 8
    s_add_u32 s23, s24, 145536
    s_xor_b32 s24, s33, 1
    s_lshl_b32 s24, s24, 31
    s_add_u32 s23, s23, 0
    v_lshlrev_b32 v132, 2, v2
    v_add_u32 v132, s23, v132
    ds_read_b32 v129, v132
    ds_read_b32 v131, v132 offset:512
    s_lshl_b32 s24, s33, 8
    s_add_u32 s23, s24, 146432
    s_xor_b32 s24, s32, 0
    s_lshl_b32 s24, s24, 7
    s_add_u32 s23, s23, s24
    v_lshlrev_b32 v132, 4, v3
    v_add_u32 v132, s23, v132
    ds_read_b128 v[32:35], v132 offset:0
    ds_read_b128 v[36:39], v132 offset:32
    ds_read_b128 v[40:43], v132 offset:64
    ds_read_b128 v[44:47], v132 offset:96
    s_lshl_b32 s24, s33, 8
    s_add_u32 s23, s24, 146432
    s_xor_b32 s24, s32, 1
    s_lshl_b32 s24, s24, 7
    s_add_u32 s23, s23, s24
    v_lshlrev_b32 v132, 4, v3
    v_add_u32 v132, s23, v132
    ds_read_b128 v[48:51], v132 offset:0
    ds_read_b128 v[52:55], v132 offset:32
    ds_read_b128 v[56:59], v132 offset:64
    ds_read_b128 v[60:63], v132 offset:96
    s_waitcnt lgkmcnt(0)
    v_mov_b32 v146, v128
    v_mov_b32 v147, v128
    v_mov_b32 v150, v130
    v_mov_b32 v151, v130
    v_mov_b32 v148, v129
    v_mov_b32 v149, v129
    v_mov_b32 v152, v131
    v_mov_b32 v153, v131
    v_pk_fma_f32 v[64:65], v[146:147], v[32:33], v[64:65] neg_lo:[1,0,0] neg_hi:[1,0,0]
    v_pk_fma_f32 v[66:67], v[146:147], v[34:35], v[66:67] neg_lo:[1,0,0] neg_hi:[1,0,0]
    v_pk_fma_f32 v[68:69], v[146:147], v[36:37], v[68:69] neg_lo:[1,0,0] neg_hi:[1,0,0]
    v_pk_fma_f32 v[70:71], v[146:147], v[38:39], v[70:71] neg_lo:[1,0,0] neg_hi:[1,0,0]
    v_pk_fma_f32 v[72:73], v[146:147], v[40:41], v[72:73] neg_lo:[1,0,0] neg_hi:[1,0,0]
    v_pk_fma_f32 v[74:75], v[146:147], v[42:43], v[74:75] neg_lo:[1,0,0] neg_hi:[1,0,0]
    v_pk_fma_f32 v[76:77], v[146:147], v[44:45], v[76:77] neg_lo:[1,0,0] neg_hi:[1,0,0]
    v_pk_fma_f32 v[78:79], v[146:147], v[46:47], v[78:79] neg_lo:[1,0,0] neg_hi:[1,0,0]
    v_pk_mul_f32 v[64:65], v[64:65], v[150:151]
    v_pk_mul_f32 v[66:67], v[66:67], v[150:151]
    v_pk_mul_f32 v[68:69], v[68:69], v[150:151]
    v_pk_mul_f32 v[70:71], v[70:71], v[150:151]
    v_pk_mul_f32 v[72:73], v[72:73], v[150:151]
    v_pk_mul_f32 v[74:75], v[74:75], v[150:151]
    v_pk_mul_f32 v[76:77], v[76:77], v[150:151]
    v_pk_mul_f32 v[78:79], v[78:79], v[150:151]
    v_cvt_pk_bf16_f32 v136, v64, v65
    v_cvt_pk_bf16_f32 v137, v66, v67
    v_cvt_pk_bf16_f32 v138, v68, v69
    v_cvt_pk_bf16_f32 v139, v70, v71
    v_pk_max_i16 v136, v136, 0
    v_pk_max_i16 v137, v137, 0
    v_pk_max_i16 v138, v138, 0
    v_pk_max_i16 v139, v139, 0
    s_nop 0
    s_nop 0
    v_permlane32_swap_b32 v136, v138
    v_permlane32_swap_b32 v137, v139
    s_cmp_eq_u32 s74, 0
    s_cbranch_scc1 L_slow_117
    buffer_store_dwordx4 v[136:139], v24, s[16:19], s40 offen
    s_branch L_dd_118
L_slow_117:
    buffer_store_dwordx4 v[136:139], v24, s[16:19], s40 offen sc1
L_dd_118:
    v_cvt_pk_bf16_f32 v140, v72, v73
    v_cvt_pk_bf16_f32 v141, v74, v75
    v_cvt_pk_bf16_f32 v142, v76, v77
    v_cvt_pk_bf16_f32 v143, v78, v79
    v_pk_max_i16 v140, v140, 0
    v_pk_max_i16 v141, v141, 0
    v_pk_max_i16 v142, v142, 0
    v_pk_max_i16 v143, v143, 0
    s_nop 0
    s_nop 0
    v_permlane32_swap_b32 v140, v142
    v_permlane32_swap_b32 v141, v143
    s_cmp_eq_u32 s74, 0
    s_cbranch_scc1 L_slow_119
    buffer_store_dwordx4 v[140:143], v25, s[16:19], s40 offen
    s_branch L_dd_120
L_slow_119:
    buffer_store_dwordx4 v[140:143], v25, s[16:19], s40 offen sc1
L_dd_120:
    v_pk_fma_f32 v[80:81], v[148:149], v[32:33], v[80:81] neg_lo:[1,0,0] neg_hi:[1,0,0]
    v_pk_fma_f32 v[82:83], v[148:149], v[34:35], v[82:83] neg_lo:[1,0,0] neg_hi:[1,0,0]
    v_pk_fma_f32 v[84:85], v[148:149], v[36:37], v[84:85] neg_lo:[1,0,0] neg_hi:[1,0,0]
    v_pk_fma_f32 v[86:87], v[148:149], v[38:39], v[86:87] neg_lo:[1,0,0] neg_hi:[1,0,0]
    v_pk_fma_f32 v[88:89], v[148:149], v[40:41], v[88:89] neg_lo:[1,0,0] neg_hi:[1,0,0]
    v_pk_fma_f32 v[90:91], v[148:149], v[42:43], v[90:91] neg_lo:[1,0,0] neg_hi:[1,0,0]
    v_pk_fma_f32 v[92:93], v[148:149], v[44:45], v[92:93] neg_lo:[1,0,0] neg_hi:[1,0,0]
    v_pk_fma_f32 v[94:95], v[148:149], v[46:47], v[94:95] neg_lo:[1,0,0] neg_hi:[1,0,0]
    v_pk_mul_f32 v[80:81], v[80:81], v[152:153]
    v_pk_mul_f32 v[82:83], v[82:83], v[152:153]
    v_pk_mul_f32 v[84:85], v[84:85], v[152:153]
    v_pk_mul_f32 v[86:87], v[86:87], v[152:153]
    v_pk_mul_f32 v[88:89], v[88:89], v[152:153]
    v_pk_mul_f32 v[90:91], v[90:91], v[152:153]
    v_pk_mul_f32 v[92:93], v[92:93], v[152:153]
    v_pk_mul_f32 v[94:95], v[94:95], v[152:153]
    v_cvt_pk_bf16_f32 v136, v80, v81
    v_cvt_pk_bf16_f32 v137, v82, v83
    v_cvt_pk_bf16_f32 v138, v84, v85
    v_cvt_pk_bf16_f32 v139, v86, v87
    v_pk_max_i16 v136, v136, 0
    v_pk_max_i16 v137, v137, 0
    v_pk_max_i16 v138, v138, 0
    v_pk_max_i16 v139, v139, 0
    s_nop 0
    s_nop 0
    v_permlane32_swap_b32 v136, v138
    v_permlane32_swap_b32 v137, v139
    s_cmp_eq_u32 s74, 0
    s_cbranch_scc1 L_slow_121
    buffer_store_dwordx4 v[136:139], v24, s[16:19], s41 offen
    s_branch L_dd_122
L_slow_121:
    buffer_store_dwordx4 v[136:139], v24, s[16:19], s41 offen sc1
L_dd_122:
    v_cvt_pk_bf16_f32 v140, v88, v89
    v_cvt_pk_bf16_f32 v141, v90, v91
    v_cvt_pk_bf16_f32 v142, v92, v93
    v_cvt_pk_bf16_f32 v143, v94, v95
    v_pk_max_i16 v140, v140, 0
    v_pk_max_i16 v141, v141, 0
    v_pk_max_i16 v142, v142, 0
    v_pk_max_i16 v143, v143, 0
    s_nop 0
    s_nop 0
    v_permlane32_swap_b32 v140, v142
    v_permlane32_swap_b32 v141, v143
    s_cmp_eq_u32 s74, 0
    s_cbranch_scc1 L_slow_123
    buffer_store_dwordx4 v[140:143], v25, s[16:19], s41 offen
    s_branch L_dd_124
L_slow_123:
    buffer_store_dwordx4 v[140:143], v25, s[16:19], s41 offen sc1
L_dd_124:
    v_pk_fma_f32 v[96:97], v[146:147], v[48:49], v[96:97] neg_lo:[1,0,0] neg_hi:[1,0,0]
    v_pk_fma_f32 v[98:99], v[146:147], v[50:51], v[98:99] neg_lo:[1,0,0] neg_hi:[1,0,0]
    v_pk_fma_f32 v[100:101], v[146:147], v[52:53], v[100:101] neg_lo:[1,0,0] neg_hi:[1,0,0]
    v_pk_fma_f32 v[102:103], v[146:147], v[54:55], v[102:103] neg_lo:[1,0,0] neg_hi:[1,0,0]
    v_pk_fma_f32 v[104:105], v[146:147], v[56:57], v[104:105] neg_lo:[1,0,0] neg_hi:[1,0,0]
    v_pk_fma_f32 v[106:107], v[146:147], v[58:59], v[106:107] neg_lo:[1,0,0] neg_hi:[1,0,0]
    v_pk_fma_f32 v[108:109], v[146:147], v[60:61], v[108:109] neg_lo:[1,0,0] neg_hi:[1,0,0]
    v_pk_fma_f32 v[110:111], v[146:147], v[62:63], v[110:111] neg_lo:[1,0,0] neg_hi:[1,0,0]
    v_pk_mul_f32 v[96:97], v[96:97], v[150:151]
    v_pk_mul_f32 v[98:99], v[98:99], v[150:151]
    v_pk_mul_f32 v[100:101], v[100:101], v[150:151]
    v_pk_mul_f32 v[102:103], v[102:103], v[150:151]
    v_pk_mul_f32 v[104:105], v[104:105], v[150:151]
    v_pk_mul_f32 v[106:107], v[106:107], v[150:151]
    v_pk_mul_f32 v[108:109], v[108:109], v[150:151]
    v_pk_mul_f32 v[110:111], v[110:111], v[150:151]
    v_cvt_pk_bf16_f32 v136, v96, v97
    v_cvt_pk_bf16_f32 v137, v98, v99
    v_cvt_pk_bf16_f32 v138, v100, v101
    v_cvt_pk_bf16_f32 v139, v102, v103
    v_pk_max_i16 v136, v136, 0
    v_pk_max_i16 v137, v137, 0
    v_pk_max_i16 v138, v138, 0
    v_pk_max_i16 v139, v139, 0
    s_nop 0
    s_nop 0
    v_permlane32_swap_b32 v136, v138
    v_permlane32_swap_b32 v137, v139
    s_cmp_eq_u32 s74, 0
    s_cbranch_scc1 L_slow_125
    buffer_store_dwordx4 v[136:139], v26, s[16:19], s40 offen
    s_branch L_dd_126
L_slow_125:
    buffer_store_dwordx4 v[136:139], v26, s[16:19], s40 offen sc1
L_dd_126:
    v_cvt_pk_bf16_f32 v140, v104, v105
    v_cvt_pk_bf16_f32 v141, v106, v107
    v_cvt_pk_bf16_f32 v142, v108, v109
    v_cvt_pk_bf16_f32 v143, v110, v111
    v_pk_max_i16 v140, v140, 0
    v_pk_max_i16 v141, v141, 0
    v_pk_max_i16 v142, v142, 0
    v_pk_max_i16 v143, v143, 0
    s_nop 0
    s_nop 0
    v_permlane32_swap_b32 v140, v142
    v_permlane32_swap_b32 v141, v143
    s_cmp_eq_u32 s74, 0
    s_cbranch_scc1 L_slow_127
    buffer_store_dwordx4 v[140:143], v27, s[16:19], s40 offen
    s_branch L_dd_128
L_slow_127:
    buffer_store_dwordx4 v[140:143], v27, s[16:19], s40 offen sc1
L_dd_128:
    v_pk_fma_f32 v[112:113], v[148:149], v[48:49], v[112:113] neg_lo:[1,0,0] neg_hi:[1,0,0]
    v_pk_fma_f32 v[114:115], v[148:149], v[50:51], v[114:115] neg_lo:[1,0,0] neg_hi:[1,0,0]
    v_pk_fma_f32 v[116:117], v[148:149], v[52:53], v[116:117] neg_lo:[1,0,0] neg_hi:[1,0,0]
    v_pk_fma_f32 v[118:119], v[148:149], v[54:55], v[118:119] neg_lo:[1,0,0] neg_hi:[1,0,0]
    v_pk_fma_f32 v[120:121], v[148:149], v[56:57], v[120:121] neg_lo:[1,0,0] neg_hi:[1,0,0]
    v_pk_fma_f32 v[122:123], v[148:149], v[58:59], v[122:123] neg_lo:[1,0,0] neg_hi:[1,0,0]
    v_pk_fma_f32 v[124:125], v[148:149], v[60:61], v[124:125] neg_lo:[1,0,0] neg_hi:[1,0,0]
    v_pk_fma_f32 v[126:127], v[148:149], v[62:63], v[126:127] neg_lo:[1,0,0] neg_hi:[1,0,0]
    v_pk_mul_f32 v[112:113], v[112:113], v[152:153]
    v_pk_mul_f32 v[114:115], v[114:115], v[152:153]
    v_pk_mul_f32 v[116:117], v[116:117], v[152:153]
    v_pk_mul_f32 v[118:119], v[118:119], v[152:153]
    v_pk_mul_f32 v[120:121], v[120:121], v[152:153]
    v_pk_mul_f32 v[122:123], v[122:123], v[152:153]
    v_pk_mul_f32 v[124:125], v[124:125], v[152:153]
    v_pk_mul_f32 v[126:127], v[126:127], v[152:153]
    v_cvt_pk_bf16_f32 v136, v112, v113
    v_cvt_pk_bf16_f32 v137, v114, v115
    v_cvt_pk_bf16_f32 v138, v116, v117
    v_cvt_pk_bf16_f32 v139, v118, v119
    v_pk_max_i16 v136, v136, 0
    v_pk_max_i16 v137, v137, 0
    v_pk_max_i16 v138, v138, 0
    v_pk_max_i16 v139, v139, 0
    s_nop 0
    s_nop 0
    v_permlane32_swap_b32 v136, v138
    v_permlane32_swap_b32 v137, v139
    s_cmp_eq_u32 s74, 0
    s_cbranch_scc1 L_slow_129
    buffer_store_dwordx4 v[136:139], v26, s[16:19], s41 offen
    s_branch L_dd_130
L_slow_129:
    buffer_store_dwordx4 v[136:139], v26, s[16:19], s41 offen sc1
L_dd_130:
    v_cvt_pk_bf16_f32 v140, v120, v121
    v_cvt_pk_bf16_f32 v141, v122, v123
    v_cvt_pk_bf16_f32 v142, v124, v125
    v_cvt_pk_bf16_f32 v143, v126, v127
    v_pk_max_i16 v140, v140, 0
    v_pk_max_i16 v141, v141, 0
    v_pk_max_i16 v142, v142, 0
    v_pk_max_i16 v143, v143, 0
    s_nop 0
    s_nop 0
    v_permlane32_swap_b32 v140, v142
    v_permlane32_swap_b32 v141, v143
    s_cmp_eq_u32 s74, 0
    s_cbranch_scc1 L_slow_131
    buffer_store_dwordx4 v[140:143], v27, s[16:19], s41 offen
    s_branch L_dd_132
L_slow_131:
    buffer_store_dwordx4 v[140:143], v27, s[16:19], s41 offen sc1
L_dd_132:
    s_waitcnt vmcnt(0)
    s_barrier
    s_cmp_eq_u32 s100, 0
    s_cbranch_scc0 L_fa_133
    s_lshr_b32 s40, s21, 7
    s_add_u32 s40, s40, 48
    s_lshl_b32 s101, s40, 7
    s_add_u32 s101, s101, 23814144
    s_lshl_b32 s75, s34, 2
    s_add_u32 s101, s101, s75
    v_mov_b32 v4, s101
    v_mov_b32 v5, 1
    s_mov_b64 exec, 1
    s_cmp_eq_u32 s74, 0
    s_cbranch_scc1 L_slow_134
    buffer_store_dword v5, v4, s[80:83], 0 offen
    s_branch L_dd_135
L_slow_134:
    buffer_store_dword v5, v4, s[80:83], 0 offen sc1
L_dd_135:
    s_mov_b64 exec, -1
L_fa_133:
    v_mbcnt_lo_u32_b32 v1, -1, 0
    v_mbcnt_hi_u32_b32 v1, -1, v1
L_f2_compute0:
    s_and_b32 s23, s73, 3
    s_lshl_b32 s21, s72, 2
    s_add_u32 s21, s21, s23
    s_lshl_b32 s21, s21, 6
    s_lshr_b32 s26, s73, 2
    s_mul_i32 s22, s26, 80
    s_mul_i32 s33, s23, 3
    s_mul_i32 s24, s26, 2
    s_add_u32 s33, s33, s24
    s_cmp_ge_u32 s33, 14
    s_cselect_b32 s24, 14, 0
    s_sub_u32 s33, s33, s24
    s_cmp_ge_u32 s33, 14
    s_cselect_b32 s24, 14, 0
    s_sub_u32 s33, s33, s24
    v_and_b32 v2, 15, v1
    v_lshrrev_b32 v3, 4, v1
    s_lshr_b32 s24, s100, 1
    s_and_b32 s25, s100, 1
    s_lshl_b32 s23, s24, 5
    s_add_u32 s23, s23, s21
    v_add_u32 v84, s23, v2
    s_mul_i32 s29, s25, 48
    s_add_u32 s29, s29, s22
    v_mul_u32_u24 v85, 1280, v84
    v_lshlrev_b32 v87, 3, v3
    v_add_u32 v85, v85, v87
    s_lshl_b32 s23, s29, 1
    v_add_u32 v85, s23, v85
    v_lshrrev_b32 v87, 1, v3
    v_lshlrev_b32 v87, 15, v87
    v_lshlrev_b32 v86, 4, v84
    v_add_u32 v86, v86, v87
    v_and_b32 v87, 1, v3
    v_lshlrev_b32 v87, 3, v87
    v_add_u32 v86, v86, v87
    s_lshl_b32 s23, s29, 12
    v_add_u32 v86, s23, v86
    s_lshl_b32 s23, s24, 9
    v_lshlrev_b32 v4, 10, v3
    v_lshlrev_b32 v87, 4, v2
    v_add_u32 v4, v4, v87
    v_add_u32 v4, s23, v4
    v_lshrrev_b32 v87, 1, v3
    v_lshlrev_b32 v87, 4, v87
    v_and_b32 v88, 1, v3
    v_lshlrev_b32 v88, 2, v88
    v_add_u32 v87, v87, v88
    v_lshrrev_b32 v88, 2, v2
    v_add_u32 v87, v87, v88
    v_mul_u32_u24 v87, 160, v87
    v_and_b32 v88, 3, v1
    v_lshlrev_b32 v88, 3, v88
    v_add_u32 v87, v87, v88
    s_mul_i32 s23, s25, 96
    s_add_u32 s23, s23, 16384
    v_add_u32 v5, s23, v87
    s_mov_b32 s30, s25
    s_add_u32 s40, s78, 0xa00000
    s_addc_u32 s41, s79, 0
    s_and_b32 s41, s41, 0xffff
    s_mov_b32 s42, 0x280000
    s_mov_b32 s43, 0x20000
    s_mov_b32 s16, s96
    s_mov_b32 s17, s97
    s_and_b32 s17, s17, 0xffff
    s_mov_b32 s18, 0x280000
    s_mov_b32 s19, 0x20000
    s_cmp_eq_u32 s25, 1
    s_cselect_b32 s44, 0x7f000000, 0
    s_cselect_b64 s[46:47], -1, 0
    s_barrier
    s_mov_b32 s23, 0
    buffer_load_dwordx2 v[70:71], v86, s[40:43], s23 offen
    s_mov_b32 s23, 256
    buffer_load_dwordx2 v[72:73], v86, s[40:43], s23 offen
    s_mov_b32 s23, 65536
    buffer_load_dwordx2 v[74:75], v86, s[40:43], s23 offen
    s_mov_b32 s23, 65792
    buffer_load_dwordx2 v[76:77], v86, s[40:43], s23 offen
    s_add_u32 s23, s44, 131072
    buffer_load_dwordx2 v[78:79], v86, s[40:43], s23 offen
    s_add_u32 s23, s44, 131328
    buffer_load_dwordx2 v[80:81], v86, s[40:43], s23 offen
    s_barrier
    v_add_u32 v6, 0, v4
    v_add_u32 v7, 0, v5
    ds_read_b128 v[8:11], v6 offset:0
    ds_read_b128 v[12:15], v6 offset:256
    ds_read_b64_tr_b16 v[32:33], v7 offset:0
    ds_read_b64_tr_b16 v[34:35], v7 offset:1280
    ds_read_b64_tr_b16 v[36:37], v7 offset:32
    ds_read_b64_tr_b16 v[38:39], v7 offset:1312
    ds_read_b64_tr_b16 v[40:41], v7 offset:64
    ds_read_b64_tr_b16 v[42:43], v7 offset:1344
    ds_read_b128 v[16:19], v6 offset:4096
    ds_read_b128 v[20:23], v6 offset:4352
    ds_read_b64_tr_b16 v[44:45], v7 offset:5120
    ds_read_b64_tr_b16 v[46:47], v7 offset:6400
    ds_read_b64_tr_b16 v[48:49], v7 offset:5152
    ds_read_b64_tr_b16 v[50:51], v7 offset:6432
    ds_read_b64_tr_b16 v[52:53], v7 offset:5184
    ds_read_b64_tr_b16 v[54:55], v7 offset:6464
    s_waitcnt lgkmcnt(8)
    v_mfma_f32_16x16x32_bf16 v[96:99], v[32:35], v[8:11], 0
    ds_read_b128 v[24:27], v6 offset:8192
    ds_read_b128 v[28:31], v6 offset:8448
    v_mfma_f32_16x16x32_bf16 v[100:103], v[32:35], v[12:15], 0
    ds_read_b64_tr_b16 v[56:57], v7 offset:10240
    ds_read_b64_tr_b16 v[58:59], v7 offset:11520
    v_mfma_f32_16x16x32_bf16 v[104:107], v[36:39], v[8:11], 0
    ds_read_b64_tr_b16 v[60:61], v7 offset:10272
    v_mfma_f32_16x16x32_bf16 v[108:111], v[36:39], v[12:15], 0
    ds_read_b64_tr_b16 v[62:63], v7 offset:11552
    v_mfma_f32_16x16x32_bf16 v[112:115], v[40:43], v[8:11], 0
    ds_read_b64_tr_b16 v[64:65], v7 offset:10304
    v_mfma_f32_16x16x32_bf16 v[116:119], v[40:43], v[12:15], 0
    ds_read_b64_tr_b16 v[66:67], v7 offset:11584
    s_waitcnt lgkmcnt(8)
    v_mfma_f32_16x16x32_bf16 v[96:99], v[44:47], v[16:19], v[96:99]
    ds_read_b128 v[8:11], v6 offset:12288
    ds_read_b128 v[12:15], v6 offset:12544
    v_mfma_f32_16x16x32_bf16 v[100:103], v[44:47], v[20:23], v[100:103]
    ds_read_b64_tr_b16 v[32:33], v7 offset:15360
    ds_read_b64_tr_b16 v[34:35], v7 offset:16640
    v_mfma_f32_16x16x32_bf16 v[104:107], v[48:51], v[16:19], v[104:107]
    ds_read_b64_tr_b16 v[36:37], v7 offset:15392
    v_mfma_f32_16x16x32_bf16 v[108:111], v[48:51], v[20:23], v[108:111]
    ds_read_b64_tr_b16 v[38:39], v7 offset:16672
    v_mfma_f32_16x16x32_bf16 v[112:115], v[52:55], v[16:19], v[112:115]
    ds_read_b64_tr_b16 v[40:41], v7 offset:15424
    v_mfma_f32_16x16x32_bf16 v[116:119], v[52:55], v[20:23], v[116:119]
    ds_read_b64_tr_b16 v[42:43], v7 offset:16704
    s_waitcnt lgkmcnt(8)
    v_mfma_f32_16x16x32_bf16 v[96:99], v[56:59], v[24:27], v[96:99]
    s_barrier
    v_add_u32 v120, 36864, v4
    v_add_u32 v121, 36864, v5
    ds_read_b128 v[16:19], v120 offset:0
    ds_read_b128 v[20:23], v120 offset:256
    v_mfma_f32_16x16x32_bf16 v[100:103], v[56:59], v[28:31], v[100:103]
    ds_read_b64_tr_b16 v[44:45], v121 offset:0
    ds_read_b64_tr_b16 v[46:47], v121 offset:1280
    v_mfma_f32_16x16x32_bf16 v[104:107], v[60:63], v[24:27], v[104:107]
    ds_read_b64_tr_b16 v[48:49], v121 offset:32
    v_mfma_f32_16x16x32_bf16 v[108:111], v[60:63], v[28:31], v[108:111]
    ds_read_b64_tr_b16 v[50:51], v121 offset:1312
    v_mfma_f32_16x16x32_bf16 v[112:115], v[64:67], v[24:27], v[112:115]
    ds_read_b64_tr_b16 v[52:53], v121 offset:64
    v_mfma_f32_16x16x32_bf16 v[116:119], v[64:67], v[28:31], v[116:119]
    ds_read_b64_tr_b16 v[54:55], v121 offset:1344
    s_waitcnt lgkmcnt(8)
    v_mfma_f32_16x16x32_bf16 v[96:99], v[32:35], v[8:11], v[96:99]
    ds_read_b128 v[24:27], v120 offset:4096
    ds_read_b128 v[28:31], v120 offset:4352
    v_mfma_f32_16x16x32_bf16 v[100:103], v[32:35], v[12:15], v[100:103]
    ds_read_b64_tr_b16 v[56:57], v121 offset:5120
    ds_read_b64_tr_b16 v[58:59], v121 offset:6400
    v_mfma_f32_16x16x32_bf16 v[104:107], v[36:39], v[8:11], v[104:107]
    ds_read_b64_tr_b16 v[60:61], v121 offset:5152
    v_mfma_f32_16x16x32_bf16 v[108:111], v[36:39], v[12:15], v[108:111]
    ds_read_b64_tr_b16 v[62:63], v121 offset:6432
    v_mfma_f32_16x16x32_bf16 v[112:115], v[40:43], v[8:11], v[112:115]
    ds_read_b64_tr_b16 v[64:65], v121 offset:5184
    v_mfma_f32_16x16x32_bf16 v[116:119], v[40:43], v[12:15], v[116:119]
    ds_read_b64_tr_b16 v[66:67], v121 offset:6464
    s_waitcnt lgkmcnt(8)
    v_mfma_f32_16x16x32_bf16 v[96:99], v[44:47], v[16:19], v[96:99]
    ds_read_b128 v[8:11], v120 offset:8192
    ds_read_b128 v[12:15], v120 offset:8448
    v_mfma_f32_16x16x32_bf16 v[100:103], v[44:47], v[20:23], v[100:103]
    ds_read_b64_tr_b16 v[32:33], v121 offset:10240
    ds_read_b64_tr_b16 v[34:35], v121 offset:11520
    v_mfma_f32_16x16x32_bf16 v[104:107], v[48:51], v[16:19], v[104:107]
    ds_read_b64_tr_b16 v[36:37], v121 offset:10272
    v_mfma_f32_16x16x32_bf16 v[108:111], v[48:51], v[20:23], v[108:111]
    ds_read_b64_tr_b16 v[38:39], v121 offset:11552
    v_mfma_f32_16x16x32_bf16 v[112:115], v[52:55], v[16:19], v[112:115]
    ds_read_b64_tr_b16 v[40:41], v121 offset:10304
    v_mfma_f32_16x16x32_bf16 v[116:119], v[52:55], v[20:23], v[116:119]
    ds_read_b64_tr_b16 v[42:43], v121 offset:11584
    s_waitcnt lgkmcnt(8)
    v_mfma_f32_16x16x32_bf16 v[96:99], v[56:59], v[24:27], v[96:99]
    ds_read_b128 v[16:19], v120 offset:12288
    ds_read_b128 v[20:23], v120 offset:12544
    v_mfma_f32_16x16x32_bf16 v[100:103], v[56:59], v[28:31], v[100:103]
    ds_read_b64_tr_b16 v[44:45], v121 offset:15360
    ds_read_b64_tr_b16 v[46:47], v121 offset:16640
    v_mfma_f32_16x16x32_bf16 v[104:107], v[60:63], v[24:27], v[104:107]
    ds_read_b64_tr_b16 v[48:49], v121 offset:15392
    v_mfma_f32_16x16x32_bf16 v[108:111], v[60:63], v[28:31], v[108:111]
    ds_read_b64_tr_b16 v[50:51], v121 offset:16672
    v_mfma_f32_16x16x32_bf16 v[112:115], v[64:67], v[24:27], v[112:115]
    ds_read_b64_tr_b16 v[52:53], v121 offset:15424
    v_mfma_f32_16x16x32_bf16 v[116:119], v[64:67], v[28:31], v[116:119]
    ds_read_b64_tr_b16 v[54:55], v121 offset:16704
    s_waitcnt lgkmcnt(8)
    v_mfma_f32_16x16x32_bf16 v[96:99], v[32:35], v[8:11], v[96:99]
    s_barrier
    v_add_u32 v6, 73728, v4
    v_add_u32 v7, 73728, v5
    ds_read_b128 v[24:27], v6 offset:0
    ds_read_b128 v[28:31], v6 offset:256
    v_mfma_f32_16x16x32_bf16 v[100:103], v[32:35], v[12:15], v[100:103]
    ds_read_b64_tr_b16 v[56:57], v7 offset:0
    ds_read_b64_tr_b16 v[58:59], v7 offset:1280
    v_mfma_f32_16x16x32_bf16 v[104:107], v[36:39], v[8:11], v[104:107]
    ds_read_b64_tr_b16 v[60:61], v7 offset:32
    v_mfma_f32_16x16x32_bf16 v[108:111], v[36:39], v[12:15], v[108:111]
    ds_read_b64_tr_b16 v[62:63], v7 offset:1312
    v_mfma_f32_16x16x32_bf16 v[112:115], v[40:43], v[8:11], v[112:115]
    ds_read_b64_tr_b16 v[64:65], v7 offset:64
    v_mfma_f32_16x16x32_bf16 v[116:119], v[40:43], v[12:15], v[116:119]
    ds_read_b64_tr_b16 v[66:67], v7 offset:1344
    s_waitcnt lgkmcnt(8)
    v_mfma_f32_16x16x32_bf16 v[96:99], v[44:47], v[16:19], v[96:99]
    ds_read_b128 v[8:11], v6 offset:4096
    ds_read_b128 v[12:15], v6 offset:4352
    v_mfma_f32_16x16x32_bf16 v[100:103], v[44:47], v[20:23], v[100:103]
    ds_read_b64_tr_b16 v[32:33], v7 offset:5120
    ds_read_b64_tr_b16 v[34:35], v7 offset:6400
    v_mfma_f32_16x16x32_bf16 v[104:107], v[48:51], v[16:19], v[104:107]
    ds_read_b64_tr_b16 v[36:37], v7 offset:5152
    v_mfma_f32_16x16x32_bf16 v[108:111], v[48:51], v[20:23], v[108:111]
    ds_read_b64_tr_b16 v[38:39], v7 offset:6432
    v_mfma_f32_16x16x32_bf16 v[112:115], v[52:55], v[16:19], v[112:115]
    ds_read_b64_tr_b16 v[40:41], v7 offset:5184
    v_mfma_f32_16x16x32_bf16 v[116:119], v[52:55], v[20:23], v[116:119]
    ds_read_b64_tr_b16 v[42:43], v7 offset:6464
    s_waitcnt lgkmcnt(8)
    v_mfma_f32_16x16x32_bf16 v[96:99], v[56:59], v[24:27], v[96:99]
    ds_read_b128 v[16:19], v6 offset:8192
    ds_read_b128 v[20:23], v6 offset:8448
    v_mfma_f32_16x16x32_bf16 v[100:103], v[56:59], v[28:31], v[100:103]
    ds_read_b64_tr_b16 v[44:45], v7 offset:10240
    ds_read_b64_tr_b16 v[46:47], v7 offset:11520
    v_mfma_f32_16x16x32_bf16 v[104:107], v[60:63], v[24:27], v[104:107]
    ds_read_b64_tr_b16 v[48:49], v7 offset:10272
    v_mfma_f32_16x16x32_bf16 v[108:111], v[60:63], v[28:31], v[108:111]
    ds_read_b64_tr_b16 v[50:51], v7 offset:11552
    v_mfma_f32_16x16x32_bf16 v[112:115], v[64:67], v[24:27], v[112:115]
    ds_read_b64_tr_b16 v[52:53], v7 offset:10304
    v_mfma_f32_16x16x32_bf16 v[116:119], v[64:67], v[28:31], v[116:119]
    ds_read_b64_tr_b16 v[54:55], v7 offset:11584
    s_waitcnt lgkmcnt(8)
    v_mfma_f32_16x16x32_bf16 v[96:99], v[32:35], v[8:11], v[96:99]
    ds_read_b128 v[24:27], v6 offset:12288
    ds_read_b128 v[28:31], v6 offset:12544
    v_mfma_f32_16x16x32_bf16 v[100:103], v[32:35], v[12:15], v[100:103]
    ds_read_b64_tr_b16 v[56:57], v7 offset:15360
    ds_read_b64_tr_b16 v[58:59], v7 offset:16640
    v_mfma_f32_16x16x32_bf16 v[104:107], v[36:39], v[8:11], v[104:107]
    ds_read_b64_tr_b16 v[60:61], v7 offset:15392
    v_mfma_f32_16x16x32_bf16 v[108:111], v[36:39], v[12:15], v[108:111]
    ds_read_b64_tr_b16 v[62:63], v7 offset:16672
    v_mfma_f32_16x16x32_bf16 v[112:115], v[40:43], v[8:11], v[112:115]
    ds_read_b64_tr_b16 v[64:65], v7 offset:15424
    v_mfma_f32_16x16x32_bf16 v[116:119], v[40:43], v[12:15], v[116:119]
    ds_read_b64_tr_b16 v[66:67], v7 offset:16704
    s_waitcnt lgkmcnt(8)
    v_mfma_f32_16x16x32_bf16 v[96:99], v[44:47], v[16:19], v[96:99]
    s_barrier
    v_add_u32 v120, 110592, v4
    v_add_u32 v121, 110592, v5
    ds_read_b128 v[8:11], v120 offset:0
    ds_read_b128 v[12:15], v120 offset:256
    v_mfma_f32_16x16x32_bf16 v[100:103], v[44:47], v[20:23], v[100:103]
    ds_read_b64_tr_b16 v[32:33], v121 offset:0
    ds_read_b64_tr_b16 v[34:35], v121 offset:1280
    v_mfma_f32_16x16x32_bf16 v[104:107], v[48:51], v[16:19], v[104:107]
    ds_read_b64_tr_b16 v[36:37], v121 offset:32
    v_mfma_f32_16x16x32_bf16 v[108:111], v[48:51], v[20:23], v[108:111]
    ds_read_b64_tr_b16 v[38:39], v121 offset:1312
    v_mfma_f32_16x16x32_bf16 v[112:115], v[52:55], v[16:19], v[112:115]
    ds_read_b64_tr_b16 v[40:41], v121 offset:64
    v_mfma_f32_16x16x32_bf16 v[116:119], v[52:55], v[20:23], v[116:119]
    ds_read_b64_tr_b16 v[42:43], v121 offset:1344
    s_waitcnt lgkmcnt(8)
    v_mfma_f32_16x16x32_bf16 v[96:99], v[56:59], v[24:27], v[96:99]
    ds_read_b128 v[16:19], v120 offset:4096
    ds_read_b128 v[20:23], v120 offset:4352
    v_mfma_f32_16x16x32_bf16 v[100:103], v[56:59], v[28:31], v[100:103]
    ds_read_b64_tr_b16 v[44:45], v121 offset:5120
    ds_read_b64_tr_b16 v[46:47], v121 offset:6400
    v_mfma_f32_16x16x32_bf16 v[104:107], v[60:63], v[24:27], v[104:107]
    ds_read_b64_tr_b16 v[48:49], v121 offset:5152
    v_mfma_f32_16x16x32_bf16 v[108:111], v[60:63], v[28:31], v[108:111]
    ds_read_b64_tr_b16 v[50:51], v121 offset:6432
    v_mfma_f32_16x16x32_bf16 v[112:115], v[64:67], v[24:27], v[112:115]
    ds_read_b64_tr_b16 v[52:53], v121 offset:5184
    v_mfma_f32_16x16x32_bf16 v[116:119], v[64:67], v[28:31], v[116:119]
    ds_read_b64_tr_b16 v[54:55], v121 offset:6464
    s_waitcnt lgkmcnt(8)
    v_mfma_f32_16x16x32_bf16 v[96:99], v[32:35], v[8:11], v[96:99]
    ds_read_b128 v[24:27], v120 offset:8192
    ds_read_b128 v[28:31], v120 offset:8448
    v_mfma_f32_16x16x32_bf16 v[100:103], v[32:35], v[12:15], v[100:103]
    ds_read_b64_tr_b16 v[56:57], v121 offset:10240
    ds_read_b64_tr_b16 v[58:59], v121 offset:11520
    v_mfma_f32_16x16x32_bf16 v[104:107], v[36:39], v[8:11], v[104:107]
    ds_read_b64_tr_b16 v[60:61], v121 offset:10272
    v_mfma_f32_16x16x32_bf16 v[108:111], v[36:39], v[12:15], v[108:111]
    ds_read_b64_tr_b16 v[62:63], v121 offset:11552
    v_mfma_f32_16x16x32_bf16 v[112:115], v[40:43], v[8:11], v[112:115]
    ds_read_b64_tr_b16 v[64:65], v121 offset:10304
    v_mfma_f32_16x16x32_bf16 v[116:119], v[40:43], v[12:15], v[116:119]
    ds_read_b64_tr_b16 v[66:67], v121 offset:11584
    s_waitcnt lgkmcnt(8)
    v_mfma_f32_16x16x32_bf16 v[96:99], v[44:47], v[16:19], v[96:99]
    ds_read_b128 v[8:11], v120 offset:12288
    ds_read_b128 v[12:15], v120 offset:12544
    v_mfma_f32_16x16x32_bf16 v[100:103], v[44:47], v[20:23], v[100:103]
    ds_read_b64_tr_b16 v[32:33], v121 offset:15360
    ds_read_b64_tr_b16 v[34:35], v121 offset:16640
    v_mfma_f32_16x16x32_bf16 v[104:107], v[48:51], v[16:19], v[104:107]
    ds_read_b64_tr_b16 v[36:37], v121 offset:15392
    v_mfma_f32_16x16x32_bf16 v[108:111], v[48:51], v[20:23], v[108:111]
    ds_read_b64_tr_b16 v[38:39], v121 offset:16672
    v_mfma_f32_16x16x32_bf16 v[112:115], v[52:55], v[16:19], v[112:115]
    ds_read_b64_tr_b16 v[40:41], v121 offset:15424
    v_mfma_f32_16x16x32_bf16 v[116:119], v[52:55], v[20:23], v[116:119]
    ds_read_b64_tr_b16 v[42:43], v121 offset:16704
    s_waitcnt lgkmcnt(8)
    v_mfma_f32_16x16x32_bf16 v[96:99], v[56:59], v[24:27], v[96:99]
    s_barrier
    v_add_u32 v6, 0, v4
    v_add_u32 v7, 0, v5
    ds_read_b128 v[16:19], v6 offset:0
    ds_read_b128 v[20:23], v6 offset:256
    v_mfma_f32_16x16x32_bf16 v[100:103], v[56:59], v[28:31], v[100:103]
    ds_read_b64_tr_b16 v[44:45], v7 offset:0
    ds_read_b64_tr_b16 v[46:47], v7 offset:1280
    v_mfma_f32_16x16x32_bf16 v[104:107], v[60:63], v[24:27], v[104:107]
    ds_read_b64_tr_b16 v[48:49], v7 offset:32
    v_mfma_f32_16x16x32_bf16 v[108:111], v[60:63], v[28:31], v[108:111]
    ds_read_b64_tr_b16 v[50:51], v7 offset:1312
    v_mfma_f32_16x16x32_bf16 v[112:115], v[64:67], v[24:27], v[112:115]
    ds_read_b64_tr_b16 v[52:53], v7 offset:64
    v_mfma_f32_16x16x32_bf16 v[116:119], v[64:67], v[28:31], v[116:119]
    ds_read_b64_tr_b16 v[54:55], v7 offset:1344
    s_waitcnt lgkmcnt(8)
    v_mfma_f32_16x16x32_bf16 v[96:99], v[32:35], v[8:11], v[96:99]
    ds_read_b128 v[24:27], v6 offset:4096
    ds_read_b128 v[28:31], v6 offset:4352
    v_mfma_f32_16x16x32_bf16 v[100:103], v[32:35], v[12:15], v[100:103]
    ds_read_b64_tr_b16 v[56:57], v7 offset:5120
    ds_read_b64_tr_b16 v[58:59], v7 offset:6400
    v_mfma_f32_16x16x32_bf16 v[104:107], v[36:39], v[8:11], v[104:107]
    ds_read_b64_tr_b16 v[60:61], v7 offset:5152
    v_mfma_f32_16x16x32_bf16 v[108:111], v[36:39], v[12:15], v[108:111]
    ds_read_b64_tr_b16 v[62:63], v7 offset:6432
    v_mfma_f32_16x16x32_bf16 v[112:115], v[40:43], v[8:11], v[112:115]
    ds_read_b64_tr_b16 v[64:65], v7 offset:5184
    v_mfma_f32_16x16x32_bf16 v[116:119], v[40:43], v[12:15], v[116:119]
    ds_read_b64_tr_b16 v[66:67], v7 offset:6464
    s_waitcnt lgkmcnt(8)
    v_mfma_f32_16x16x32_bf16 v[96:99], v[44:47], v[16:19], v[96:99]
    ds_read_b128 v[8:11], v6 offset:8192
    ds_read_b128 v[12:15], v6 offset:8448
    v_mfma_f32_16x16x32_bf16 v[100:103], v[44:47], v[20:23], v[100:103]
    ds_read_b64_tr_b16 v[32:33], v7 offset:10240
    ds_read_b64_tr_b16 v[34:35], v7 offset:11520
    v_mfma_f32_16x16x32_bf16 v[104:107], v[48:51], v[16:19], v[104:107]
    ds_read_b64_tr_b16 v[36:37], v7 offset:10272
    v_mfma_f32_16x16x32_bf16 v[108:111], v[48:51], v[20:23], v[108:111]
    ds_read_b64_tr_b16 v[38:39], v7 offset:11552
    v_mfma_f32_16x16x32_bf16 v[112:115], v[52:55], v[16:19], v[112:115]
    ds_read_b64_tr_b16 v[40:41], v7 offset:10304
    v_mfma_f32_16x16x32_bf16 v[116:119], v[52:55], v[20:23], v[116:119]
    ds_read_b64_tr_b16 v[42:43], v7 offset:11584
    s_waitcnt lgkmcnt(8)
    v_mfma_f32_16x16x32_bf16 v[96:99], v[56:59], v[24:27], v[96:99]
    ds_read_b128 v[16:19], v6 offset:12288
    ds_read_b128 v[20:23], v6 offset:12544
    v_mfma_f32_16x16x32_bf16 v[100:103], v[56:59], v[28:31], v[100:103]
    ds_read_b64_tr_b16 v[44:45], v7 offset:15360
    ds_read_b64_tr_b16 v[46:47], v7 offset:16640
    v_mfma_f32_16x16x32_bf16 v[104:107], v[60:63], v[24:27], v[104:107]
    ds_read_b64_tr_b16 v[48:49], v7 offset:15392
    v_mfma_f32_16x16x32_bf16 v[108:111], v[60:63], v[28:31], v[108:111]
    ds_read_b64_tr_b16 v[50:51], v7 offset:16672
    v_mfma_f32_16x16x32_bf16 v[112:115], v[64:67], v[24:27], v[112:115]
    ds_read_b64_tr_b16 v[52:53], v7 offset:15424
    v_mfma_f32_16x16x32_bf16 v[116:119], v[64:67], v[28:31], v[116:119]
    ds_read_b64_tr_b16 v[54:55], v7 offset:16704
    s_waitcnt lgkmcnt(8)
    v_mfma_f32_16x16x32_bf16 v[96:99], v[32:35], v[8:11], v[96:99]
    s_barrier
    v_add_u32 v120, 36864, v4
    v_add_u32 v121, 36864, v5
    ds_read_b128 v[24:27], v120 offset:0
    ds_read_b128 v[28:31], v120 offset:256
    v_mfma_f32_16x16x32_bf16 v[100:103], v[32:35], v[12:15], v[100:103]
    ds_read_b64_tr_b16 v[56:57], v121 offset:0
    ds_read_b64_tr_b16 v[58:59], v121 offset:1280
    v_mfma_f32_16x16x32_bf16 v[104:107], v[36:39], v[8:11], v[104:107]
    ds_read_b64_tr_b16 v[60:61], v121 offset:32
    v_mfma_f32_16x16x32_bf16 v[108:111], v[36:39], v[12:15], v[108:111]
    ds_read_b64_tr_b16 v[62:63], v121 offset:1312
    v_mfma_f32_16x16x32_bf16 v[112:115], v[40:43], v[8:11], v[112:115]
    ds_read_b64_tr_b16 v[64:65], v121 offset:64
    v_mfma_f32_16x16x32_bf16 v[116:119], v[40:43], v[12:15], v[116:119]
    ds_read_b64_tr_b16 v[66:67], v121 offset:1344
    s_waitcnt lgkmcnt(8)
    v_mfma_f32_16x16x32_bf16 v[96:99], v[44:47], v[16:19], v[96:99]
    ds_read_b128 v[8:11], v120 offset:4096
    ds_read_b128 v[12:15], v120 offset:4352
    v_mfma_f32_16x16x32_bf16 v[100:103], v[44:47], v[20:23], v[100:103]
    ds_read_b64_tr_b16 v[32:33], v121 offset:5120
    ds_read_b64_tr_b16 v[34:35], v121 offset:6400
    v_mfma_f32_16x16x32_bf16 v[104:107], v[48:51], v[16:19], v[104:107]
    ds_read_b64_tr_b16 v[36:37], v121 offset:5152
    v_mfma_f32_16x16x32_bf16 v[108:111], v[48:51], v[20:23], v[108:111]
    ds_read_b64_tr_b16 v[38:39], v121 offset:6432
    v_mfma_f32_16x16x32_bf16 v[112:115], v[52:55], v[16:19], v[112:115]
    ds_read_b64_tr_b16 v[40:41], v121 offset:5184
    v_mfma_f32_16x16x32_bf16 v[116:119], v[52:55], v[20:23], v[116:119]
    ds_read_b64_tr_b16 v[42:43], v121 offset:6464
    s_waitcnt lgkmcnt(8)
    v_mfma_f32_16x16x32_bf16 v[96:99], v[56:59], v[24:27], v[96:99]
    ds_read_b128 v[16:19], v120 offset:8192
    ds_read_b128 v[20:23], v120 offset:8448
    v_mfma_f32_16x16x32_bf16 v[100:103], v[56:59], v[28:31], v[100:103]
    ds_read_b64_tr_b16 v[44:45], v121 offset:10240
    ds_read_b64_tr_b16 v[46:47], v121 offset:11520
    v_mfma_f32_16x16x32_bf16 v[104:107], v[60:63], v[24:27], v[104:107]
    ds_read_b64_tr_b16 v[48:49], v121 offset:10272
    v_mfma_f32_16x16x32_bf16 v[108:111], v[60:63], v[28:31], v[108:111]
    ds_read_b64_tr_b16 v[50:51], v121 offset:11552
    v_mfma_f32_16x16x32_bf16 v[112:115], v[64:67], v[24:27], v[112:115]
    ds_read_b64_tr_b16 v[52:53], v121 offset:10304
    v_mfma_f32_16x16x32_bf16 v[116:119], v[64:67], v[28:31], v[116:119]
    ds_read_b64_tr_b16 v[54:55], v121 offset:11584
    s_waitcnt lgkmcnt(8)
    v_mfma_f32_16x16x32_bf16 v[96:99], v[32:35], v[8:11], v[96:99]
    ds_read_b128 v[24:27], v120 offset:12288
    ds_read_b128 v[28:31], v120 offset:12544
    v_mfma_f32_16x16x32_bf16 v[100:103], v[32:35], v[12:15], v[100:103]
    ds_read_b64_tr_b16 v[56:57], v121 offset:15360
    ds_read_b64_tr_b16 v[58:59], v121 offset:16640
    v_mfma_f32_16x16x32_bf16 v[104:107], v[36:39], v[8:11], v[104:107]
    ds_read_b64_tr_b16 v[60:61], v121 offset:15392
    v_mfma_f32_16x16x32_bf16 v[108:111], v[36:39], v[12:15], v[108:111]
    ds_read_b64_tr_b16 v[62:63], v121 offset:16672
    v_mfma_f32_16x16x32_bf16 v[112:115], v[40:43], v[8:11], v[112:115]
    ds_read_b64_tr_b16 v[64:65], v121 offset:15424
    v_mfma_f32_16x16x32_bf16 v[116:119], v[40:43], v[12:15], v[116:119]
    ds_read_b64_tr_b16 v[66:67], v121 offset:16704
    s_waitcnt lgkmcnt(8)
    v_mfma_f32_16x16x32_bf16 v[96:99], v[44:47], v[16:19], v[96:99]
    s_barrier
    v_add_u32 v6, 73728, v4
    v_add_u32 v7, 73728, v5
    ds_read_b128 v[8:11], v6 offset:0
    ds_read_b128 v[12:15], v6 offset:256
    v_mfma_f32_16x16x32_bf16 v[100:103], v[44:47], v[20:23], v[100:103]
    ds_read_b64_tr_b16 v[32:33], v7 offset:0
    ds_read_b64_tr_b16 v[34:35], v7 offset:1280
    v_mfma_f32_16x16x32_bf16 v[104:107], v[48:51], v[16:19], v[104:107]
    ds_read_b64_tr_b16 v[36:37], v7 offset:32
    v_mfma_f32_16x16x32_bf16 v[108:111], v[48:51], v[20:23], v[108:111]
    ds_read_b64_tr_b16 v[38:39], v7 offset:1312
    v_mfma_f32_16x16x32_bf16 v[112:115], v[52:55], v[16:19], v[112:115]
    ds_read_b64_tr_b16 v[40:41], v7 offset:64
    v_mfma_f32_16x16x32_bf16 v[116:119], v[52:55], v[20:23], v[116:119]
    ds_read_b64_tr_b16 v[42:43], v7 offset:1344
    s_waitcnt lgkmcnt(8)
    v_mfma_f32_16x16x32_bf16 v[96:99], v[56:59], v[24:27], v[96:99]
    ds_read_b128 v[16:19], v6 offset:4096
    ds_read_b128 v[20:23], v6 offset:4352
    v_mfma_f32_16x16x32_bf16 v[100:103], v[56:59], v[28:31], v[100:103]
    ds_read_b64_tr_b16 v[44:45], v7 offset:5120
    ds_read_b64_tr_b16 v[46:47], v7 offset:6400
    v_mfma_f32_16x16x32_bf16 v[104:107], v[60:63], v[24:27], v[104:107]
    ds_read_b64_tr_b16 v[48:49], v7 offset:5152
    v_mfma_f32_16x16x32_bf16 v[108:111], v[60:63], v[28:31], v[108:111]
    ds_read_b64_tr_b16 v[50:51], v7 offset:6432
    v_mfma_f32_16x16x32_bf16 v[112:115], v[64:67], v[24:27], v[112:115]
    ds_read_b64_tr_b16 v[52:53], v7 offset:5184
    v_mfma_f32_16x16x32_bf16 v[116:119], v[64:67], v[28:31], v[116:119]
    ds_read_b64_tr_b16 v[54:55], v7 offset:6464
    s_waitcnt lgkmcnt(8)
    v_mfma_f32_16x16x32_bf16 v[96:99], v[32:35], v[8:11], v[96:99]
    ds_read_b128 v[24:27], v6 offset:8192
    ds_read_b128 v[28:31], v6 offset:8448
    v_mfma_f32_16x16x32_bf16 v[100:103], v[32:35], v[12:15], v[100:103]
    ds_read_b64_tr_b16 v[56:57], v7 offset:10240
    ds_read_b64_tr_b16 v[58:59], v7 offset:11520
    v_mfma_f32_16x16x32_bf16 v[104:107], v[36:39], v[8:11], v[104:107]
    ds_read_b64_tr_b16 v[60:61], v7 offset:10272
    v_mfma_f32_16x16x32_bf16 v[108:111], v[36:39], v[12:15], v[108:111]
    ds_read_b64_tr_b16 v[62:63], v7 offset:11552
    v_mfma_f32_16x16x32_bf16 v[112:115], v[40:43], v[8:11], v[112:115]
    ds_read_b64_tr_b16 v[64:65], v7 offset:10304
    v_mfma_f32_16x16x32_bf16 v[116:119], v[40:43], v[12:15], v[116:119]
    ds_read_b64_tr_b16 v[66:67], v7 offset:11584
    s_waitcnt lgkmcnt(8)
    v_mfma_f32_16x16x32_bf16 v[96:99], v[44:47], v[16:19], v[96:99]
    ds_read_b128 v[8:11], v6 offset:12288
    ds_read_b128 v[12:15], v6 offset:12544
    v_mfma_f32_16x16x32_bf16 v[100:103], v[44:47], v[20:23], v[100:103]
    ds_read_b64_tr_b16 v[32:33], v7 offset:15360
    ds_read_b64_tr_b16 v[34:35], v7 offset:16640
    v_mfma_f32_16x16x32_bf16 v[104:107], v[48:51], v[16:19], v[104:107]
    ds_read_b64_tr_b16 v[36:37], v7 offset:15392
    v_mfma_f32_16x16x32_bf16 v[108:111], v[48:51], v[20:23], v[108:111]
    ds_read_b64_tr_b16 v[38:39], v7 offset:16672
    v_mfma_f32_16x16x32_bf16 v[112:115], v[52:55], v[16:19], v[112:115]
    ds_read_b64_tr_b16 v[40:41], v7 offset:15424
    v_mfma_f32_16x16x32_bf16 v[116:119], v[52:55], v[20:23], v[116:119]
    ds_read_b64_tr_b16 v[42:43], v7 offset:16704
    s_waitcnt lgkmcnt(8)
    v_mfma_f32_16x16x32_bf16 v[96:99], v[56:59], v[24:27], v[96:99]
    s_barrier
    v_add_u32 v120, 110592, v4
    v_add_u32 v121, 110592, v5
    ds_read_b128 v[16:19], v120 offset:0
    ds_read_b128 v[20:23], v120 offset:256
    v_mfma_f32_16x16x32_bf16 v[100:103], v[56:59], v[28:31], v[100:103]
    ds_read_b64_tr_b16 v[44:45], v121 offset:0
    ds_read_b64_tr_b16 v[46:47], v121 offset:1280
    v_mfma_f32_16x16x32_bf16 v[104:107], v[60:63], v[24:27], v[104:107]
    ds_read_b64_tr_b16 v[48:49], v121 offset:32
    v_mfma_f32_16x16x32_bf16 v[108:111], v[60:63], v[28:31], v[108:111]
    ds_read_b64_tr_b16 v[50:51], v121 offset:1312
    v_mfma_f32_16x16x32_bf16 v[112:115], v[64:67], v[24:27], v[112:115]
    ds_read_b64_tr_b16 v[52:53], v121 offset:64
    v_mfma_f32_16x16x32_bf16 v[116:119], v[64:67], v[28:31], v[116:119]
    ds_read_b64_tr_b16 v[54:55], v121 offset:1344
    s_waitcnt lgkmcnt(8)
    v_mfma_f32_16x16x32_bf16 v[96:99], v[32:35], v[8:11], v[96:99]
    ds_read_b128 v[24:27], v120 offset:4096
    ds_read_b128 v[28:31], v120 offset:4352
    v_mfma_f32_16x16x32_bf16 v[100:103], v[32:35], v[12:15], v[100:103]
    ds_read_b64_tr_b16 v[56:57], v121 offset:5120
    ds_read_b64_tr_b16 v[58:59], v121 offset:6400
    v_mfma_f32_16x16x32_bf16 v[104:107], v[36:39], v[8:11], v[104:107]
    ds_read_b64_tr_b16 v[60:61], v121 offset:5152
    v_mfma_f32_16x16x32_bf16 v[108:111], v[36:39], v[12:15], v[108:111]
    ds_read_b64_tr_b16 v[62:63], v121 offset:6432
    v_mfma_f32_16x16x32_bf16 v[112:115], v[40:43], v[8:11], v[112:115]
    ds_read_b64_tr_b16 v[64:65], v121 offset:5184
    v_mfma_f32_16x16x32_bf16 v[116:119], v[40:43], v[12:15], v[116:119]
    ds_read_b64_tr_b16 v[66:67], v121 offset:6464
    s_waitcnt lgkmcnt(8)
    v_mfma_f32_16x16x32_bf16 v[96:99], v[44:47], v[16:19], v[96:99]
    ds_read_b128 v[8:11], v120 offset:8192
    ds_read_b128 v[12:15], v120 offset:8448
    v_mfma_f32_16x16x32_bf16 v[100:103], v[44:47], v[20:23], v[100:103]
    ds_read_b64_tr_b16 v[32:33], v121 offset:10240
    ds_read_b64_tr_b16 v[34:35], v121 offset:11520
    v_mfma_f32_16x16x32_bf16 v[104:107], v[48:51], v[16:19], v[104:107]
    ds_read_b64_tr_b16 v[36:37], v121 offset:10272
    v_mfma_f32_16x16x32_bf16 v[108:111], v[48:51], v[20:23], v[108:111]
    ds_read_b64_tr_b16 v[38:39], v121 offset:11552
    v_mfma_f32_16x16x32_bf16 v[112:115], v[52:55], v[16:19], v[112:115]
    ds_read_b64_tr_b16 v[40:41], v121 offset:10304
    v_mfma_f32_16x16x32_bf16 v[116:119], v[52:55], v[20:23], v[116:119]
    ds_read_b64_tr_b16 v[42:43], v121 offset:11584
    s_waitcnt lgkmcnt(8)
    v_mfma_f32_16x16x32_bf16 v[96:99], v[56:59], v[24:27], v[96:99]
    ds_read_b128 v[16:19], v120 offset:12288
    ds_read_b128 v[20:23], v120 offset:12544
    v_mfma_f32_16x16x32_bf16 v[100:103], v[56:59], v[28:31], v[100:103]
    ds_read_b64_tr_b16 v[44:45], v121 offset:15360
    ds_read_b64_tr_b16 v[46:47], v121 offset:16640
    v_mfma_f32_16x16x32_bf16 v[104:107], v[60:63], v[24:27], v[104:107]
    ds_read_b64_tr_b16 v[48:49], v121 offset:15392
    v_mfma_f32_16x16x32_bf16 v[108:111], v[60:63], v[28:31], v[108:111]
    ds_read_b64_tr_b16 v[50:51], v121 offset:16672
    v_mfma_f32_16x16x32_bf16 v[112:115], v[64:67], v[24:27], v[112:115]
    ds_read_b64_tr_b16 v[52:53], v121 offset:15424
    v_mfma_f32_16x16x32_bf16 v[116:119], v[64:67], v[28:31], v[116:119]
    ds_read_b64_tr_b16 v[54:55], v121 offset:16704
    s_waitcnt lgkmcnt(8)
    v_mfma_f32_16x16x32_bf16 v[96:99], v[32:35], v[8:11], v[96:99]
    s_barrier
    v_add_u32 v6, 0, v4
    v_add_u32 v7, 0, v5
    ds_read_b128 v[24:27], v6 offset:0
    ds_read_b128 v[28:31], v6 offset:256
    v_mfma_f32_16x16x32_bf16 v[100:103], v[32:35], v[12:15], v[100:103]
    ds_read_b64_tr_b16 v[56:57], v7 offset:0
    ds_read_b64_tr_b16 v[58:59], v7 offset:1280
    v_mfma_f32_16x16x32_bf16 v[104:107], v[36:39], v[8:11], v[104:107]
    ds_read_b64_tr_b16 v[60:61], v7 offset:32
    v_mfma_f32_16x16x32_bf16 v[108:111], v[36:39], v[12:15], v[108:111]
    ds_read_b64_tr_b16 v[62:63], v7 offset:1312
    v_mfma_f32_16x16x32_bf16 v[112:115], v[40:43], v[8:11], v[112:115]
    ds_read_b64_tr_b16 v[64:65], v7 offset:64
    v_mfma_f32_16x16x32_bf16 v[116:119], v[40:43], v[12:15], v[116:119]
    ds_read_b64_tr_b16 v[66:67], v7 offset:1344
    s_waitcnt lgkmcnt(8)
    v_mfma_f32_16x16x32_bf16 v[96:99], v[44:47], v[16:19], v[96:99]
    ds_read_b128 v[8:11], v6 offset:4096
    ds_read_b128 v[12:15], v6 offset:4352
    v_mfma_f32_16x16x32_bf16 v[100:103], v[44:47], v[20:23], v[100:103]
    ds_read_b64_tr_b16 v[32:33], v7 offset:5120
    ds_read_b64_tr_b16 v[34:35], v7 offset:6400
    v_mfma_f32_16x16x32_bf16 v[104:107], v[48:51], v[16:19], v[104:107]
    ds_read_b64_tr_b16 v[36:37], v7 offset:5152
    v_mfma_f32_16x16x32_bf16 v[108:111], v[48:51], v[20:23], v[108:111]
    ds_read_b64_tr_b16 v[38:39], v7 offset:6432
    v_mfma_f32_16x16x32_bf16 v[112:115], v[52:55], v[16:19], v[112:115]
    ds_read_b64_tr_b16 v[40:41], v7 offset:5184
    v_mfma_f32_16x16x32_bf16 v[116:119], v[52:55], v[20:23], v[116:119]
    ds_read_b64_tr_b16 v[42:43], v7 offset:6464
    s_waitcnt lgkmcnt(8)
    v_mfma_f32_16x16x32_bf16 v[96:99], v[56:59], v[24:27], v[96:99]
    ds_read_b128 v[16:19], v6 offset:8192
    ds_read_b128 v[20:23], v6 offset:8448
    v_mfma_f32_16x16x32_bf16 v[100:103], v[56:59], v[28:31], v[100:103]
    ds_read_b64_tr_b16 v[44:45], v7 offset:10240
    ds_read_b64_tr_b16 v[46:47], v7 offset:11520
    v_mfma_f32_16x16x32_bf16 v[104:107], v[60:63], v[24:27], v[104:107]
    ds_read_b64_tr_b16 v[48:49], v7 offset:10272
    v_mfma_f32_16x16x32_bf16 v[108:111], v[60:63], v[28:31], v[108:111]
    ds_read_b64_tr_b16 v[50:51], v7 offset:11552
    v_mfma_f32_16x16x32_bf16 v[112:115], v[64:67], v[24:27], v[112:115]
    ds_read_b64_tr_b16 v[52:53], v7 offset:10304
    v_mfma_f32_16x16x32_bf16 v[116:119], v[64:67], v[28:31], v[116:119]
    ds_read_b64_tr_b16 v[54:55], v7 offset:11584
    s_waitcnt lgkmcnt(8)
    v_mfma_f32_16x16x32_bf16 v[96:99], v[32:35], v[8:11], v[96:99]
    ds_read_b128 v[24:27], v6 offset:12288
    ds_read_b128 v[28:31], v6 offset:12544
    v_mfma_f32_16x16x32_bf16 v[100:103], v[32:35], v[12:15], v[100:103]
    ds_read_b64_tr_b16 v[56:57], v7 offset:15360
    ds_read_b64_tr_b16 v[58:59], v7 offset:16640
    v_mfma_f32_16x16x32_bf16 v[104:107], v[36:39], v[8:11], v[104:107]
    ds_read_b64_tr_b16 v[60:61], v7 offset:15392
    v_mfma_f32_16x16x32_bf16 v[108:111], v[36:39], v[12:15], v[108:111]
    ds_read_b64_tr_b16 v[62:63], v7 offset:16672
    v_mfma_f32_16x16x32_bf16 v[112:115], v[40:43], v[8:11], v[112:115]
    ds_read_b64_tr_b16 v[64:65], v7 offset:15424
    v_mfma_f32_16x16x32_bf16 v[116:119], v[40:43], v[12:15], v[116:119]
    ds_read_b64_tr_b16 v[66:67], v7 offset:16704
    s_waitcnt lgkmcnt(8)
    v_mfma_f32_16x16x32_bf16 v[96:99], v[44:47], v[16:19], v[96:99]
    s_barrier
    v_add_u32 v120, 36864, v4
    v_add_u32 v121, 36864, v5
    ds_read_b128 v[8:11], v120 offset:0
    ds_read_b128 v[12:15], v120 offset:256
    v_mfma_f32_16x16x32_bf16 v[100:103], v[44:47], v[20:23], v[100:103]
    ds_read_b64_tr_b16 v[32:33], v121 offset:0
    ds_read_b64_tr_b16 v[34:35], v121 offset:1280
    v_mfma_f32_16x16x32_bf16 v[104:107], v[48:51], v[16:19], v[104:107]
    ds_read_b64_tr_b16 v[36:37], v121 offset:32
    v_mfma_f32_16x16x32_bf16 v[108:111], v[48:51], v[20:23], v[108:111]
    ds_read_b64_tr_b16 v[38:39], v121 offset:1312
    v_mfma_f32_16x16x32_bf16 v[112:115], v[52:55], v[16:19], v[112:115]
    ds_read_b64_tr_b16 v[40:41], v121 offset:64
    v_mfma_f32_16x16x32_bf16 v[116:119], v[52:55], v[20:23], v[116:119]
    ds_read_b64_tr_b16 v[42:43], v121 offset:1344
    s_waitcnt lgkmcnt(8)
    v_mfma_f32_16x16x32_bf16 v[96:99], v[56:59], v[24:27], v[96:99]
    ds_read_b128 v[16:19], v120 offset:4096
    ds_read_b128 v[20:23], v120 offset:4352
    v_mfma_f32_16x16x32_bf16 v[100:103], v[56:59], v[28:31], v[100:103]
    ds_read_b64_tr_b16 v[44:45], v121 offset:5120
    ds_read_b64_tr_b16 v[46:47], v121 offset:6400
    v_mfma_f32_16x16x32_bf16 v[104:107], v[60:63], v[24:27], v[104:107]
    ds_read_b64_tr_b16 v[48:49], v121 offset:5152
    v_mfma_f32_16x16x32_bf16 v[108:111], v[60:63], v[28:31], v[108:111]
    ds_read_b64_tr_b16 v[50:51], v121 offset:6432
    v_mfma_f32_16x16x32_bf16 v[112:115], v[64:67], v[24:27], v[112:115]
    ds_read_b64_tr_b16 v[52:53], v121 offset:5184
    v_mfma_f32_16x16x32_bf16 v[116:119], v[64:67], v[28:31], v[116:119]
    ds_read_b64_tr_b16 v[54:55], v121 offset:6464
    s_waitcnt lgkmcnt(8)
    v_mfma_f32_16x16x32_bf16 v[96:99], v[32:35], v[8:11], v[96:99]
    ds_read_b128 v[24:27], v120 offset:8192
    ds_read_b128 v[28:31], v120 offset:8448
    v_mfma_f32_16x16x32_bf16 v[100:103], v[32:35], v[12:15], v[100:103]
    ds_read_b64_tr_b16 v[56:57], v121 offset:10240
    ds_read_b64_tr_b16 v[58:59], v121 offset:11520
    v_mfma_f32_16x16x32_bf16 v[104:107], v[36:39], v[8:11], v[104:107]
    ds_read_b64_tr_b16 v[60:61], v121 offset:10272
    v_mfma_f32_16x16x32_bf16 v[108:111], v[36:39], v[12:15], v[108:111]
    ds_read_b64_tr_b16 v[62:63], v121 offset:11552
    v_mfma_f32_16x16x32_bf16 v[112:115], v[40:43], v[8:11], v[112:115]
    ds_read_b64_tr_b16 v[64:65], v121 offset:10304
    v_mfma_f32_16x16x32_bf16 v[116:119], v[40:43], v[12:15], v[116:119]
    ds_read_b64_tr_b16 v[66:67], v121 offset:11584
    s_waitcnt lgkmcnt(8)
    v_mfma_f32_16x16x32_bf16 v[96:99], v[44:47], v[16:19], v[96:99]
    ds_read_b128 v[8:11], v120 offset:12288
    ds_read_b128 v[12:15], v120 offset:12544
    v_mfma_f32_16x16x32_bf16 v[100:103], v[44:47], v[20:23], v[100:103]
    ds_read_b64_tr_b16 v[32:33], v121 offset:15360
    ds_read_b64_tr_b16 v[34:35], v121 offset:16640
    v_mfma_f32_16x16x32_bf16 v[104:107], v[48:51], v[16:19], v[104:107]
    ds_read_b64_tr_b16 v[36:37], v121 offset:15392
    v_mfma_f32_16x16x32_bf16 v[108:111], v[48:51], v[20:23], v[108:111]
    ds_read_b64_tr_b16 v[38:39], v121 offset:16672
    v_mfma_f32_16x16x32_bf16 v[112:115], v[52:55], v[16:19], v[112:115]
    ds_read_b64_tr_b16 v[40:41], v121 offset:15424
    v_mfma_f32_16x16x32_bf16 v[116:119], v[52:55], v[20:23], v[116:119]
    ds_read_b64_tr_b16 v[42:43], v121 offset:16704
    s_waitcnt lgkmcnt(8)
    v_mfma_f32_16x16x32_bf16 v[96:99], v[56:59], v[24:27], v[96:99]
    s_barrier
    v_add_u32 v6, 73728, v4
    v_add_u32 v7, 73728, v5
    ds_read_b128 v[16:19], v6 offset:0
    ds_read_b128 v[20:23], v6 offset:256
    v_mfma_f32_16x16x32_bf16 v[100:103], v[56:59], v[28:31], v[100:103]
    ds_read_b64_tr_b16 v[44:45], v7 offset:0
    ds_read_b64_tr_b16 v[46:47], v7 offset:1280
    v_mfma_f32_16x16x32_bf16 v[104:107], v[60:63], v[24:27], v[104:107]
    ds_read_b64_tr_b16 v[48:49], v7 offset:32
    v_mfma_f32_16x16x32_bf16 v[108:111], v[60:63], v[28:31], v[108:111]
    ds_read_b64_tr_b16 v[50:51], v7 offset:1312
    v_mfma_f32_16x16x32_bf16 v[112:115], v[64:67], v[24:27], v[112:115]
    ds_read_b64_tr_b16 v[52:53], v7 offset:64
    v_mfma_f32_16x16x32_bf16 v[116:119], v[64:67], v[28:31], v[116:119]
    ds_read_b64_tr_b16 v[54:55], v7 offset:1344
    s_waitcnt lgkmcnt(8)
    v_mfma_f32_16x16x32_bf16 v[96:99], v[32:35], v[8:11], v[96:99]
    ds_read_b128 v[24:27], v6 offset:4096
    ds_read_b128 v[28:31], v6 offset:4352
    v_mfma_f32_16x16x32_bf16 v[100:103], v[32:35], v[12:15], v[100:103]
    ds_read_b64_tr_b16 v[56:57], v7 offset:5120
    ds_read_b64_tr_b16 v[58:59], v7 offset:6400
    v_mfma_f32_16x16x32_bf16 v[104:107], v[36:39], v[8:11], v[104:107]
    ds_read_b64_tr_b16 v[60:61], v7 offset:5152
    v_mfma_f32_16x16x32_bf16 v[108:111], v[36:39], v[12:15], v[108:111]
    ds_read_b64_tr_b16 v[62:63], v7 offset:6432
    v_mfma_f32_16x16x32_bf16 v[112:115], v[40:43], v[8:11], v[112:115]
    ds_read_b64_tr_b16 v[64:65], v7 offset:5184
    v_mfma_f32_16x16x32_bf16 v[116:119], v[40:43], v[12:15], v[116:119]
    ds_read_b64_tr_b16 v[66:67], v7 offset:6464
    s_waitcnt lgkmcnt(8)
    v_mfma_f32_16x16x32_bf16 v[96:99], v[44:47], v[16:19], v[96:99]
    ds_read_b128 v[8:11], v6 offset:8192
    ds_read_b128 v[12:15], v6 offset:8448
    v_mfma_f32_16x16x32_bf16 v[100:103], v[44:47], v[20:23], v[100:103]
    ds_read_b64_tr_b16 v[32:33], v7 offset:10240
    ds_read_b64_tr_b16 v[34:35], v7 offset:11520
    v_mfma_f32_16x16x32_bf16 v[104:107], v[48:51], v[16:19], v[104:107]
    ds_read_b64_tr_b16 v[36:37], v7 offset:10272
    v_mfma_f32_16x16x32_bf16 v[108:111], v[48:51], v[20:23], v[108:111]
    ds_read_b64_tr_b16 v[38:39], v7 offset:11552
    v_mfma_f32_16x16x32_bf16 v[112:115], v[52:55], v[16:19], v[112:115]
    ds_read_b64_tr_b16 v[40:41], v7 offset:10304
    v_mfma_f32_16x16x32_bf16 v[116:119], v[52:55], v[20:23], v[116:119]
    ds_read_b64_tr_b16 v[42:43], v7 offset:11584
    s_waitcnt lgkmcnt(8)
    v_mfma_f32_16x16x32_bf16 v[96:99], v[56:59], v[24:27], v[96:99]
    ds_read_b128 v[16:19], v6 offset:12288
    ds_read_b128 v[20:23], v6 offset:12544
    v_mfma_f32_16x16x32_bf16 v[100:103], v[56:59], v[28:31], v[100:103]
    ds_read_b64_tr_b16 v[44:45], v7 offset:15360
    ds_read_b64_tr_b16 v[46:47], v7 offset:16640
    v_mfma_f32_16x16x32_bf16 v[104:107], v[60:63], v[24:27], v[104:107]
    ds_read_b64_tr_b16 v[48:49], v7 offset:15392
    v_mfma_f32_16x16x32_bf16 v[108:111], v[60:63], v[28:31], v[108:111]
    ds_read_b64_tr_b16 v[50:51], v7 offset:16672
    v_mfma_f32_16x16x32_bf16 v[112:115], v[64:67], v[24:27], v[112:115]
    ds_read_b64_tr_b16 v[52:53], v7 offset:15424
    v_mfma_f32_16x16x32_bf16 v[116:119], v[64:67], v[28:31], v[116:119]
    ds_read_b64_tr_b16 v[54:55], v7 offset:16704
    s_waitcnt lgkmcnt(8)
    v_mfma_f32_16x16x32_bf16 v[96:99], v[32:35], v[8:11], v[96:99]
    s_barrier
    v_add_u32 v120, 110592, v4
    v_add_u32 v121, 110592, v5
    ds_read_b128 v[24:27], v120 offset:0
    ds_read_b128 v[28:31], v120 offset:256
    v_mfma_f32_16x16x32_bf16 v[100:103], v[32:35], v[12:15], v[100:103]
    ds_read_b64_tr_b16 v[56:57], v121 offset:0
    ds_read_b64_tr_b16 v[58:59], v121 offset:1280
    v_mfma_f32_16x16x32_bf16 v[104:107], v[36:39], v[8:11], v[104:107]
    ds_read_b64_tr_b16 v[60:61], v121 offset:32
    v_mfma_f32_16x16x32_bf16 v[108:111], v[36:39], v[12:15], v[108:111]
    ds_read_b64_tr_b16 v[62:63], v121 offset:1312
    v_mfma_f32_16x16x32_bf16 v[112:115], v[40:43], v[8:11], v[112:115]
    ds_read_b64_tr_b16 v[64:65], v121 offset:64
    v_mfma_f32_16x16x32_bf16 v[116:119], v[40:43], v[12:15], v[116:119]
    ds_read_b64_tr_b16 v[66:67], v121 offset:1344
    s_waitcnt lgkmcnt(8)
    v_mfma_f32_16x16x32_bf16 v[96:99], v[44:47], v[16:19], v[96:99]
    ds_read_b128 v[8:11], v120 offset:4096
    ds_read_b128 v[12:15], v120 offset:4352
    v_mfma_f32_16x16x32_bf16 v[100:103], v[44:47], v[20:23], v[100:103]
    ds_read_b64_tr_b16 v[32:33], v121 offset:5120
    ds_read_b64_tr_b16 v[34:35], v121 offset:6400
    v_mfma_f32_16x16x32_bf16 v[104:107], v[48:51], v[16:19], v[104:107]
    ds_read_b64_tr_b16 v[36:37], v121 offset:5152
    v_mfma_f32_16x16x32_bf16 v[108:111], v[48:51], v[20:23], v[108:111]
    ds_read_b64_tr_b16 v[38:39], v121 offset:6432
    v_mfma_f32_16x16x32_bf16 v[112:115], v[52:55], v[16:19], v[112:115]
    ds_read_b64_tr_b16 v[40:41], v121 offset:5184
    v_mfma_f32_16x16x32_bf16 v[116:119], v[52:55], v[20:23], v[116:119]
    ds_read_b64_tr_b16 v[42:43], v121 offset:6464
    s_waitcnt lgkmcnt(8)
    v_mfma_f32_16x16x32_bf16 v[96:99], v[56:59], v[24:27], v[96:99]
    ds_read_b128 v[16:19], v120 offset:8192
    ds_read_b128 v[20:23], v120 offset:8448
    v_mfma_f32_16x16x32_bf16 v[100:103], v[56:59], v[28:31], v[100:103]
    ds_read_b64_tr_b16 v[44:45], v121 offset:10240
    ds_read_b64_tr_b16 v[46:47], v121 offset:11520
    v_mfma_f32_16x16x32_bf16 v[104:107], v[60:63], v[24:27], v[104:107]
    ds_read_b64_tr_b16 v[48:49], v121 offset:10272
    v_mfma_f32_16x16x32_bf16 v[108:111], v[60:63], v[28:31], v[108:111]
    ds_read_b64_tr_b16 v[50:51], v121 offset:11552
    v_mfma_f32_16x16x32_bf16 v[112:115], v[64:67], v[24:27], v[112:115]
    ds_read_b64_tr_b16 v[52:53], v121 offset:10304
    v_mfma_f32_16x16x32_bf16 v[116:119], v[64:67], v[28:31], v[116:119]
    ds_read_b64_tr_b16 v[54:55], v121 offset:11584
    s_waitcnt lgkmcnt(8)
    v_mfma_f32_16x16x32_bf16 v[96:99], v[32:35], v[8:11], v[96:99]
    ds_read_b128 v[24:27], v120 offset:12288
    ds_read_b128 v[28:31], v120 offset:12544
    v_mfma_f32_16x16x32_bf16 v[100:103], v[32:35], v[12:15], v[100:103]
    ds_read_b64_tr_b16 v[56:57], v121 offset:15360
    ds_read_b64_tr_b16 v[58:59], v121 offset:16640
    v_mfma_f32_16x16x32_bf16 v[104:107], v[36:39], v[8:11], v[104:107]
    ds_read_b64_tr_b16 v[60:61], v121 offset:15392
    v_mfma_f32_16x16x32_bf16 v[108:111], v[36:39], v[12:15], v[108:111]
    ds_read_b64_tr_b16 v[62:63], v121 offset:16672
    v_mfma_f32_16x16x32_bf16 v[112:115], v[40:43], v[8:11], v[112:115]
    ds_read_b64_tr_b16 v[64:65], v121 offset:15424
    v_mfma_f32_16x16x32_bf16 v[116:119], v[40:43], v[12:15], v[116:119]
    ds_read_b64_tr_b16 v[66:67], v121 offset:16704
    s_waitcnt lgkmcnt(8)
    v_mfma_f32_16x16x32_bf16 v[96:99], v[44:47], v[16:19], v[96:99]
    s_barrier
    v_add_u32 v6, 0, v4
    v_add_u32 v7, 0, v5
    ds_read_b128 v[8:11], v6 offset:0
    ds_read_b128 v[12:15], v6 offset:256
    v_mfma_f32_16x16x32_bf16 v[100:103], v[44:47], v[20:23], v[100:103]
    ds_read_b64_tr_b16 v[32:33], v7 offset:0
    ds_read_b64_tr_b16 v[34:35], v7 offset:1280
    v_mfma_f32_16x16x32_bf16 v[104:107], v[48:51], v[16:19], v[104:107]
    ds_read_b64_tr_b16 v[36:37], v7 offset:32
    v_mfma_f32_16x16x32_bf16 v[108:111], v[48:51], v[20:23], v[108:111]
    ds_read_b64_tr_b16 v[38:39], v7 offset:1312
    v_mfma_f32_16x16x32_bf16 v[112:115], v[52:55], v[16:19], v[112:115]
    ds_read_b64_tr_b16 v[40:41], v7 offset:64
    v_mfma_f32_16x16x32_bf16 v[116:119], v[52:55], v[20:23], v[116:119]
    ds_read_b64_tr_b16 v[42:43], v7 offset:1344
    s_waitcnt lgkmcnt(8)
    v_mfma_f32_16x16x32_bf16 v[96:99], v[56:59], v[24:27], v[96:99]
    ds_read_b128 v[16:19], v6 offset:4096
    ds_read_b128 v[20:23], v6 offset:4352
    v_mfma_f32_16x16x32_bf16 v[100:103], v[56:59], v[28:31], v[100:103]
    ds_read_b64_tr_b16 v[44:45], v7 offset:5120
    ds_read_b64_tr_b16 v[46:47], v7 offset:6400
    v_mfma_f32_16x16x32_bf16 v[104:107], v[60:63], v[24:27], v[104:107]
    ds_read_b64_tr_b16 v[48:49], v7 offset:5152
    v_mfma_f32_16x16x32_bf16 v[108:111], v[60:63], v[28:31], v[108:111]
    ds_read_b64_tr_b16 v[50:51], v7 offset:6432
    v_mfma_f32_16x16x32_bf16 v[112:115], v[64:67], v[24:27], v[112:115]
    ds_read_b64_tr_b16 v[52:53], v7 offset:5184
    v_mfma_f32_16x16x32_bf16 v[116:119], v[64:67], v[28:31], v[116:119]
    ds_read_b64_tr_b16 v[54:55], v7 offset:6464
    s_waitcnt lgkmcnt(8)
    v_mfma_f32_16x16x32_bf16 v[96:99], v[32:35], v[8:11], v[96:99]
    ds_read_b128 v[24:27], v6 offset:8192
    ds_read_b128 v[28:31], v6 offset:8448
    v_mfma_f32_16x16x32_bf16 v[100:103], v[32:35], v[12:15], v[100:103]
    ds_read_b64_tr_b16 v[56:57], v7 offset:10240
    ds_read_b64_tr_b16 v[58:59], v7 offset:11520
    v_mfma_f32_16x16x32_bf16 v[104:107], v[36:39], v[8:11], v[104:107]
    ds_read_b64_tr_b16 v[60:61], v7 offset:10272
    v_mfma_f32_16x16x32_bf16 v[108:111], v[36:39], v[12:15], v[108:111]
    ds_read_b64_tr_b16 v[62:63], v7 offset:11552
    v_mfma_f32_16x16x32_bf16 v[112:115], v[40:43], v[8:11], v[112:115]
    ds_read_b64_tr_b16 v[64:65], v7 offset:10304
    v_mfma_f32_16x16x32_bf16 v[116:119], v[40:43], v[12:15], v[116:119]
    ds_read_b64_tr_b16 v[66:67], v7 offset:11584
    s_waitcnt lgkmcnt(8)
    v_mfma_f32_16x16x32_bf16 v[96:99], v[44:47], v[16:19], v[96:99]
    ds_read_b128 v[8:11], v6 offset:12288
    ds_read_b128 v[12:15], v6 offset:12544
    v_mfma_f32_16x16x32_bf16 v[100:103], v[44:47], v[20:23], v[100:103]
    ds_read_b64_tr_b16 v[32:33], v7 offset:15360
    ds_read_b64_tr_b16 v[34:35], v7 offset:16640
    v_mfma_f32_16x16x32_bf16 v[104:107], v[48:51], v[16:19], v[104:107]
    ds_read_b64_tr_b16 v[36:37], v7 offset:15392
    v_mfma_f32_16x16x32_bf16 v[108:111], v[48:51], v[20:23], v[108:111]
    ds_read_b64_tr_b16 v[38:39], v7 offset:16672
    v_mfma_f32_16x16x32_bf16 v[112:115], v[52:55], v[16:19], v[112:115]
    ds_read_b64_tr_b16 v[40:41], v7 offset:15424
    v_mfma_f32_16x16x32_bf16 v[116:119], v[52:55], v[20:23], v[116:119]
    ds_read_b64_tr_b16 v[42:43], v7 offset:16704
    s_waitcnt lgkmcnt(8)
    v_mfma_f32_16x16x32_bf16 v[96:99], v[56:59], v[24:27], v[96:99]
    s_barrier
    v_add_u32 v120, 36864, v4
    v_add_u32 v121, 36864, v5
    ds_read_b128 v[16:19], v120 offset:0
    ds_read_b128 v[20:23], v120 offset:256
    v_mfma_f32_16x16x32_bf16 v[100:103], v[56:59], v[28:31], v[100:103]
    ds_read_b64_tr_b16 v[44:45], v121 offset:0
    ds_read_b64_tr_b16 v[46:47], v121 offset:1280
    v_mfma_f32_16x16x32_bf16 v[104:107], v[60:63], v[24:27], v[104:107]
    ds_read_b64_tr_b16 v[48:49], v121 offset:32
    v_mfma_f32_16x16x32_bf16 v[108:111], v[60:63], v[28:31], v[108:111]
    ds_read_b64_tr_b16 v[50:51], v121 offset:1312
    v_mfma_f32_16x16x32_bf16 v[112:115], v[64:67], v[24:27], v[112:115]
    ds_read_b64_tr_b16 v[52:53], v121 offset:64
    v_mfma_f32_16x16x32_bf16 v[116:119], v[64:67], v[28:31], v[116:119]
    ds_read_b64_tr_b16 v[54:55], v121 offset:1344
    s_waitcnt lgkmcnt(8)
    v_mfma_f32_16x16x32_bf16 v[96:99], v[32:35], v[8:11], v[96:99]
    ds_read_b128 v[24:27], v120 offset:4096
    ds_read_b128 v[28:31], v120 offset:4352
    v_mfma_f32_16x16x32_bf16 v[100:103], v[32:35], v[12:15], v[100:103]
    ds_read_b64_tr_b16 v[56:57], v121 offset:5120
    ds_read_b64_tr_b16 v[58:59], v121 offset:6400
    v_mfma_f32_16x16x32_bf16 v[104:107], v[36:39], v[8:11], v[104:107]
    ds_read_b64_tr_b16 v[60:61], v121 offset:5152
    v_mfma_f32_16x16x32_bf16 v[108:111], v[36:39], v[12:15], v[108:111]
    ds_read_b64_tr_b16 v[62:63], v121 offset:6432
    v_mfma_f32_16x16x32_bf16 v[112:115], v[40:43], v[8:11], v[112:115]
    ds_read_b64_tr_b16 v[64:65], v121 offset:5184
    v_mfma_f32_16x16x32_bf16 v[116:119], v[40:43], v[12:15], v[116:119]
    ds_read_b64_tr_b16 v[66:67], v121 offset:6464
    s_waitcnt lgkmcnt(8)
    v_mfma_f32_16x16x32_bf16 v[96:99], v[44:47], v[16:19], v[96:99]
    ds_read_b128 v[8:11], v120 offset:8192
    ds_read_b128 v[12:15], v120 offset:8448
    v_mfma_f32_16x16x32_bf16 v[100:103], v[44:47], v[20:23], v[100:103]
    ds_read_b64_tr_b16 v[32:33], v121 offset:10240
    ds_read_b64_tr_b16 v[34:35], v121 offset:11520
    v_mfma_f32_16x16x32_bf16 v[104:107], v[48:51], v[16:19], v[104:107]
    ds_read_b64_tr_b16 v[36:37], v121 offset:10272
    v_mfma_f32_16x16x32_bf16 v[108:111], v[48:51], v[20:23], v[108:111]
    ds_read_b64_tr_b16 v[38:39], v121 offset:11552
    v_mfma_f32_16x16x32_bf16 v[112:115], v[52:55], v[16:19], v[112:115]
    ds_read_b64_tr_b16 v[40:41], v121 offset:10304
    v_mfma_f32_16x16x32_bf16 v[116:119], v[52:55], v[20:23], v[116:119]
    ds_read_b64_tr_b16 v[42:43], v121 offset:11584
    s_waitcnt lgkmcnt(8)
    v_mfma_f32_16x16x32_bf16 v[96:99], v[56:59], v[24:27], v[96:99]
    ds_read_b128 v[16:19], v120 offset:12288
    ds_read_b128 v[20:23], v120 offset:12544
    v_mfma_f32_16x16x32_bf16 v[100:103], v[56:59], v[28:31], v[100:103]
    ds_read_b64_tr_b16 v[44:45], v121 offset:15360
    ds_read_b64_tr_b16 v[46:47], v121 offset:16640
    v_mfma_f32_16x16x32_bf16 v[104:107], v[60:63], v[24:27], v[104:107]
    ds_read_b64_tr_b16 v[48:49], v121 offset:15392
    v_mfma_f32_16x16x32_bf16 v[108:111], v[60:63], v[28:31], v[108:111]
    ds_read_b64_tr_b16 v[50:51], v121 offset:16672
    v_mfma_f32_16x16x32_bf16 v[112:115], v[64:67], v[24:27], v[112:115]
    ds_read_b64_tr_b16 v[52:53], v121 offset:15424
    v_mfma_f32_16x16x32_bf16 v[116:119], v[64:67], v[28:31], v[116:119]
    ds_read_b64_tr_b16 v[54:55], v121 offset:16704
    s_waitcnt lgkmcnt(8)
    v_mfma_f32_16x16x32_bf16 v[96:99], v[32:35], v[8:11], v[96:99]
    v_mfma_f32_16x16x32_bf16 v[100:103], v[32:35], v[12:15], v[100:103]
    v_mfma_f32_16x16x32_bf16 v[104:107], v[36:39], v[8:11], v[104:107]
    v_mfma_f32_16x16x32_bf16 v[108:111], v[36:39], v[12:15], v[108:111]
    v_mfma_f32_16x16x32_bf16 v[112:115], v[40:43], v[8:11], v[112:115]
    v_mfma_f32_16x16x32_bf16 v[116:119], v[40:43], v[12:15], v[116:119]
    s_waitcnt lgkmcnt(0)
    v_mfma_f32_16x16x32_bf16 v[96:99], v[44:47], v[16:19], v[96:99]
    v_mfma_f32_16x16x32_bf16 v[100:103], v[44:47], v[20:23], v[100:103]
    v_mfma_f32_16x16x32_bf16 v[104:107], v[48:51], v[16:19], v[104:107]
    v_mfma_f32_16x16x32_bf16 v[108:111], v[48:51], v[20:23], v[108:111]
    v_mfma_f32_16x16x32_bf16 v[112:115], v[52:55], v[16:19], v[112:115]
    v_mfma_f32_16x16x32_bf16 v[116:119], v[52:55], v[20:23], v[116:119]
    s_nop 7
    s_waitcnt vmcnt(0)
    v_lshlrev_b32 v24, 16, v70
    v_and_b32 v25, 0xffff0000, v70
    v_lshlrev_b32 v26, 16, v71
    v_and_b32 v27, 0xffff0000, v71
    v_add_f32 v96, v96, v24
    v_add_f32 v97, v97, v25
    v_add_f32 v98, v98, v26
    v_add_f32 v99, v99, v27
    v_cvt_pk_bf16_f32 v8, v96, v97
    v_cvt_pk_bf16_f32 v9, v98, v99
    s_mov_b32 s23, 0
    buffer_store_dwordx2 v[8:9], v85, s[16:19], s23 offen
    v_lshlrev_b32 v24, 16, v72
    v_and_b32 v25, 0xffff0000, v72
    v_lshlrev_b32 v26, 16, v73
    v_and_b32 v27, 0xffff0000, v73
    v_add_f32 v100, v100, v24
    v_add_f32 v101, v101, v25
    v_add_f32 v102, v102, v26
    v_add_f32 v103, v103, v27
    v_cvt_pk_bf16_f32 v10, v100, v101
    v_cvt_pk_bf16_f32 v11, v102, v103
    s_mov_b32 s23, 20480
    buffer_store_dwordx2 v[10:11], v85, s[16:19], s23 offen
    v_lshlrev_b32 v24, 16, v74
    v_and_b32 v25, 0xffff0000, v74
    v_lshlrev_b32 v26, 16, v75
    v_and_b32 v27, 0xffff0000, v75
    v_add_f32 v104, v104, v24
    v_add_f32 v105, v105, v25
    v_add_f32 v106, v106, v26
    v_add_f32 v107, v107, v27
    v_cvt_pk_bf16_f32 v12, v104, v105
    v_cvt_pk_bf16_f32 v13, v106, v107
    s_mov_b32 s23, 32
    buffer_store_dwordx2 v[12:13], v85, s[16:19], s23 offen
    v_lshlrev_b32 v24, 16, v76
    v_and_b32 v25, 0xffff0000, v76
    v_lshlrev_b32 v26, 16, v77
    v_and_b32 v27, 0xffff0000, v77
    v_add_f32 v108, v108, v24
    v_add_f32 v109, v109, v25
    v_add_f32 v110, v110, v26
    v_add_f32 v111, v111, v27
    v_cvt_pk_bf16_f32 v14, v108, v109
    v_cvt_pk_bf16_f32 v15, v110, v111
    s_mov_b32 s23, 20512
    buffer_store_dwordx2 v[14:15], v85, s[16:19], s23 offen
    v_lshlrev_b32 v24, 16, v78
    v_and_b32 v25, 0xffff0000, v78
    v_lshlrev_b32 v26, 16, v79
    v_and_b32 v27, 0xffff0000, v79
    v_add_f32 v112, v112, v24
    v_add_f32 v113, v113, v25
    v_add_f32 v114, v114, v26
    v_add_f32 v115, v115, v27
    v_cvt_pk_bf16_f32 v16, v112, v113
    v_cvt_pk_bf16_f32 v17, v114, v115
    s_add_u32 s23, s44, 64
    buffer_store_dwordx2 v[16:17], v85, s[16:19], s23 offen
    v_lshlrev_b32 v24, 16, v80
    v_and_b32 v25, 0xffff0000, v80
    v_lshlrev_b32 v26, 16, v81
    v_and_b32 v27, 0xffff0000, v81
    v_add_f32 v116, v116, v24
    v_add_f32 v117, v117, v25
    v_add_f32 v118, v118, v26
    v_add_f32 v119, v119, v27
    v_cvt_pk_bf16_f32 v18, v116, v117
    v_cvt_pk_bf16_f32 v19, v118, v119
    s_add_u32 s23, s44, 20544
    buffer_store_dwordx2 v[18:19], v85, s[16:19], s23 offen
L_exit:
    s_endpgm
.section .rodata,"a"
.p2align 6
.amdhsa_kernel sequential_preLN__softmax_full_mha__dense_activation_relu__prompt_kernel
  .amdhsa_next_free_vgpr 256
  .amdhsa_next_free_sgpr 102
  .amdhsa_accum_offset 176
  .amdhsa_group_segment_fixed_size 0
  .amdhsa_kernarg_size 72
  .amdhsa_user_sgpr_count 2
  .amdhsa_user_sgpr_kernarg_segment_ptr 1
  .amdhsa_system_sgpr_workgroup_id_x 1
  .amdhsa_float_denorm_mode_32 3
  .amdhsa_float_denorm_mode_16_64 3
.end_amdhsa_kernel
```
